```python
import torch

def _softmax(x, axis=-1):
    return torch.softmax(x, dim=axis)
def _gelu(x):
    return torch.nn.functional.gelu(x, approximate="tanh")
def _silu(x):
    return torch.nn.functional.silu(x)
def _sigmoid(x):
    return torch.sigmoid(x)
def _layernorm(x, axis=-1, eps=1e-5):
    m = x.mean(dim=axis, keepdim=True)
    v = x.var(dim=axis, keepdim=True, unbiased=False)
    return (x - m) / torch.sqrt(v + eps)
def _scatter_add(tgt, idx, src, axis=0):
    return tgt.clone().index_add_(axis, idx, src)
def _segment_sum(src, seg, n):
    out = torch.zeros((n,) + src.shape[1:], dtype=src.dtype)
    return out.index_add_(0, seg, src)
def _pad(x, pw):
    flat = tuple(v for pair in reversed(pw) for v in pair)
    return torch.nn.functional.pad(x, flat)

kernel_name = 'gated_mix__softmax_full_mha__glu_gated_glu__prompt'

def setup_inputs():

    _w = (lambda a: (lambda t: t.to(torch.bfloat16) if t.is_floating_point() else t)(torch.as_tensor(a)))
    def _A_setup():
        B, S, D = 1, 2048, 448
        return {
            "x": _w((lambda *s: torch.randn(*s, dtype=torch.bfloat16) * 0.05)(B, S, D)),
            "wqkv": _w((lambda *s: torch.randn(*s, dtype=torch.bfloat16) * 0.8)(D, 3 * D)),
            "wo": _w((lambda *s: torch.randn(*s, dtype=torch.bfloat16) * 0.1)(D, D)),
        }
    _A_in = _A_setup()

    def _B_setup():
        B, S, D, F = 1, 2048, 448, 1792
        return {
            "x": _w((lambda *s: torch.randn(*s, dtype=torch.bfloat16) * 0.05)(B, S, D)),
            "w_gate": _w((lambda *s: torch.randn(*s, dtype=torch.bfloat16) * 0.4)(D, F)),
            "w_up": _w((lambda *s: torch.randn(*s, dtype=torch.bfloat16) * 0.05)(D, F)),
            "w_down": _w((lambda *s: torch.randn(*s, dtype=torch.bfloat16) * 0.05)(F, D)),
        }
    _B_in = _B_setup()

    return {
        "A_x": _A_in["x"],
        "A_wqkv": _A_in["wqkv"],
        "A_wo": _A_in["wo"],
        "B_x": _B_in["x"],
        "B_w_gate": _B_in["w_gate"],
        "B_w_up": _B_in["w_up"],
        "B_w_down": _B_in["w_down"],
        "gate_w": _w((lambda *s: torch.randn(*s, dtype=torch.bfloat16) * 0.05)(448) * 16.0),
    }

def reference(A_x, A_wqkv, A_wo, B_x, B_w_gate, B_w_up, B_w_down, gate_w):
    def _A_ref(x, wqkv, wo):
        B, S, D = x.shape
        H = 16; Dh = D // H
        qkv = (lambda x, *d: x.permute(*d))((x @ wqkv).reshape(B, S, 3, H, Dh), 2, 0, 3, 1, 4)
        q, k, v = qkv[0], qkv[1], qkv[2]
        scale = Dh ** -0.5
        scores = torch.einsum("bhqd,bhkd->bhqk", q, k) * scale
        p = _softmax(scores, axis=-1)
        o = torch.einsum("bhqk,bhkd->bhqd", p, v)
        return (lambda x, *d: x.permute(*d))(o, 0, 2, 1, 3).reshape(B, S, D) @ wo

    def _B_ref(x, w_gate, w_up, w_down):
        g = torch.einsum("bsd,df->bsf", x, w_gate)
        u = torch.einsum("bsd,df->bsf", x, w_up)
        h = _sigmoid(g) * u
        return torch.einsum("bsf,fd->bsd", h, w_down)

    x = A_x
    g = _sigmoid((x * gate_w).sum(-1, keepdims=True))
    a = _A_ref(x, A_wqkv, A_wo)
    b = _B_ref(x, B_w_gate, B_w_up, B_w_down)
    return g * a + (1 - g) * b
```

```asm
; @launch kernel=f_kernel grid=(256,1,1) block=(512,1,1) lds=161536
.amdgcn_target "amdgcn-amd-amdhsa--gfx950"
.text
.globl f_kernel
.p2align 8
.type f_kernel,@function
f_kernel:
  s_cmp_ge_u32 s2, 256
  s_cbranch_scc1 f_exit
  s_load_dwordx8 s[4:11], s[0:1], 0
  s_load_dwordx8 s[12:19], s[0:1], 32
  s_load_dwordx4 s[20:23], s[0:1], 64
  s_load_dwordx2 s[24:25], s[0:1], 80
  v_and_b32 v1, 63, v0
  v_lshrrev_b32 v3, 6, v0
  s_and_b32 s49, s2, 7
  v_readfirstlane_b32 s48, v3
  s_lshr_b32 s50, s2, 3
  v_lshlrev_b32 v2, 4, v1
  s_and_b32 s55, s49, 1
  s_lshl_b32 s55, s55, 3
  s_and_b32 s56, s50, 7
  s_add_u32 s51, s55, s56
  s_lshr_b32 s55, s49, 1
  s_lshl_b32 s55, s55, 2
  s_lshr_b32 s56, s50, 3
  s_add_u32 s52, s55, s56
  s_mul_i32 s55, s51, 1
  s_mul_i32 s56, s52, 1
  s_add_u32 s53, s55, s56
  s_mul_i32 s55, s53, 9363
  s_lshr_b32 s55, s55, 16
  s_mul_i32 s55, s55, 7
  s_sub_u32 s53, s53, s55
  s_mov_b32 s54, 0x186a0
  s_cmp_ge_u32 s48, 4
  s_cbranch_scc1 f_gemm
  v_lshrrev_b32 v3, 3, v1
  s_lshl_b32 s55, s48, 4
  v_add_u32 v3, s55, v3
  v_mul_u32_u24 v3, 2688, v3
  v_and_b32 v4, 7, v1
  v_bfe_u32 v5, v1, 4, 1
  v_lshlrev_b32 v5, 2, v5
  v_xor_b32 v4, v4, v5
  v_lshl_add_u32 v3, v4, 4, v3
  s_lshl_b32 s56, s52, 7
  s_add_u32 s56, s56, 896
  v_add_u32 v128, s56, v3
  s_mul_i32 s59, s53, 172032
  s_lshl_b32 s61, s48, 11
  v_mov_b32 v11, 0x27600
  v_lshl_add_u32 v3, v1, 2, v11
  v_mov_b32 v4, 0
  s_cmp_lg_u32 s48, 0
  s_cbranch_scc1 Lz1
  ds_write_b32 v3, v4
Lz1:
  s_waitcnt lgkmcnt(0)
  s_mov_b32 s32, s6
  s_and_b32 s33, s7, 0xffff
  s_mov_b32 s34, 0x126000
  s_mov_b32 s35, 0x00020000
  s_mov_b32 s36, s6
  s_and_b32 s37, s7, 0xffff
  s_mov_b32 s38, 0x126000
  s_mov_b32 s39, 0x00020000
  s_cmp_ge_u32 s52, 14
  s_cselect_b32 s38, 0, s38
  s_mov_b32 s28, s24
  s_and_b32 s29, s25, 0xffff
  s_mov_b32 s30, 0x10000000
  s_mov_b32 s31, 0x00020000
  s_xor_b32 s55, s2, 0
  s_or_b32 s55, s55, s48
  s_cmp_lg_u32 s55, 0
  s_cbranch_scc1 Lz2
  v_mov_b32 v136, 0
  v_mov_b32 v137, 0
  v_mov_b32 v138, 0
  v_mov_b32 v139, 0
  s_mov_b32 s55, 0x1c00000
  buffer_store_dwordx4 v[136:139], v2, s[28:31], s55 offen offset:0 sc1
  buffer_store_dwordx4 v[136:139], v2, s[28:31], s55 offen offset:1024 sc1
  buffer_store_dwordx4 v[136:139], v2, s[28:31], s55 offen offset:2048 sc1
  buffer_store_dwordx4 v[136:139], v2, s[28:31], s55 offen offset:3072 sc1
  s_add_u32 s55, s55, 4096
  buffer_store_dwordx4 v[136:139], v2, s[28:31], s55 offen offset:0 sc1
  buffer_store_dwordx4 v[136:139], v2, s[28:31], s55 offen offset:1024 sc1
  buffer_store_dwordx4 v[136:139], v2, s[28:31], s55 offen offset:2048 sc1
  buffer_store_dwordx4 v[136:139], v2, s[28:31], s55 offen offset:3072 sc1
  s_add_u32 s55, s55, 4096
  buffer_store_dwordx4 v[136:139], v2, s[28:31], s55 offen offset:0 sc1
  buffer_store_dwordx4 v[136:139], v2, s[28:31], s55 offen offset:1024 sc1
  buffer_store_dwordx4 v[136:139], v2, s[28:31], s55 offen offset:2048 sc1
  buffer_store_dwordx4 v[136:139], v2, s[28:31], s55 offen offset:3072 sc1
  s_add_u32 s55, s55, 4096
Lz2:
  s_mov_b32 s40, s4
  s_and_b32 s41, s5, 0xffff
  s_mov_b32 s42, 0x1c0000
  s_mov_b32 s43, 0x00020000
  s_lshl_b32 s55, s51, 2
  s_add_u32 s55, s55, s48
  v_lshrrev_b32 v3, 3, v1
  v_and_b32 v4, 7, v1
  v_lshrrev_b32 v5, 4, v1
  v_xor_b32 v5, v5, v4
  s_lshl_b32 s55, s55, 5
  v_add_u32 v6, s55, v3
  v_mul_u32_u24 v6, 896, v6
  v_lshl_add_u32 v141, v5, 4, v6
  v_xor_b32 v5, 4, v5
  v_lshl_add_u32 v142, v5, 4, v6
  v_add_u32 v142, 7168, v142
  v_add_u32 v143, 14336, v141
  v_add_u32 v144, 14336, v142
  s_add_u32 s55, s53, 0
  s_sub_u32 s56, s55, 7
  s_min_u32 s55, s55, s56
  s_lshl_b32 s17, s55, 7
  s_lshl_b32 s4, s48, 14
  s_add_u32 m0, s4, 0x0
  s_nop 0
  buffer_load_dwordx4 v141, s[40:43], s17 offen lds
  s_add_u32 m0, s4, 0x400
  s_nop 0
  buffer_load_dwordx4 v142, s[40:43], s17 offen lds
  s_add_u32 m0, s4, 0x800
  s_nop 0
  buffer_load_dwordx4 v143, s[40:43], s17 offen lds
  s_add_u32 m0, s4, 0xc00
  s_nop 0
  buffer_load_dwordx4 v144, s[40:43], s17 offen lds
  s_add_u32 s17, s17, 128
  s_cmp_eq_u32 s17, 896
  s_cselect_b32 s17, 0, s17
  s_add_u32 m0, s61, 0x10000
  s_nop 0
  buffer_load_dwordx4 v128, s[36:39], s59 offen lds
  s_add_u32 s55, s59, 21504
  s_add_u32 m0, s61, 0x10400
  s_nop 0
  buffer_load_dwordx4 v128, s[36:39], s55 offen lds
  s_add_u32 s59, s59, 172032
  s_cmp_eq_u32 s59, 1204224
  s_cselect_b32 s59, 0, s59
  s_add_u32 m0, s4, 0x1000
  s_nop 0
  buffer_load_dwordx4 v141, s[40:43], s17 offen lds
  s_add_u32 m0, s4, 0x1400
  s_nop 0
  buffer_load_dwordx4 v142, s[40:43], s17 offen lds
  s_add_u32 m0, s4, 0x1800
  s_nop 0
  buffer_load_dwordx4 v143, s[40:43], s17 offen lds
  s_add_u32 m0, s4, 0x1c00
  s_nop 0
  buffer_load_dwordx4 v144, s[40:43], s17 offen lds
  s_add_u32 s17, s17, 128
  s_cmp_eq_u32 s17, 896
  s_cselect_b32 s17, 0, s17
  s_add_u32 m0, s61, 0x12000
  s_nop 0
  buffer_load_dwordx4 v128, s[36:39], s59 offen lds
  s_add_u32 s55, s59, 21504
  s_add_u32 m0, s61, 0x12400
  s_nop 0
  buffer_load_dwordx4 v128, s[36:39], s55 offen lds
  s_add_u32 s59, s59, 172032
  s_cmp_eq_u32 s59, 1204224
  s_cselect_b32 s59, 0, s59
  s_barrier
  s_add_u32 m0, s4, 0x2000
  s_nop 0
  buffer_load_dwordx4 v141, s[40:43], s17 offen lds
  s_add_u32 m0, s4, 0x2400
  s_nop 0
  buffer_load_dwordx4 v142, s[40:43], s17 offen lds
  s_add_u32 m0, s4, 0x2800
  s_nop 0
  buffer_load_dwordx4 v143, s[40:43], s17 offen lds
  s_add_u32 m0, s4, 0x2c00
  s_nop 0
  buffer_load_dwordx4 v144, s[40:43], s17 offen lds
  s_add_u32 s17, s17, 128
  s_cmp_eq_u32 s17, 896
  s_cselect_b32 s17, 0, s17
  s_add_u32 m0, s61, 0x14000
  s_nop 0
  buffer_load_dwordx4 v128, s[36:39], s59 offen lds
  s_add_u32 s55, s59, 21504
  s_add_u32 m0, s61, 0x14400
  s_nop 0
  buffer_load_dwordx4 v128, s[36:39], s55 offen lds
  s_add_u32 s59, s59, 172032
  s_cmp_eq_u32 s59, 1204224
  s_cselect_b32 s59, 0, s59
  s_lshl_b32 s55, s48, 2
  v_add_u32 v12, s55, v11
  s_lshl_b32 s55, s48, 4
  v_lshrrev_b32 v3, 4, v1
  v_and_b32 v4, 15, v1
  v_add_u32 v4, s55, v4
  v_add_u32 v5, s53, v3
  v_subrev_u32 v6, 7, v5
  v_min_u32 v5, v5, v6
  v_lshl_add_u32 v5, v5, 6, v4
  v_lshlrev_b32 v132, 1, v5
  v_add_u32 v5, s53, v3
  v_add_u32 v5, 4, v5
  v_subrev_u32 v6, 7, v5
  v_min_u32 v5, v5, v6
  v_lshl_add_u32 v5, v5, 6, v4
  v_lshlrev_b32 v133, 1, v5
  v_lshlrev_b32 v5, 12, v3
  v_lshl_add_u32 v5, v4, 6, v5
  v_add_u32 v134, 0x1e038, v5
  v_add_u32 v135, 0x4000, v134
  s_mov_b32 s44, s18
  s_and_b32 s45, s19, 0xffff
  s_mov_b32 s46, 0x380
  s_mov_b32 s47, 0x00020000
  buffer_load_ushort v132, v132, s[44:47], 0 offen
  buffer_load_ushort v133, v133, s[44:47], 0 offen
  s_lshl_b32 s55, s48, 4
  v_lshrrev_b32 v3, 2, v1
  v_add_u32 v3, s55, v3
  v_mul_u32_u24 v3, 2688, v3
  v_and_b32 v4, 3, v1
  v_lshl_add_u32 v3, v4, 4, v3
  s_mul_i32 s56, s52, 56
  v_add_u32 v129, s56, v3
  s_mul_i32 s62, s53, 172032
  s_lshl_b32 s60, s48, 10
  v_lshrrev_b32 v3, 3, v1
  v_bfe_u32 v4, v1, 4, 1
  v_lshlrev_b32 v4, 1, v4
  v_and_b32 v5, 7, v1
  v_xor_b32 v5, v5, v4
  s_lshl_b32 s55, s48, 4
  v_add_u32 v3, s55, v3
  v_mul_u32_u24 v3, 3584, v3
  v_lshl_add_u32 v3, v5, 4, v3
  s_lshl_b32 s55, s52, 7
  v_add_u32 v130, s55, v3
  v_xor_b32 v131, 64, v130
  s_mul_i32 s63, s53, 229376
  s_mul_i32 s55, s52, 28
  v_bfe_u32 v3, v1, 4, 1
  v_mul_u32_u24 v3, 27, v3
  v_add_u32 v3, s55, v3
  v_lshrrev_b32 v3, 6, v3
  v_lshrrev_b32 v4, 5, v1
  v_mul_u32_u24 v5, 7, v4
  v_add_u32 v3, v3, v5
  v_and_b32 v5, 15, v1
  v_lshl_add_u32 v3, v3, 6, v5
  s_lshl_b32 s56, s48, 6
  s_add_u32 s56, s56, 0x1c00000
  v_lshl_add_u32 v29, v3, 2, s56
  v_lshlrev_b32 v28, 3, v1
  v_mul_u32_u24 v4, 448, v4
  v_and_b32 v5, 31, v1
  v_lshl_add_u32 v31, v5, 4, v4
  s_mov_b32 s20, 0x0fffffff
  s_mov_b32 s21, 0x0fffffff
  v_cmp_eq_u32 vcc, 28, v5
  v_mov_b32 v3, 0x3f803f80
  s_nop 0
  v_cndmask_b32 v4, 0, v3, vcc
  v_mov_b32 v182, 0x3f803f80
  v_mov_b32 v183, 0x3f80
  v_mov_b32 v208, v4
  v_mov_b32 v209, v4
  v_mov_b32 v210, v4
  v_mov_b32 v211, v4
  v_mov_b32 v212, v4
  v_mov_b32 v213, v4
  v_mov_b32 v214, v4
  v_mov_b32 v215, v4
  v_mov_b32 v190, 0x3f803f80
  v_mov_b32 v191, 0x3f80
  v_mov_b32 v216, v4
  v_mov_b32 v217, v4
  v_mov_b32 v218, v4
  v_mov_b32 v219, v4
  v_mov_b32 v220, v4
  v_mov_b32 v221, v4
  v_mov_b32 v222, v4
  v_mov_b32 v223, v4
  v_mov_b32 v198, 0x3f803f80
  v_mov_b32 v199, 0x3f80
  v_mov_b32 v224, v4
  v_mov_b32 v225, v4
  v_mov_b32 v226, v4
  v_mov_b32 v227, v4
  v_mov_b32 v228, v4
  v_mov_b32 v229, v4
  v_mov_b32 v230, v4
  v_mov_b32 v231, v4
  v_mov_b32 v206, 0x3f803f80
  v_mov_b32 v207, 0x3f80
  v_mov_b32 v232, v4
  v_mov_b32 v233, v4
  v_mov_b32 v234, v4
  v_mov_b32 v235, v4
  v_mov_b32 v236, v4
  v_mov_b32 v237, v4
  v_mov_b32 v238, v4
  v_mov_b32 v239, v4
  s_lshl_b32 s57, s52, 2
  s_add_u32 s57, s57, s48
  s_mul_i32 s57, s57, 57344
  s_add_u32 s8, s57, 0x200000
  s_and_b32 s16, s51, 7
  s_mul_i32 s16, s16, 7168
  s_mov_b32 s11, 0
  s_lshl_b32 s55, s51, 2
  s_add_u32 s55, s55, s48
  s_lshl_b32 s55, s55, 4
  s_add_u32 s55, s55, s52
  s_lshl_b32 s27, s55, 11
  s_add_u32 s27, s27, 0x1000000
  s_lshl_b32 s26, s55, 2
  s_add_u32 s26, s26, 0x1c02000
  v_mov_b32 v30, s26
  v_add_u32 v21, 128, v11
  v_add_u32 v22, 128, v12
  s_mul_i32 s55, s48, 12288
  s_add_u32 s55, s55, 0x10000
  v_add_u32 v20, s55, v2
  s_sub_u32 s55, s48, 1
  s_and_b32 s55, s55, 3
  s_mul_i32 s55, s55, 12288
  s_add_u32 s55, s55, 65536
  v_add_u32 v17, s55, v2
  s_sub_u32 s55, s48, 2
  s_and_b32 s55, s55, 3
  s_mul_i32 s55, s55, 12288
  s_add_u32 s55, s55, 69632
  v_add_u32 v18, s55, v2
  s_sub_u32 s55, s48, 3
  s_and_b32 s55, s55, 3
  s_mul_i32 s55, s55, 12288
  s_add_u32 s55, s55, 73728
  v_add_u32 v19, s55, v2
  s_add_u32 s55, s48, 0
  s_and_b32 s55, s55, 3
  s_lshl_b32 s55, s55, 11
  s_add_u32 s55, s55, 0x25400
  v_add_u32 v24, s55, v2
  s_add_u32 s55, s48, 1
  s_and_b32 s55, s55, 3
  s_lshl_b32 s55, s55, 11
  s_add_u32 s55, s55, 0x25400
  v_add_u32 v25, s55, v2
  s_add_u32 s55, s48, 2
  s_and_b32 s55, s55, 3
  s_lshl_b32 s55, s55, 11
  s_add_u32 s55, s55, 0x25400
  v_add_u32 v26, s55, v2
  s_add_u32 s55, s48, 3
  s_and_b32 s55, s55, 3
  s_lshl_b32 s55, s55, 11
  s_add_u32 s55, s55, 0x25400
  v_add_u32 v27, s55, v2
  v_and_b32 v3, 31, v1
  s_lshl_b32 s55, s48, 7
  s_add_u32 s55, s55, 0x27400
  v_lshl_add_u32 v23, v3, 2, s55
  s_waitcnt vmcnt(14)
  s_xor_b32 s55, s2, 0
  s_or_b32 s55, s55, s48
  s_cmp_lg_u32 s55, 0
  s_cbranch_scc1 Lz3
  s_mov_b32 s44, s22
  s_and_b32 s45, s23, 0xffff
  s_mov_b32 s46, 0x100
  s_mov_b32 s47, 0x00020000
  v_mov_b32 v3, 1
  v_mov_b32 v4, 0
  buffer_store_dword v3, v4, s[44:47], 0 offen sc1
Lz3:
  v_mov_b32 v10, 1
  ds_write_b32 v12, v10 offset:0
  s_add_u32 m0, s4, 0x3000
  s_nop 0
  buffer_load_dwordx4 v141, s[40:43], s17 offen lds
  s_add_u32 m0, s4, 0x3400
  s_nop 0
  buffer_load_dwordx4 v142, s[40:43], s17 offen lds
  s_add_u32 m0, s4, 0x3800
  s_nop 0
  buffer_load_dwordx4 v143, s[40:43], s17 offen lds
  s_add_u32 m0, s4, 0x3c00
  s_nop 0
  buffer_load_dwordx4 v144, s[40:43], s17 offen lds
  s_add_u32 s17, s17, 128
  s_cmp_eq_u32 s17, 896
  s_cselect_b32 s17, 0, s17
  s_add_u32 m0, s61, 0x16000
  s_nop 0
  buffer_load_dwordx4 v128, s[36:39], s59 offen lds
  s_add_u32 s55, s59, 21504
  s_add_u32 m0, s61, 0x16400
  s_nop 0
  buffer_load_dwordx4 v128, s[36:39], s55 offen lds
  s_add_u32 s59, s59, 172032
  s_cmp_eq_u32 s59, 1204224
  s_cselect_b32 s59, 0, s59
  s_waitcnt vmcnt(14)
  v_mov_b32 v10, 2
  ds_write_b32 v12, v10 offset:0
Lp4:
  ds_read_b128 v[136:139], v11 offset:64
  s_waitcnt lgkmcnt(0)
  v_min_u32 v140, v136, v137
  v_min3_u32 v140, v140, v138, v139
  s_nop 0
  v_readfirstlane_b32 s58, v140
  s_cmp_ge_u32 s58, 1
  s_cbranch_scc1 Ld5
  s_sub_u32 s54, s54, 1
  s_cmp_gt_i32 s54, 0
  s_cbranch_scc1 Lp4
Ld5:
  s_add_u32 m0, s4, 0x0
  s_nop 0
  buffer_load_dwordx4 v141, s[40:43], s17 offen lds
  s_add_u32 m0, s4, 0x400
  s_nop 0
  buffer_load_dwordx4 v142, s[40:43], s17 offen lds
  s_add_u32 m0, s4, 0x800
  s_nop 0
  buffer_load_dwordx4 v143, s[40:43], s17 offen lds
  s_add_u32 m0, s4, 0xc00
  s_nop 0
  buffer_load_dwordx4 v144, s[40:43], s17 offen lds
  s_add_u32 s17, s17, 128
  s_cmp_eq_u32 s17, 896
  s_cselect_b32 s17, 0, s17
  s_add_u32 m0, s61, 0x18000
  s_nop 0
  buffer_load_dwordx4 v128, s[36:39], s59 offen lds
  s_add_u32 s55, s59, 21504
  s_add_u32 m0, s61, 0x18400
  s_nop 0
  buffer_load_dwordx4 v128, s[36:39], s55 offen lds
  s_add_u32 s59, s59, 172032
  s_cmp_eq_u32 s59, 1204224
  s_cselect_b32 s59, 0, s59
  s_waitcnt vmcnt(14)
  v_mov_b32 v10, 3
  ds_write_b32 v12, v10 offset:0
Lp6:
  ds_read_b128 v[136:139], v11 offset:64
  s_waitcnt lgkmcnt(0)
  v_min_u32 v140, v136, v137
  v_min3_u32 v140, v140, v138, v139
  s_nop 0
  v_readfirstlane_b32 s58, v140
  s_cmp_ge_u32 s58, 2
  s_cbranch_scc1 Ld7
  s_sub_u32 s54, s54, 1
  s_cmp_gt_i32 s54, 0
  s_cbranch_scc1 Lp6
Ld7:
  s_add_u32 m0, s4, 0x1000
  s_nop 0
  buffer_load_dwordx4 v141, s[40:43], s17 offen lds
  s_add_u32 m0, s4, 0x1400
  s_nop 0
  buffer_load_dwordx4 v142, s[40:43], s17 offen lds
  s_add_u32 m0, s4, 0x1800
  s_nop 0
  buffer_load_dwordx4 v143, s[40:43], s17 offen lds
  s_add_u32 m0, s4, 0x1c00
  s_nop 0
  buffer_load_dwordx4 v144, s[40:43], s17 offen lds
  s_add_u32 s17, s17, 128
  s_cmp_eq_u32 s17, 896
  s_cselect_b32 s17, 0, s17
  s_add_u32 m0, s61, 0x1a000
  s_nop 0
  buffer_load_dwordx4 v128, s[36:39], s59 offen lds
  s_add_u32 s55, s59, 21504
  s_add_u32 m0, s61, 0x1a400
  s_nop 0
  buffer_load_dwordx4 v128, s[36:39], s55 offen lds
  s_add_u32 s59, s59, 172032
  s_cmp_eq_u32 s59, 1204224
  s_cselect_b32 s59, 0, s59
  s_waitcnt vmcnt(12)
  v_mov_b32 v10, 4
  ds_write_b32 v12, v10 offset:0
Lp8:
  ds_read_b128 v[136:139], v11 offset:64
  s_waitcnt lgkmcnt(0)
  v_min_u32 v140, v136, v137
  v_min3_u32 v140, v140, v138, v139
  s_nop 0
  v_readfirstlane_b32 s58, v140
  s_cmp_ge_u32 s58, 3
  s_cbranch_scc1 Ld9
  s_sub_u32 s54, s54, 1
  s_cmp_gt_i32 s54, 0
  s_cbranch_scc1 Lp8
Ld9:
  s_add_u32 m0, s4, 0x2000
  s_nop 0
  buffer_load_dwordx4 v141, s[40:43], s17 offen lds
  s_add_u32 m0, s4, 0x2400
  s_nop 0
  buffer_load_dwordx4 v142, s[40:43], s17 offen lds
  s_add_u32 m0, s4, 0x2800
  s_nop 0
  buffer_load_dwordx4 v143, s[40:43], s17 offen lds
  s_add_u32 m0, s4, 0x2c00
  s_nop 0
  buffer_load_dwordx4 v144, s[40:43], s17 offen lds
  s_add_u32 s17, s17, 128
  s_cmp_eq_u32 s17, 896
  s_cselect_b32 s17, 0, s17
  s_add_u32 m0, s61, 0x1c000
  s_nop 0
  buffer_load_dwordx4 v128, s[36:39], s59 offen lds
  s_add_u32 s55, s59, 21504
  s_add_u32 m0, s61, 0x1c400
  s_nop 0
  buffer_load_dwordx4 v128, s[36:39], s55 offen lds
  s_add_u32 s59, s59, 172032
  s_cmp_eq_u32 s59, 1204224
  s_cselect_b32 s59, 0, s59
  s_waitcnt vmcnt(12)
  v_mov_b32 v10, 5
  ds_write_b32 v12, v10 offset:0
  s_waitcnt vmcnt(6)
  v_mov_b32 v10, 6
  ds_write_b32 v12, v10 offset:0
  s_add_u32 m0, s60, 0x1e000
  s_nop 0
  buffer_load_dwordx4 v129, s[32:35], s62 offen lds
  s_add_u32 s62, s62, 172032
  s_cmp_eq_u32 s62, 1204224
  s_cselect_b32 s62, 0, s62
  s_add_u32 m0, s60, 0x1f000
  s_nop 0
  buffer_load_dwordx4 v129, s[32:35], s62 offen lds
  s_add_u32 s62, s62, 172032
  s_cmp_eq_u32 s62, 1204224
  s_cselect_b32 s62, 0, s62
  s_waitcnt vmcnt(2)
  v_mov_b32 v10, 7
  ds_write_b32 v12, v10 offset:0
  s_add_u32 m0, s60, 0x20000
  s_nop 0
  buffer_load_dwordx4 v129, s[32:35], s62 offen lds
  s_add_u32 s62, s62, 172032
  s_cmp_eq_u32 s62, 1204224
  s_cselect_b32 s62, 0, s62
  s_add_u32 m0, s60, 0x21000
  s_nop 0
  buffer_load_dwordx4 v129, s[32:35], s62 offen lds
  s_add_u32 s62, s62, 172032
  s_cmp_eq_u32 s62, 1204224
  s_cselect_b32 s62, 0, s62
  s_waitcnt vmcnt(3)
  s_mov_b32 exec_lo, 0xffff
  s_mov_b32 exec_hi, 0x0
  ds_write_b16 v134, v132
  s_mov_b64 exec, -1
  v_mov_b32 v10, 8
  ds_write_b32 v12, v10 offset:0
  s_add_u32 m0, s60, 0x22000
  s_nop 0
  buffer_load_dwordx4 v129, s[32:35], s62 offen lds
  s_add_u32 s62, s62, 172032
  s_cmp_eq_u32 s62, 1204224
  s_cselect_b32 s62, 0, s62
  s_waitcnt vmcnt(3)
  s_mov_b32 exec_lo, 0xffff0000
  s_mov_b32 exec_hi, 0x0
  ds_write_b16 v134, v132
  s_mov_b64 exec, -1
  v_mov_b32 v10, 9
  ds_write_b32 v12, v10 offset:0
  s_add_u32 m0, s60, 0x23000
  s_nop 0
  buffer_load_dwordx4 v129, s[32:35], s62 offen lds
  s_add_u32 s62, s62, 172032
  s_cmp_eq_u32 s62, 1204224
  s_cselect_b32 s62, 0, s62
  s_waitcnt vmcnt(3)
  s_mov_b32 exec_lo, 0x0
  s_mov_b32 exec_hi, 0xffff
  ds_write_b16 v134, v132
  s_mov_b64 exec, -1
  v_mov_b32 v10, 10
  ds_write_b32 v12, v10 offset:0
  s_add_u32 m0, s60, 0x24000
  s_nop 0
  buffer_load_dwordx4 v129, s[32:35], s62 offen lds
  s_add_u32 s62, s62, 172032
  s_cmp_eq_u32 s62, 1204224
  s_cselect_b32 s62, 0, s62
  s_waitcnt vmcnt(3)
  s_mov_b32 exec_lo, 0x0
  s_mov_b32 exec_hi, 0xffff0000
  ds_write_b16 v134, v132
  s_mov_b64 exec, -1
  v_mov_b32 v10, 11
  ds_write_b32 v12, v10 offset:0
  s_waitcnt vmcnt(2)
  s_mov_b32 exec_lo, 0xffff
  s_mov_b32 exec_hi, 0x0
  ds_write_b16 v135, v133
  s_mov_b64 exec, -1
  v_mov_b32 v10, 12
  ds_write_b32 v12, v10 offset:0
Lp10:
  ds_read_b128 v[136:139], v11 offset:16
  s_waitcnt lgkmcnt(0)
  v_min_u32 v140, v136, v137
  v_min3_u32 v140, v140, v138, v139
  s_nop 0
  v_readfirstlane_b32 s58, v140
  s_cmp_ge_u32 s58, 2
  s_cbranch_scc1 Ld11
  s_sleep 1
  s_sub_u32 s54, s54, 1
  s_cmp_gt_i32 s54, 0
  s_cbranch_scc1 Lp10
Ld11:
  s_mov_b32 s36, s12
  s_and_b32 s37, s13, 0xffff
  s_mov_b32 s38, 0x188000
  s_mov_b32 s39, 0x00020000
  s_mov_b32 s40, s14
  s_and_b32 s41, s15, 0xffff
  s_mov_b32 s42, 0x188000
  s_mov_b32 s43, 0x00020000
  s_add_u32 m0, s61, 0x10000
  s_nop 0
  buffer_load_dwordx4 v130, s[36:39], s63 offen lds
  s_add_u32 s55, s63, 28672
  s_add_u32 m0, s61, 0x10400
  s_nop 0
  buffer_load_dwordx4 v130, s[36:39], s55 offen lds
  s_add_u32 m0, s61, 0x12000
  s_nop 0
  buffer_load_dwordx4 v131, s[40:43], s63 offen lds
  s_add_u32 s55, s63, 28672
  s_add_u32 m0, s61, 0x12400
  s_nop 0
  buffer_load_dwordx4 v131, s[40:43], s55 offen lds
  s_add_u32 s63, s63, 229376
  s_cmp_eq_u32 s63, 1605632
  s_cselect_b32 s63, 0, s63
  s_waitcnt vmcnt(5)
  s_mov_b32 exec_lo, 0xffff0000
  s_mov_b32 exec_hi, 0x0
  ds_write_b16 v135, v133
  s_mov_b64 exec, -1
  v_mov_b32 v10, 13
  ds_write_b32 v12, v10 offset:0
Lp12:
  ds_read_b128 v[136:139], v11 offset:16
  s_waitcnt lgkmcnt(0)
  v_min_u32 v140, v136, v137
  v_min3_u32 v140, v140, v138, v139
  s_nop 0
  v_readfirstlane_b32 s58, v140
  s_cmp_ge_u32 s58, 4
  s_cbranch_scc1 Ld13
  s_sleep 1
  s_sub_u32 s54, s54, 1
  s_cmp_gt_i32 s54, 0
  s_cbranch_scc1 Lp12
Ld13:
  s_add_u32 m0, s61, 0x14000
  s_nop 0
  buffer_load_dwordx4 v130, s[36:39], s63 offen lds
  s_add_u32 s55, s63, 28672
  s_add_u32 m0, s61, 0x14400
  s_nop 0
  buffer_load_dwordx4 v130, s[36:39], s55 offen lds
  s_add_u32 m0, s61, 0x16000
  s_nop 0
  buffer_load_dwordx4 v131, s[40:43], s63 offen lds
  s_add_u32 s55, s63, 28672
  s_add_u32 m0, s61, 0x16400
  s_nop 0
  buffer_load_dwordx4 v131, s[40:43], s55 offen lds
  s_add_u32 s63, s63, 229376
  s_cmp_eq_u32 s63, 1605632
  s_cselect_b32 s63, 0, s63
  s_waitcnt vmcnt(8)
  s_mov_b32 exec_lo, 0x0
  s_mov_b32 exec_hi, 0xffff
  ds_write_b16 v135, v133
  s_mov_b64 exec, -1
  v_mov_b32 v10, 14
  ds_write_b32 v12, v10 offset:0
Lp14:
  ds_read_b128 v[136:139], v11 offset:16
  s_waitcnt lgkmcnt(0)
  v_min_u32 v140, v136, v137
  v_min3_u32 v140, v140, v138, v139
  s_nop 0
  v_readfirstlane_b32 s58, v140
  s_cmp_ge_u32 s58, 6
  s_cbranch_scc1 Ld15
  s_sleep 1
  s_sub_u32 s54, s54, 1
  s_cmp_gt_i32 s54, 0
  s_cbranch_scc1 Lp14
Ld15:
  s_add_u32 m0, s61, 0x18000
  s_nop 0
  buffer_load_dwordx4 v130, s[36:39], s63 offen lds
  s_add_u32 s55, s63, 28672
  s_add_u32 m0, s61, 0x18400
  s_nop 0
  buffer_load_dwordx4 v130, s[36:39], s55 offen lds
  s_add_u32 m0, s61, 0x1a000
  s_nop 0
  buffer_load_dwordx4 v131, s[40:43], s63 offen lds
  s_add_u32 s55, s63, 28672
  s_add_u32 m0, s61, 0x1a400
  s_nop 0
  buffer_load_dwordx4 v131, s[40:43], s55 offen lds
  s_add_u32 s63, s63, 229376
  s_cmp_eq_u32 s63, 1605632
  s_cselect_b32 s63, 0, s63
  s_waitcnt vmcnt(8)
  v_mov_b32 v10, 15
  ds_write_b32 v12, v10 offset:0
  s_add_u32 m0, s61, 0x0
  s_nop 0
  buffer_load_dwordx4 v130, s[36:39], s63 offen lds
  s_add_u32 s55, s63, 28672
  s_add_u32 m0, s61, 0x400
  s_nop 0
  buffer_load_dwordx4 v130, s[36:39], s55 offen lds
  s_add_u32 m0, s61, 0x2000
  s_nop 0
  buffer_load_dwordx4 v131, s[40:43], s63 offen lds
  s_add_u32 s55, s63, 28672
  s_add_u32 m0, s61, 0x2400
  s_nop 0
  buffer_load_dwordx4 v131, s[40:43], s55 offen lds
  s_add_u32 s63, s63, 229376
  s_cmp_eq_u32 s63, 1605632
  s_cselect_b32 s63, 0, s63
  s_waitcnt vmcnt(8)
  v_mov_b32 v10, 16
  ds_write_b32 v12, v10 offset:0
  s_add_u32 m0, s61, 0x4000
  s_nop 0
  buffer_load_dwordx4 v130, s[36:39], s63 offen lds
  s_add_u32 s55, s63, 28672
  s_add_u32 m0, s61, 0x4400
  s_nop 0
  buffer_load_dwordx4 v130, s[36:39], s55 offen lds
  s_add_u32 m0, s61, 0x6000
  s_nop 0
  buffer_load_dwordx4 v131, s[40:43], s63 offen lds
  s_add_u32 s55, s63, 28672
  s_add_u32 m0, s61, 0x6400
  s_nop 0
  buffer_load_dwordx4 v131, s[40:43], s55 offen lds
  s_add_u32 s63, s63, 229376
  s_cmp_eq_u32 s63, 1605632
  s_cselect_b32 s63, 0, s63
  s_waitcnt vmcnt(8)
  v_mov_b32 v10, 17
  ds_write_b32 v12, v10 offset:0
  s_add_u32 m0, s61, 0x8000
  s_nop 0
  buffer_load_dwordx4 v130, s[36:39], s63 offen lds
  s_add_u32 s55, s63, 28672
  s_add_u32 m0, s61, 0x8400
  s_nop 0
  buffer_load_dwordx4 v130, s[36:39], s55 offen lds
  s_add_u32 m0, s61, 0xa000
  s_nop 0
  buffer_load_dwordx4 v131, s[40:43], s63 offen lds
  s_add_u32 s55, s63, 28672
  s_add_u32 m0, s61, 0xa400
  s_nop 0
  buffer_load_dwordx4 v131, s[40:43], s55 offen lds
  s_add_u32 s63, s63, 229376
  s_cmp_eq_u32 s63, 1605632
  s_cselect_b32 s63, 0, s63
  s_waitcnt vmcnt(8)
  v_mov_b32 v10, 18
  ds_write_b32 v12, v10 offset:0
  s_add_u32 m0, s61, 0xc000
  s_nop 0
  buffer_load_dwordx4 v130, s[36:39], s63 offen lds
  s_add_u32 s55, s63, 28672
  s_add_u32 m0, s61, 0xc400
  s_nop 0
  buffer_load_dwordx4 v130, s[36:39], s55 offen lds
  s_add_u32 m0, s61, 0xe000
  s_nop 0
  buffer_load_dwordx4 v131, s[40:43], s63 offen lds
  s_add_u32 s55, s63, 28672
  s_add_u32 m0, s61, 0xe400
  s_nop 0
  buffer_load_dwordx4 v131, s[40:43], s55 offen lds
  s_add_u32 s63, s63, 229376
  s_cmp_eq_u32 s63, 1605632
  s_cselect_b32 s63, 0, s63
  s_waitcnt vmcnt(8)
  v_mov_b32 v10, 19
  ds_write_b32 v12, v10 offset:0
  s_waitcnt vmcnt(4)
  v_mov_b32 v10, 20
  ds_write_b32 v12, v10 offset:0
  s_waitcnt vmcnt(0)
  v_mov_b32 v10, 21
  ds_write_b32 v12, v10 offset:0
Lp16:
  ds_read_b128 v[136:139], v11 offset:32
  s_waitcnt lgkmcnt(0)
  v_min_u32 v140, v136, v137
  v_min3_u32 v140, v140, v138, v139
  s_nop 0
  v_readfirstlane_b32 s58, v140
  s_cmp_ge_u32 s58, 1
  s_cbranch_scc1 Ld17
  s_sleep 1
  s_sub_u32 s54, s54, 1
  s_cmp_gt_i32 s54, 0
  s_cbranch_scc1 Lp16
Ld17:
  ds_read_b128 v[32:35], v24 offset:0
  ds_read_b128 v[36:39], v24 offset:1024
  ds_read_b128 v[40:43], v25 offset:0
  ds_read_b128 v[44:47], v25 offset:1024
  ds_read_b128 v[48:51], v26 offset:0
  ds_read_b128 v[52:55], v26 offset:1024
  ds_read_b128 v[56:59], v27 offset:0
  ds_read_b128 v[60:63], v27 offset:1024
  ds_read_b32 v23, v23
  v_mov_b32 v4, 1
  ds_write_b32 v12, v4 offset:48
Lg18:
  buffer_load_dword v3, v29, s[28:31], 0 offen sc1
  s_waitcnt vmcnt(0)
  v_cmp_le_u32 vcc, 1, v3
  s_nop 1
  s_cmp_eq_u64 vcc, exec
  s_cbranch_scc1 Le19
  s_sleep 2
  s_sub_u32 s54, s54, 1
  s_cmp_gt_i32 s54, 0
  s_cbranch_scc1 Lg18
Le19:
f_attn_main:
  s_mov_b32 s9, s16
  s_add_u32 s10, s8, s9
  buffer_load_dwordx2 v[176:177], v28, s[28:31], s10 offen offset:0 sc1
  buffer_load_dwordx2 v[178:179], v28, s[28:31], s10 offen offset:512 sc1
  buffer_load_dwordx2 v[180:181], v28, s[28:31], s10 offen offset:1024 sc1
  s_mov_b32 exec_hi, 0
  buffer_load_dwordx2 v[182:183], v28, s[28:31], s10 offen offset:1536 sc1
  s_mov_b64 exec, s[20:21]
  buffer_load_dwordx4 v[208:211], v31, s[28:31], s10 offen offset:1792 sc1
  buffer_load_dwordx4 v[212:215], v31, s[28:31], s10 offen offset:2688 sc1
  s_mov_b64 exec, -1
  s_add_u32 s9, s9, 3584
  s_cmp_eq_u32 s9, 57344
  s_cselect_b32 s9, 0, s9
  s_add_u32 s10, s8, s9
  buffer_load_dwordx2 v[184:185], v28, s[28:31], s10 offen offset:0 sc1
  buffer_load_dwordx2 v[186:187], v28, s[28:31], s10 offen offset:512 sc1
  buffer_load_dwordx2 v[188:189], v28, s[28:31], s10 offen offset:1024 sc1
  s_mov_b32 exec_hi, 0
  buffer_load_dwordx2 v[190:191], v28, s[28:31], s10 offen offset:1536 sc1
  s_mov_b64 exec, s[20:21]
  buffer_load_dwordx4 v[216:219], v31, s[28:31], s10 offen offset:1792 sc1
  buffer_load_dwordx4 v[220:223], v31, s[28:31], s10 offen offset:2688 sc1
  s_mov_b64 exec, -1
  s_add_u32 s9, s9, 3584
  s_cmp_eq_u32 s9, 57344
  s_cselect_b32 s9, 0, s9
  s_add_u32 s10, s8, s9
  s_waitcnt lgkmcnt(0)
  s_waitcnt vmcnt(8)
  v_mfma_f32_32x32x16_bf16 v[128:143], v[176:179], v[32:35], 0
  v_mfma_f32_32x32x16_bf16 v[128:143], v[180:183], v[36:39], v[128:143]
  s_nop 7
  s_nop 3
  s_setprio 3
  v_mfma_f32_32x32x16_bf16 v[144:159], v[176:179], v[40:43], 0
  s_setprio 1
  v_exp_f32 v128, v128
  v_exp_f32 v129, v129
  v_exp_f32 v130, v130
  v_exp_f32 v131, v131
  s_setprio 3
  v_mfma_f32_32x32x16_bf16 v[144:159], v[180:183], v[44:47], v[144:159]
  s_setprio 1
  v_exp_f32 v132, v132
  v_exp_f32 v133, v133
  v_exp_f32 v134, v134
  v_exp_f32 v135, v135
  v_exp_f32 v136, v136
  v_exp_f32 v137, v137
  v_exp_f32 v138, v138
  v_exp_f32 v139, v139
  v_exp_f32 v140, v140
  v_exp_f32 v141, v141
  v_exp_f32 v142, v142
  v_exp_f32 v143, v143
  v_cvt_pk_bf16_f32 v160, v128, v129
  v_cvt_pk_bf16_f32 v161, v130, v131
  v_cvt_pk_bf16_f32 v162, v132, v133
  v_cvt_pk_bf16_f32 v163, v134, v135
  v_cvt_pk_bf16_f32 v164, v136, v137
  v_cvt_pk_bf16_f32 v165, v138, v139
  v_cvt_pk_bf16_f32 v166, v140, v141
  v_cvt_pk_bf16_f32 v167, v142, v143
  buffer_load_dwordx2 v[192:193], v28, s[28:31], s10 offen offset:0 sc1
  buffer_load_dwordx2 v[194:195], v28, s[28:31], s10 offen offset:512 sc1
  buffer_load_dwordx2 v[196:197], v28, s[28:31], s10 offen offset:1024 sc1
  s_mov_b32 exec_hi, 0
  buffer_load_dwordx2 v[198:199], v28, s[28:31], s10 offen offset:1536 sc1
  s_mov_b64 exec, s[20:21]
  buffer_load_dwordx4 v[224:227], v31, s[28:31], s10 offen offset:1792 sc1
  buffer_load_dwordx4 v[228:231], v31, s[28:31], s10 offen offset:2688 sc1
  s_mov_b64 exec, -1
  s_add_u32 s9, s9, 3584
  s_cmp_eq_u32 s9, 57344
  s_cselect_b32 s9, 0, s9
  s_add_u32 s10, s8, s9
  s_waitcnt vmcnt(12)
  s_setprio 3
  v_mfma_f32_32x32x16_bf16 v[128:143], v[176:179], v[48:51], 0
  s_setprio 1
  v_exp_f32 v144, v144
  v_exp_f32 v145, v145
  v_exp_f32 v146, v146
  v_exp_f32 v147, v147
  s_setprio 3
  v_mfma_f32_32x32x16_bf16 v[128:143], v[180:183], v[52:55], v[128:143]
  s_setprio 1
  v_exp_f32 v148, v148
  v_exp_f32 v149, v149
  v_exp_f32 v150, v150
  v_exp_f32 v151, v151
  s_setprio 3
  v_mfma_f32_32x32x16_bf16 v[64:79], v[208:211], v[160:163], 0
  s_setprio 1
  v_exp_f32 v152, v152
  v_exp_f32 v153, v153
  v_exp_f32 v154, v154
  v_exp_f32 v155, v155
  s_setprio 3
  v_mfma_f32_32x32x16_bf16 v[64:79], v[212:215], v[164:167], v[64:79]
  s_setprio 1
  v_exp_f32 v156, v156
  v_exp_f32 v157, v157
  v_exp_f32 v158, v158
  v_exp_f32 v159, v159
  v_cvt_pk_bf16_f32 v168, v144, v145
  v_cvt_pk_bf16_f32 v169, v146, v147
  v_cvt_pk_bf16_f32 v170, v148, v149
  v_cvt_pk_bf16_f32 v171, v150, v151
  v_cvt_pk_bf16_f32 v172, v152, v153
  v_cvt_pk_bf16_f32 v173, v154, v155
  v_cvt_pk_bf16_f32 v174, v156, v157
  v_cvt_pk_bf16_f32 v175, v158, v159
  buffer_load_dwordx2 v[200:201], v28, s[28:31], s10 offen offset:0 sc1
  buffer_load_dwordx2 v[202:203], v28, s[28:31], s10 offen offset:512 sc1
  buffer_load_dwordx2 v[204:205], v28, s[28:31], s10 offen offset:1024 sc1
  s_mov_b32 exec_hi, 0
  buffer_load_dwordx2 v[206:207], v28, s[28:31], s10 offen offset:1536 sc1
  s_mov_b64 exec, s[20:21]
  buffer_load_dwordx4 v[232:235], v31, s[28:31], s10 offen offset:1792 sc1
  buffer_load_dwordx4 v[236:239], v31, s[28:31], s10 offen offset:2688 sc1
  s_mov_b64 exec, -1
  s_add_u32 s9, s9, 3584
  s_cmp_eq_u32 s9, 57344
  s_cselect_b32 s9, 0, s9
  s_add_u32 s10, s8, s9
  s_setprio 3
  v_mfma_f32_32x32x16_bf16 v[144:159], v[176:179], v[56:59], 0
  s_setprio 1
  v_exp_f32 v128, v128
  v_exp_f32 v129, v129
  v_exp_f32 v130, v130
  v_exp_f32 v131, v131
  s_setprio 3
  v_mfma_f32_32x32x16_bf16 v[144:159], v[180:183], v[60:63], v[144:159]
  s_setprio 1
  v_exp_f32 v132, v132
  v_exp_f32 v133, v133
  v_exp_f32 v134, v134
  v_exp_f32 v135, v135
  s_setprio 3
  v_mfma_f32_32x32x16_bf16 v[80:95], v[208:211], v[168:171], 0
  s_setprio 1
  v_exp_f32 v136, v136
  v_exp_f32 v137, v137
  v_exp_f32 v138, v138
  v_exp_f32 v139, v139
  s_setprio 3
  v_mfma_f32_32x32x16_bf16 v[80:95], v[212:215], v[172:175], v[80:95]
  s_setprio 1
  v_exp_f32 v140, v140
  v_exp_f32 v141, v141
  v_exp_f32 v142, v142
  v_exp_f32 v143, v143
  v_cvt_pk_bf16_f32 v160, v128, v129
  v_cvt_pk_bf16_f32 v161, v130, v131
  v_cvt_pk_bf16_f32 v162, v132, v133
  v_cvt_pk_bf16_f32 v163, v134, v135
  v_cvt_pk_bf16_f32 v164, v136, v137
  v_cvt_pk_bf16_f32 v165, v138, v139
  v_cvt_pk_bf16_f32 v166, v140, v141
  v_cvt_pk_bf16_f32 v167, v142, v143
  s_waitcnt vmcnt(14)
  s_setprio 3
  v_mfma_f32_32x32x16_bf16 v[128:143], v[184:187], v[32:35], 0
  s_setprio 1
  v_exp_f32 v144, v144
  v_exp_f32 v145, v145
  v_exp_f32 v146, v146
  v_exp_f32 v147, v147
  s_setprio 3
  v_mfma_f32_32x32x16_bf16 v[128:143], v[188:191], v[36:39], v[128:143]
  s_setprio 1
  v_exp_f32 v148, v148
  v_exp_f32 v149, v149
  v_exp_f32 v150, v150
  v_exp_f32 v151, v151
  s_setprio 3
  v_mfma_f32_32x32x16_bf16 v[96:111], v[208:211], v[160:163], 0
  s_setprio 1
  v_exp_f32 v152, v152
  v_exp_f32 v153, v153
  v_exp_f32 v154, v154
  v_exp_f32 v155, v155
  s_setprio 3
  v_mfma_f32_32x32x16_bf16 v[96:111], v[212:215], v[164:167], v[96:111]
  s_setprio 1
  v_exp_f32 v156, v156
  v_exp_f32 v157, v157
  v_exp_f32 v158, v158
  v_exp_f32 v159, v159
  v_cvt_pk_bf16_f32 v168, v144, v145
  v_cvt_pk_bf16_f32 v169, v146, v147
  v_cvt_pk_bf16_f32 v170, v148, v149
  v_cvt_pk_bf16_f32 v171, v150, v151
  v_cvt_pk_bf16_f32 v172, v152, v153
  v_cvt_pk_bf16_f32 v173, v154, v155
  v_cvt_pk_bf16_f32 v174, v156, v157
  v_cvt_pk_bf16_f32 v175, v158, v159
  s_setprio 3
  v_mfma_f32_32x32x16_bf16 v[144:159], v[184:187], v[40:43], 0
  s_setprio 1
  v_exp_f32 v128, v128
  v_exp_f32 v129, v129
  v_exp_f32 v130, v130
  v_exp_f32 v131, v131
  s_setprio 3
  v_mfma_f32_32x32x16_bf16 v[144:159], v[188:191], v[44:47], v[144:159]
  s_setprio 1
  v_exp_f32 v132, v132
  v_exp_f32 v133, v133
  v_exp_f32 v134, v134
  v_exp_f32 v135, v135
  s_setprio 3
  v_mfma_f32_32x32x16_bf16 v[112:127], v[208:211], v[168:171], 0
  s_setprio 1
  v_exp_f32 v136, v136
  v_exp_f32 v137, v137
  v_exp_f32 v138, v138
  v_exp_f32 v139, v139
  s_setprio 3
  v_mfma_f32_32x32x16_bf16 v[112:127], v[212:215], v[172:175], v[112:127]
  s_setprio 1
  v_exp_f32 v140, v140
  v_exp_f32 v141, v141
  v_exp_f32 v142, v142
  v_exp_f32 v143, v143
  v_cvt_pk_bf16_f32 v160, v128, v129
  v_cvt_pk_bf16_f32 v161, v130, v131
  v_cvt_pk_bf16_f32 v162, v132, v133
  v_cvt_pk_bf16_f32 v163, v134, v135
  v_cvt_pk_bf16_f32 v164, v136, v137
  v_cvt_pk_bf16_f32 v165, v138, v139
  v_cvt_pk_bf16_f32 v166, v140, v141
  v_cvt_pk_bf16_f32 v167, v142, v143
  s_waitcnt vmcnt(12)
  s_setprio 3
  v_mfma_f32_32x32x16_bf16 v[128:143], v[184:187], v[48:51], 0
  s_setprio 1
  v_exp_f32 v144, v144
  v_exp_f32 v145, v145
  v_exp_f32 v146, v146
  v_exp_f32 v147, v147
  s_setprio 3
  v_mfma_f32_32x32x16_bf16 v[128:143], v[188:191], v[52:55], v[128:143]
  s_setprio 1
  v_exp_f32 v148, v148
  v_exp_f32 v149, v149
  v_exp_f32 v150, v150
  v_exp_f32 v151, v151
  s_setprio 3
  v_mfma_f32_32x32x16_bf16 v[64:79], v[216:219], v[160:163], v[64:79]
  s_setprio 1
  v_exp_f32 v152, v152
  v_exp_f32 v153, v153
  v_exp_f32 v154, v154
  v_exp_f32 v155, v155
  s_setprio 3
  v_mfma_f32_32x32x16_bf16 v[64:79], v[220:223], v[164:167], v[64:79]
  s_setprio 1
  v_exp_f32 v156, v156
  v_exp_f32 v157, v157
  v_exp_f32 v158, v158
  v_exp_f32 v159, v159
  v_cvt_pk_bf16_f32 v168, v144, v145
  v_cvt_pk_bf16_f32 v169, v146, v147
  v_cvt_pk_bf16_f32 v170, v148, v149
  v_cvt_pk_bf16_f32 v171, v150, v151
  v_cvt_pk_bf16_f32 v172, v152, v153
  v_cvt_pk_bf16_f32 v173, v154, v155
  v_cvt_pk_bf16_f32 v174, v156, v157
  v_cvt_pk_bf16_f32 v175, v158, v159
  buffer_load_dwordx2 v[176:177], v28, s[28:31], s10 offen offset:0 sc1
  buffer_load_dwordx2 v[178:179], v28, s[28:31], s10 offen offset:512 sc1
  buffer_load_dwordx2 v[180:181], v28, s[28:31], s10 offen offset:1024 sc1
  s_mov_b32 exec_hi, 0
  buffer_load_dwordx2 v[182:183], v28, s[28:31], s10 offen offset:1536 sc1
  s_mov_b64 exec, s[20:21]
  buffer_load_dwordx4 v[208:211], v31, s[28:31], s10 offen offset:1792 sc1
  buffer_load_dwordx4 v[212:215], v31, s[28:31], s10 offen offset:2688 sc1
  s_mov_b64 exec, -1
  s_add_u32 s9, s9, 3584
  s_cmp_eq_u32 s9, 57344
  s_cselect_b32 s9, 0, s9
  s_add_u32 s10, s8, s9
  s_setprio 3
  v_mfma_f32_32x32x16_bf16 v[144:159], v[184:187], v[56:59], 0
  s_setprio 1
  v_exp_f32 v128, v128
  v_exp_f32 v129, v129
  v_exp_f32 v130, v130
  v_exp_f32 v131, v131
  s_setprio 3
  v_mfma_f32_32x32x16_bf16 v[144:159], v[188:191], v[60:63], v[144:159]
  s_setprio 1
  v_exp_f32 v132, v132
  v_exp_f32 v133, v133
  v_exp_f32 v134, v134
  v_exp_f32 v135, v135
  s_setprio 3
  v_mfma_f32_32x32x16_bf16 v[80:95], v[216:219], v[168:171], v[80:95]
  s_setprio 1
  v_exp_f32 v136, v136
  v_exp_f32 v137, v137
  v_exp_f32 v138, v138
  v_exp_f32 v139, v139
  s_setprio 3
  v_mfma_f32_32x32x16_bf16 v[80:95], v[220:223], v[172:175], v[80:95]
  s_setprio 1
  v_exp_f32 v140, v140
  v_exp_f32 v141, v141
  v_exp_f32 v142, v142
  v_exp_f32 v143, v143
  v_cvt_pk_bf16_f32 v160, v128, v129
  v_cvt_pk_bf16_f32 v161, v130, v131
  v_cvt_pk_bf16_f32 v162, v132, v133
  v_cvt_pk_bf16_f32 v163, v134, v135
  v_cvt_pk_bf16_f32 v164, v136, v137
  v_cvt_pk_bf16_f32 v165, v138, v139
  v_cvt_pk_bf16_f32 v166, v140, v141
  v_cvt_pk_bf16_f32 v167, v142, v143
  s_waitcnt vmcnt(14)
  s_setprio 3
  v_mfma_f32_32x32x16_bf16 v[128:143], v[192:195], v[32:35], 0
  s_setprio 1
  v_exp_f32 v144, v144
  v_exp_f32 v145, v145
  v_exp_f32 v146, v146
  v_exp_f32 v147, v147
  s_setprio 3
  v_mfma_f32_32x32x16_bf16 v[128:143], v[196:199], v[36:39], v[128:143]
  s_setprio 1
  v_exp_f32 v148, v148
  v_exp_f32 v149, v149
  v_exp_f32 v150, v150
  v_exp_f32 v151, v151
  s_setprio 3
  v_mfma_f32_32x32x16_bf16 v[96:111], v[216:219], v[160:163], v[96:111]
  s_setprio 1
  v_exp_f32 v152, v152
  v_exp_f32 v153, v153
  v_exp_f32 v154, v154
  v_exp_f32 v155, v155
  s_setprio 3
  v_mfma_f32_32x32x16_bf16 v[96:111], v[220:223], v[164:167], v[96:111]
  s_setprio 1
  v_exp_f32 v156, v156
  v_exp_f32 v157, v157
  v_exp_f32 v158, v158
  v_exp_f32 v159, v159
  v_cvt_pk_bf16_f32 v168, v144, v145
  v_cvt_pk_bf16_f32 v169, v146, v147
  v_cvt_pk_bf16_f32 v170, v148, v149
  v_cvt_pk_bf16_f32 v171, v150, v151
  v_cvt_pk_bf16_f32 v172, v152, v153
  v_cvt_pk_bf16_f32 v173, v154, v155
  v_cvt_pk_bf16_f32 v174, v156, v157
  v_cvt_pk_bf16_f32 v175, v158, v159
  s_setprio 3
  v_mfma_f32_32x32x16_bf16 v[144:159], v[192:195], v[40:43], 0
  s_setprio 1
  v_exp_f32 v128, v128
  v_exp_f32 v129, v129
  v_exp_f32 v130, v130
  v_exp_f32 v131, v131
  s_setprio 3
  v_mfma_f32_32x32x16_bf16 v[144:159], v[196:199], v[44:47], v[144:159]
  s_setprio 1
  v_exp_f32 v132, v132
  v_exp_f32 v133, v133
  v_exp_f32 v134, v134
  v_exp_f32 v135, v135
  s_setprio 3
  v_mfma_f32_32x32x16_bf16 v[112:127], v[216:219], v[168:171], v[112:127]
  s_setprio 1
  v_exp_f32 v136, v136
  v_exp_f32 v137, v137
  v_exp_f32 v138, v138
  v_exp_f32 v139, v139
  s_setprio 3
  v_mfma_f32_32x32x16_bf16 v[112:127], v[220:223], v[172:175], v[112:127]
  s_setprio 1
  v_exp_f32 v140, v140
  v_exp_f32 v141, v141
  v_exp_f32 v142, v142
  v_exp_f32 v143, v143
  v_cvt_pk_bf16_f32 v160, v128, v129
  v_cvt_pk_bf16_f32 v161, v130, v131
  v_cvt_pk_bf16_f32 v162, v132, v133
  v_cvt_pk_bf16_f32 v163, v134, v135
  v_cvt_pk_bf16_f32 v164, v136, v137
  v_cvt_pk_bf16_f32 v165, v138, v139
  v_cvt_pk_bf16_f32 v166, v140, v141
  v_cvt_pk_bf16_f32 v167, v142, v143
  s_waitcnt vmcnt(12)
  s_setprio 3
  v_mfma_f32_32x32x16_bf16 v[128:143], v[192:195], v[48:51], 0
  s_setprio 1
  v_exp_f32 v144, v144
  v_exp_f32 v145, v145
  v_exp_f32 v146, v146
  v_exp_f32 v147, v147
  s_setprio 3
  v_mfma_f32_32x32x16_bf16 v[128:143], v[196:199], v[52:55], v[128:143]
  s_setprio 1
  v_exp_f32 v148, v148
  v_exp_f32 v149, v149
  v_exp_f32 v150, v150
  v_exp_f32 v151, v151
  s_setprio 3
  v_mfma_f32_32x32x16_bf16 v[64:79], v[224:227], v[160:163], v[64:79]
  s_setprio 1
  v_exp_f32 v152, v152
  v_exp_f32 v153, v153
  v_exp_f32 v154, v154
  v_exp_f32 v155, v155
  s_setprio 3
  v_mfma_f32_32x32x16_bf16 v[64:79], v[228:231], v[164:167], v[64:79]
  s_setprio 1
  v_exp_f32 v156, v156
  v_exp_f32 v157, v157
  v_exp_f32 v158, v158
  v_exp_f32 v159, v159
  v_cvt_pk_bf16_f32 v168, v144, v145
  v_cvt_pk_bf16_f32 v169, v146, v147
  v_cvt_pk_bf16_f32 v170, v148, v149
  v_cvt_pk_bf16_f32 v171, v150, v151
  v_cvt_pk_bf16_f32 v172, v152, v153
  v_cvt_pk_bf16_f32 v173, v154, v155
  v_cvt_pk_bf16_f32 v174, v156, v157
  v_cvt_pk_bf16_f32 v175, v158, v159
  buffer_load_dwordx2 v[184:185], v28, s[28:31], s10 offen offset:0 sc1
  buffer_load_dwordx2 v[186:187], v28, s[28:31], s10 offen offset:512 sc1
  buffer_load_dwordx2 v[188:189], v28, s[28:31], s10 offen offset:1024 sc1
  s_mov_b32 exec_hi, 0
  buffer_load_dwordx2 v[190:191], v28, s[28:31], s10 offen offset:1536 sc1
  s_mov_b64 exec, s[20:21]
  buffer_load_dwordx4 v[216:219], v31, s[28:31], s10 offen offset:1792 sc1
  buffer_load_dwordx4 v[220:223], v31, s[28:31], s10 offen offset:2688 sc1
  s_mov_b64 exec, -1
  s_add_u32 s9, s9, 3584
  s_cmp_eq_u32 s9, 57344
  s_cselect_b32 s9, 0, s9
  s_add_u32 s10, s8, s9
  s_setprio 3
  v_mfma_f32_32x32x16_bf16 v[144:159], v[192:195], v[56:59], 0
  s_setprio 1
  v_exp_f32 v128, v128
  v_exp_f32 v129, v129
  v_exp_f32 v130, v130
  v_exp_f32 v131, v131
  s_setprio 3
  v_mfma_f32_32x32x16_bf16 v[144:159], v[196:199], v[60:63], v[144:159]
  s_setprio 1
  v_exp_f32 v132, v132
  v_exp_f32 v133, v133
  v_exp_f32 v134, v134
  v_exp_f32 v135, v135
  s_setprio 3
  v_mfma_f32_32x32x16_bf16 v[80:95], v[224:227], v[168:171], v[80:95]
  s_setprio 1
  v_exp_f32 v136, v136
  v_exp_f32 v137, v137
  v_exp_f32 v138, v138
  v_exp_f32 v139, v139
  s_setprio 3
  v_mfma_f32_32x32x16_bf16 v[80:95], v[228:231], v[172:175], v[80:95]
  s_setprio 1
  v_exp_f32 v140, v140
  v_exp_f32 v141, v141
  v_exp_f32 v142, v142
  v_exp_f32 v143, v143
  v_cvt_pk_bf16_f32 v160, v128, v129
  v_cvt_pk_bf16_f32 v161, v130, v131
  v_cvt_pk_bf16_f32 v162, v132, v133
  v_cvt_pk_bf16_f32 v163, v134, v135
  v_cvt_pk_bf16_f32 v164, v136, v137
  v_cvt_pk_bf16_f32 v165, v138, v139
  v_cvt_pk_bf16_f32 v166, v140, v141
  v_cvt_pk_bf16_f32 v167, v142, v143
  s_waitcnt vmcnt(14)
  s_setprio 3
  v_mfma_f32_32x32x16_bf16 v[128:143], v[200:203], v[32:35], 0
  s_setprio 1
  v_exp_f32 v144, v144
  v_exp_f32 v145, v145
  v_exp_f32 v146, v146
  v_exp_f32 v147, v147
  s_setprio 3
  v_mfma_f32_32x32x16_bf16 v[128:143], v[204:207], v[36:39], v[128:143]
  s_setprio 1
  v_exp_f32 v148, v148
  v_exp_f32 v149, v149
  v_exp_f32 v150, v150
  v_exp_f32 v151, v151
  s_setprio 3
  v_mfma_f32_32x32x16_bf16 v[96:111], v[224:227], v[160:163], v[96:111]
  s_setprio 1
  v_exp_f32 v152, v152
  v_exp_f32 v153, v153
  v_exp_f32 v154, v154
  v_exp_f32 v155, v155
  s_setprio 3
  v_mfma_f32_32x32x16_bf16 v[96:111], v[228:231], v[164:167], v[96:111]
  s_setprio 1
  v_exp_f32 v156, v156
  v_exp_f32 v157, v157
  v_exp_f32 v158, v158
  v_exp_f32 v159, v159
  v_cvt_pk_bf16_f32 v168, v144, v145
  v_cvt_pk_bf16_f32 v169, v146, v147
  v_cvt_pk_bf16_f32 v170, v148, v149
  v_cvt_pk_bf16_f32 v171, v150, v151
  v_cvt_pk_bf16_f32 v172, v152, v153
  v_cvt_pk_bf16_f32 v173, v154, v155
  v_cvt_pk_bf16_f32 v174, v156, v157
  v_cvt_pk_bf16_f32 v175, v158, v159
  s_setprio 3
  v_mfma_f32_32x32x16_bf16 v[144:159], v[200:203], v[40:43], 0
  s_setprio 1
  v_exp_f32 v128, v128
  v_exp_f32 v129, v129
  v_exp_f32 v130, v130
  v_exp_f32 v131, v131
  s_setprio 3
  v_mfma_f32_32x32x16_bf16 v[144:159], v[204:207], v[44:47], v[144:159]
  s_setprio 1
  v_exp_f32 v132, v132
  v_exp_f32 v133, v133
  v_exp_f32 v134, v134
  v_exp_f32 v135, v135
  s_setprio 3
  v_mfma_f32_32x32x16_bf16 v[112:127], v[224:227], v[168:171], v[112:127]
  s_setprio 1
  v_exp_f32 v136, v136
  v_exp_f32 v137, v137
  v_exp_f32 v138, v138
  v_exp_f32 v139, v139
  s_setprio 3
  v_mfma_f32_32x32x16_bf16 v[112:127], v[228:231], v[172:175], v[112:127]
  s_setprio 1
  v_exp_f32 v140, v140
  v_exp_f32 v141, v141
  v_exp_f32 v142, v142
  v_exp_f32 v143, v143
  v_cvt_pk_bf16_f32 v160, v128, v129
  v_cvt_pk_bf16_f32 v161, v130, v131
  v_cvt_pk_bf16_f32 v162, v132, v133
  v_cvt_pk_bf16_f32 v163, v134, v135
  v_cvt_pk_bf16_f32 v164, v136, v137
  v_cvt_pk_bf16_f32 v165, v138, v139
  v_cvt_pk_bf16_f32 v166, v140, v141
  v_cvt_pk_bf16_f32 v167, v142, v143
  s_waitcnt vmcnt(12)
  s_setprio 3
  v_mfma_f32_32x32x16_bf16 v[128:143], v[200:203], v[48:51], 0
  s_setprio 1
  v_exp_f32 v144, v144
  v_exp_f32 v145, v145
  v_exp_f32 v146, v146
  v_exp_f32 v147, v147
  s_setprio 3
  v_mfma_f32_32x32x16_bf16 v[128:143], v[204:207], v[52:55], v[128:143]
  s_setprio 1
  v_exp_f32 v148, v148
  v_exp_f32 v149, v149
  v_exp_f32 v150, v150
  v_exp_f32 v151, v151
  s_setprio 3
  v_mfma_f32_32x32x16_bf16 v[64:79], v[232:235], v[160:163], v[64:79]
  s_setprio 1
  v_exp_f32 v152, v152
  v_exp_f32 v153, v153
  v_exp_f32 v154, v154
  v_exp_f32 v155, v155
  s_setprio 3
  v_mfma_f32_32x32x16_bf16 v[64:79], v[236:239], v[164:167], v[64:79]
  s_setprio 1
  v_exp_f32 v156, v156
  v_exp_f32 v157, v157
  v_exp_f32 v158, v158
  v_exp_f32 v159, v159
  v_cvt_pk_bf16_f32 v168, v144, v145
  v_cvt_pk_bf16_f32 v169, v146, v147
  v_cvt_pk_bf16_f32 v170, v148, v149
  v_cvt_pk_bf16_f32 v171, v150, v151
  v_cvt_pk_bf16_f32 v172, v152, v153
  v_cvt_pk_bf16_f32 v173, v154, v155
  v_cvt_pk_bf16_f32 v174, v156, v157
  v_cvt_pk_bf16_f32 v175, v158, v159
  buffer_load_dwordx2 v[192:193], v28, s[28:31], s10 offen offset:0 sc1
  buffer_load_dwordx2 v[194:195], v28, s[28:31], s10 offen offset:512 sc1
  buffer_load_dwordx2 v[196:197], v28, s[28:31], s10 offen offset:1024 sc1
  s_mov_b32 exec_hi, 0
  buffer_load_dwordx2 v[198:199], v28, s[28:31], s10 offen offset:1536 sc1
  s_mov_b64 exec, s[20:21]
  buffer_load_dwordx4 v[224:227], v31, s[28:31], s10 offen offset:1792 sc1
  buffer_load_dwordx4 v[228:231], v31, s[28:31], s10 offen offset:2688 sc1
  s_mov_b64 exec, -1
  s_add_u32 s9, s9, 3584
  s_cmp_eq_u32 s9, 57344
  s_cselect_b32 s9, 0, s9
  s_add_u32 s10, s8, s9
  s_setprio 3
  v_mfma_f32_32x32x16_bf16 v[144:159], v[200:203], v[56:59], 0
  s_setprio 1
  v_exp_f32 v128, v128
  v_exp_f32 v129, v129
  v_exp_f32 v130, v130
  v_exp_f32 v131, v131
  s_setprio 3
  v_mfma_f32_32x32x16_bf16 v[144:159], v[204:207], v[60:63], v[144:159]
  s_setprio 1
  v_exp_f32 v132, v132
  v_exp_f32 v133, v133
  v_exp_f32 v134, v134
  v_exp_f32 v135, v135
  s_setprio 3
  v_mfma_f32_32x32x16_bf16 v[80:95], v[232:235], v[168:171], v[80:95]
  s_setprio 1
  v_exp_f32 v136, v136
  v_exp_f32 v137, v137
  v_exp_f32 v138, v138
  v_exp_f32 v139, v139
  s_setprio 3
  v_mfma_f32_32x32x16_bf16 v[80:95], v[236:239], v[172:175], v[80:95]
  s_setprio 1
  v_exp_f32 v140, v140
  v_exp_f32 v141, v141
  v_exp_f32 v142, v142
  v_exp_f32 v143, v143
  v_cvt_pk_bf16_f32 v160, v128, v129
  v_cvt_pk_bf16_f32 v161, v130, v131
  v_cvt_pk_bf16_f32 v162, v132, v133
  v_cvt_pk_bf16_f32 v163, v134, v135
  v_cvt_pk_bf16_f32 v164, v136, v137
  v_cvt_pk_bf16_f32 v165, v138, v139
  v_cvt_pk_bf16_f32 v166, v140, v141
  v_cvt_pk_bf16_f32 v167, v142, v143
  s_waitcnt vmcnt(14)
  s_setprio 3
  v_mfma_f32_32x32x16_bf16 v[128:143], v[176:179], v[32:35], 0
  s_setprio 1
  v_exp_f32 v144, v144
  v_exp_f32 v145, v145
  v_exp_f32 v146, v146
  v_exp_f32 v147, v147
  s_setprio 3
  v_mfma_f32_32x32x16_bf16 v[128:143], v[180:183], v[36:39], v[128:143]
  s_setprio 1
  v_exp_f32 v148, v148
  v_exp_f32 v149, v149
  v_exp_f32 v150, v150
  v_exp_f32 v151, v151
  s_setprio 3
  v_mfma_f32_32x32x16_bf16 v[96:111], v[232:235], v[160:163], v[96:111]
  s_setprio 1
  v_exp_f32 v152, v152
  v_exp_f32 v153, v153
  v_exp_f32 v154, v154
  v_exp_f32 v155, v155
  s_setprio 3
  v_mfma_f32_32x32x16_bf16 v[96:111], v[236:239], v[164:167], v[96:111]
  s_setprio 1
  v_exp_f32 v156, v156
  v_exp_f32 v157, v157
  v_exp_f32 v158, v158
  v_exp_f32 v159, v159
  v_cvt_pk_bf16_f32 v168, v144, v145
  v_cvt_pk_bf16_f32 v169, v146, v147
  v_cvt_pk_bf16_f32 v170, v148, v149
  v_cvt_pk_bf16_f32 v171, v150, v151
  v_cvt_pk_bf16_f32 v172, v152, v153
  v_cvt_pk_bf16_f32 v173, v154, v155
  v_cvt_pk_bf16_f32 v174, v156, v157
  v_cvt_pk_bf16_f32 v175, v158, v159
  s_setprio 3
  v_mfma_f32_32x32x16_bf16 v[144:159], v[176:179], v[40:43], 0
  s_setprio 1
  v_exp_f32 v128, v128
  v_exp_f32 v129, v129
  v_exp_f32 v130, v130
  v_exp_f32 v131, v131
  s_setprio 3
  v_mfma_f32_32x32x16_bf16 v[144:159], v[180:183], v[44:47], v[144:159]
  s_setprio 1
  v_exp_f32 v132, v132
  v_exp_f32 v133, v133
  v_exp_f32 v134, v134
  v_exp_f32 v135, v135
  s_setprio 3
  v_mfma_f32_32x32x16_bf16 v[112:127], v[232:235], v[168:171], v[112:127]
  s_setprio 1
  v_exp_f32 v136, v136
  v_exp_f32 v137, v137
  v_exp_f32 v138, v138
  v_exp_f32 v139, v139
  s_setprio 3
  v_mfma_f32_32x32x16_bf16 v[112:127], v[236:239], v[172:175], v[112:127]
  s_setprio 1
  v_exp_f32 v140, v140
  v_exp_f32 v141, v141
  v_exp_f32 v142, v142
  v_exp_f32 v143, v143
  v_cvt_pk_bf16_f32 v160, v128, v129
  v_cvt_pk_bf16_f32 v161, v130, v131
  v_cvt_pk_bf16_f32 v162, v132, v133
  v_cvt_pk_bf16_f32 v163, v134, v135
  v_cvt_pk_bf16_f32 v164, v136, v137
  v_cvt_pk_bf16_f32 v165, v138, v139
  v_cvt_pk_bf16_f32 v166, v140, v141
  v_cvt_pk_bf16_f32 v167, v142, v143
  s_waitcnt vmcnt(12)
  s_setprio 3
  v_mfma_f32_32x32x16_bf16 v[128:143], v[176:179], v[48:51], 0
  s_setprio 1
  v_exp_f32 v144, v144
  v_exp_f32 v145, v145
  v_exp_f32 v146, v146
  v_exp_f32 v147, v147
  s_setprio 3
  v_mfma_f32_32x32x16_bf16 v[128:143], v[180:183], v[52:55], v[128:143]
  s_setprio 1
  v_exp_f32 v148, v148
  v_exp_f32 v149, v149
  v_exp_f32 v150, v150
  v_exp_f32 v151, v151
  s_setprio 3
  v_mfma_f32_32x32x16_bf16 v[64:79], v[208:211], v[160:163], v[64:79]
  s_setprio 1
  v_exp_f32 v152, v152
  v_exp_f32 v153, v153
  v_exp_f32 v154, v154
  v_exp_f32 v155, v155
  s_setprio 3
  v_mfma_f32_32x32x16_bf16 v[64:79], v[212:215], v[164:167], v[64:79]
  s_setprio 1
  v_exp_f32 v156, v156
  v_exp_f32 v157, v157
  v_exp_f32 v158, v158
  v_exp_f32 v159, v159
  v_cvt_pk_bf16_f32 v168, v144, v145
  v_cvt_pk_bf16_f32 v169, v146, v147
  v_cvt_pk_bf16_f32 v170, v148, v149
  v_cvt_pk_bf16_f32 v171, v150, v151
  v_cvt_pk_bf16_f32 v172, v152, v153
  v_cvt_pk_bf16_f32 v173, v154, v155
  v_cvt_pk_bf16_f32 v174, v156, v157
  v_cvt_pk_bf16_f32 v175, v158, v159
  buffer_load_dwordx2 v[200:201], v28, s[28:31], s10 offen offset:0 sc1
  buffer_load_dwordx2 v[202:203], v28, s[28:31], s10 offen offset:512 sc1
  buffer_load_dwordx2 v[204:205], v28, s[28:31], s10 offen offset:1024 sc1
  s_mov_b32 exec_hi, 0
  buffer_load_dwordx2 v[206:207], v28, s[28:31], s10 offen offset:1536 sc1
  s_mov_b64 exec, s[20:21]
  buffer_load_dwordx4 v[232:235], v31, s[28:31], s10 offen offset:1792 sc1
  buffer_load_dwordx4 v[236:239], v31, s[28:31], s10 offen offset:2688 sc1
  s_mov_b64 exec, -1
  s_add_u32 s9, s9, 3584
  s_cmp_eq_u32 s9, 57344
  s_cselect_b32 s9, 0, s9
  s_add_u32 s10, s8, s9
  s_setprio 3
  v_mfma_f32_32x32x16_bf16 v[144:159], v[176:179], v[56:59], 0
  s_setprio 1
  v_exp_f32 v128, v128
  v_exp_f32 v129, v129
  v_exp_f32 v130, v130
  v_exp_f32 v131, v131
  s_setprio 3
  v_mfma_f32_32x32x16_bf16 v[144:159], v[180:183], v[60:63], v[144:159]
  s_setprio 1
  v_exp_f32 v132, v132
  v_exp_f32 v133, v133
  v_exp_f32 v134, v134
  v_exp_f32 v135, v135
  s_setprio 3
  v_mfma_f32_32x32x16_bf16 v[80:95], v[208:211], v[168:171], v[80:95]
  s_setprio 1
  v_exp_f32 v136, v136
  v_exp_f32 v137, v137
  v_exp_f32 v138, v138
  v_exp_f32 v139, v139
  s_setprio 3
  v_mfma_f32_32x32x16_bf16 v[80:95], v[212:215], v[172:175], v[80:95]
  s_setprio 1
  v_exp_f32 v140, v140
  v_exp_f32 v141, v141
  v_exp_f32 v142, v142
  v_exp_f32 v143, v143
  v_cvt_pk_bf16_f32 v160, v128, v129
  v_cvt_pk_bf16_f32 v161, v130, v131
  v_cvt_pk_bf16_f32 v162, v132, v133
  v_cvt_pk_bf16_f32 v163, v134, v135
  v_cvt_pk_bf16_f32 v164, v136, v137
  v_cvt_pk_bf16_f32 v165, v138, v139
  v_cvt_pk_bf16_f32 v166, v140, v141
  v_cvt_pk_bf16_f32 v167, v142, v143
  s_waitcnt vmcnt(14)
  s_setprio 3
  v_mfma_f32_32x32x16_bf16 v[128:143], v[184:187], v[32:35], 0
  s_setprio 1
  v_exp_f32 v144, v144
  v_exp_f32 v145, v145
  v_exp_f32 v146, v146
  v_exp_f32 v147, v147
  s_setprio 3
  v_mfma_f32_32x32x16_bf16 v[128:143], v[188:191], v[36:39], v[128:143]
  s_setprio 1
  v_exp_f32 v148, v148
  v_exp_f32 v149, v149
  v_exp_f32 v150, v150
  v_exp_f32 v151, v151
  s_setprio 3
  v_mfma_f32_32x32x16_bf16 v[96:111], v[208:211], v[160:163], v[96:111]
  s_setprio 1
  v_exp_f32 v152, v152
  v_exp_f32 v153, v153
  v_exp_f32 v154, v154
  v_exp_f32 v155, v155
  s_setprio 3
  v_mfma_f32_32x32x16_bf16 v[96:111], v[212:215], v[164:167], v[96:111]
  s_setprio 1
  v_exp_f32 v156, v156
  v_exp_f32 v157, v157
  v_exp_f32 v158, v158
  v_exp_f32 v159, v159
  v_cvt_pk_bf16_f32 v168, v144, v145
  v_cvt_pk_bf16_f32 v169, v146, v147
  v_cvt_pk_bf16_f32 v170, v148, v149
  v_cvt_pk_bf16_f32 v171, v150, v151
  v_cvt_pk_bf16_f32 v172, v152, v153
  v_cvt_pk_bf16_f32 v173, v154, v155
  v_cvt_pk_bf16_f32 v174, v156, v157
  v_cvt_pk_bf16_f32 v175, v158, v159
  s_setprio 3
  v_mfma_f32_32x32x16_bf16 v[144:159], v[184:187], v[40:43], 0
  s_setprio 1
  v_exp_f32 v128, v128
  v_exp_f32 v129, v129
  v_exp_f32 v130, v130
  v_exp_f32 v131, v131
  s_setprio 3
  v_mfma_f32_32x32x16_bf16 v[144:159], v[188:191], v[44:47], v[144:159]
  s_setprio 1
  v_exp_f32 v132, v132
  v_exp_f32 v133, v133
  v_exp_f32 v134, v134
  v_exp_f32 v135, v135
  s_setprio 3
  v_mfma_f32_32x32x16_bf16 v[112:127], v[208:211], v[168:171], v[112:127]
  s_setprio 1
  v_exp_f32 v136, v136
  v_exp_f32 v137, v137
  v_exp_f32 v138, v138
  v_exp_f32 v139, v139
  s_setprio 3
  v_mfma_f32_32x32x16_bf16 v[112:127], v[212:215], v[172:175], v[112:127]
  s_setprio 1
  v_exp_f32 v140, v140
  v_exp_f32 v141, v141
  v_exp_f32 v142, v142
  v_exp_f32 v143, v143
  v_cvt_pk_bf16_f32 v160, v128, v129
  v_cvt_pk_bf16_f32 v161, v130, v131
  v_cvt_pk_bf16_f32 v162, v132, v133
  v_cvt_pk_bf16_f32 v163, v134, v135
  v_cvt_pk_bf16_f32 v164, v136, v137
  v_cvt_pk_bf16_f32 v165, v138, v139
  v_cvt_pk_bf16_f32 v166, v140, v141
  v_cvt_pk_bf16_f32 v167, v142, v143
  s_waitcnt vmcnt(12)
  s_setprio 3
  v_mfma_f32_32x32x16_bf16 v[128:143], v[184:187], v[48:51], 0
  s_setprio 1
  v_exp_f32 v144, v144
  v_exp_f32 v145, v145
  v_exp_f32 v146, v146
  v_exp_f32 v147, v147
  s_setprio 3
  v_mfma_f32_32x32x16_bf16 v[128:143], v[188:191], v[52:55], v[128:143]
  s_setprio 1
  v_exp_f32 v148, v148
  v_exp_f32 v149, v149
  v_exp_f32 v150, v150
  v_exp_f32 v151, v151
  s_setprio 3
  v_mfma_f32_32x32x16_bf16 v[64:79], v[216:219], v[160:163], v[64:79]
  s_setprio 1
  v_exp_f32 v152, v152
  v_exp_f32 v153, v153
  v_exp_f32 v154, v154
  v_exp_f32 v155, v155
  s_setprio 3
  v_mfma_f32_32x32x16_bf16 v[64:79], v[220:223], v[164:167], v[64:79]
  s_setprio 1
  v_exp_f32 v156, v156
  v_exp_f32 v157, v157
  v_exp_f32 v158, v158
  v_exp_f32 v159, v159
  v_cvt_pk_bf16_f32 v168, v144, v145
  v_cvt_pk_bf16_f32 v169, v146, v147
  v_cvt_pk_bf16_f32 v170, v148, v149
  v_cvt_pk_bf16_f32 v171, v150, v151
  v_cvt_pk_bf16_f32 v172, v152, v153
  v_cvt_pk_bf16_f32 v173, v154, v155
  v_cvt_pk_bf16_f32 v174, v156, v157
  v_cvt_pk_bf16_f32 v175, v158, v159
  buffer_load_dwordx2 v[176:177], v28, s[28:31], s10 offen offset:0 sc1
  buffer_load_dwordx2 v[178:179], v28, s[28:31], s10 offen offset:512 sc1
  buffer_load_dwordx2 v[180:181], v28, s[28:31], s10 offen offset:1024 sc1
  s_mov_b32 exec_hi, 0
  buffer_load_dwordx2 v[182:183], v28, s[28:31], s10 offen offset:1536 sc1
  s_mov_b64 exec, s[20:21]
  buffer_load_dwordx4 v[208:211], v31, s[28:31], s10 offen offset:1792 sc1
  buffer_load_dwordx4 v[212:215], v31, s[28:31], s10 offen offset:2688 sc1
  s_mov_b64 exec, -1
  s_add_u32 s9, s9, 3584
  s_cmp_eq_u32 s9, 57344
  s_cselect_b32 s9, 0, s9
  s_add_u32 s10, s8, s9
  s_setprio 3
  v_mfma_f32_32x32x16_bf16 v[144:159], v[184:187], v[56:59], 0
  s_setprio 1
  v_exp_f32 v128, v128
  v_exp_f32 v129, v129
  v_exp_f32 v130, v130
  v_exp_f32 v131, v131
  s_setprio 3
  v_mfma_f32_32x32x16_bf16 v[144:159], v[188:191], v[60:63], v[144:159]
  s_setprio 1
  v_exp_f32 v132, v132
  v_exp_f32 v133, v133
  v_exp_f32 v134, v134
  v_exp_f32 v135, v135
  s_setprio 3
  v_mfma_f32_32x32x16_bf16 v[80:95], v[216:219], v[168:171], v[80:95]
  s_setprio 1
  v_exp_f32 v136, v136
  v_exp_f32 v137, v137
  v_exp_f32 v138, v138
  v_exp_f32 v139, v139
  s_setprio 3
  v_mfma_f32_32x32x16_bf16 v[80:95], v[220:223], v[172:175], v[80:95]
  s_setprio 1
  v_exp_f32 v140, v140
  v_exp_f32 v141, v141
  v_exp_f32 v142, v142
  v_exp_f32 v143, v143
  v_cvt_pk_bf16_f32 v160, v128, v129
  v_cvt_pk_bf16_f32 v161, v130, v131
  v_cvt_pk_bf16_f32 v162, v132, v133
  v_cvt_pk_bf16_f32 v163, v134, v135
  v_cvt_pk_bf16_f32 v164, v136, v137
  v_cvt_pk_bf16_f32 v165, v138, v139
  v_cvt_pk_bf16_f32 v166, v140, v141
  v_cvt_pk_bf16_f32 v167, v142, v143
  s_waitcnt vmcnt(14)
  s_setprio 3
  v_mfma_f32_32x32x16_bf16 v[128:143], v[192:195], v[32:35], 0
  s_setprio 1
  v_exp_f32 v144, v144
  v_exp_f32 v145, v145
  v_exp_f32 v146, v146
  v_exp_f32 v147, v147
  s_setprio 3
  v_mfma_f32_32x32x16_bf16 v[128:143], v[196:199], v[36:39], v[128:143]
  s_setprio 1
  v_exp_f32 v148, v148
  v_exp_f32 v149, v149
  v_exp_f32 v150, v150
  v_exp_f32 v151, v151
  s_setprio 3
  v_mfma_f32_32x32x16_bf16 v[96:111], v[216:219], v[160:163], v[96:111]
  s_setprio 1
  v_exp_f32 v152, v152
  v_exp_f32 v153, v153
  v_exp_f32 v154, v154
  v_exp_f32 v155, v155
  s_setprio 3
  v_mfma_f32_32x32x16_bf16 v[96:111], v[220:223], v[164:167], v[96:111]
  s_setprio 1
  v_exp_f32 v156, v156
  v_exp_f32 v157, v157
  v_exp_f32 v158, v158
  v_exp_f32 v159, v159
  v_cvt_pk_bf16_f32 v168, v144, v145
  v_cvt_pk_bf16_f32 v169, v146, v147
  v_cvt_pk_bf16_f32 v170, v148, v149
  v_cvt_pk_bf16_f32 v171, v150, v151
  v_cvt_pk_bf16_f32 v172, v152, v153
  v_cvt_pk_bf16_f32 v173, v154, v155
  v_cvt_pk_bf16_f32 v174, v156, v157
  v_cvt_pk_bf16_f32 v175, v158, v159
  s_setprio 3
  v_mfma_f32_32x32x16_bf16 v[144:159], v[192:195], v[40:43], 0
  s_setprio 1
  v_exp_f32 v128, v128
  v_exp_f32 v129, v129
  v_exp_f32 v130, v130
  v_exp_f32 v131, v131
  s_setprio 3
  v_mfma_f32_32x32x16_bf16 v[144:159], v[196:199], v[44:47], v[144:159]
  s_setprio 1
  v_exp_f32 v132, v132
  v_exp_f32 v133, v133
  v_exp_f32 v134, v134
  v_exp_f32 v135, v135
  s_setprio 3
  v_mfma_f32_32x32x16_bf16 v[112:127], v[216:219], v[168:171], v[112:127]
  s_setprio 1
  v_exp_f32 v136, v136
  v_exp_f32 v137, v137
  v_exp_f32 v138, v138
  v_exp_f32 v139, v139
  s_setprio 3
  v_mfma_f32_32x32x16_bf16 v[112:127], v[220:223], v[172:175], v[112:127]
  s_setprio 1
  v_exp_f32 v140, v140
  v_exp_f32 v141, v141
  v_exp_f32 v142, v142
  v_exp_f32 v143, v143
  v_cvt_pk_bf16_f32 v160, v128, v129
  v_cvt_pk_bf16_f32 v161, v130, v131
  v_cvt_pk_bf16_f32 v162, v132, v133
  v_cvt_pk_bf16_f32 v163, v134, v135
  v_cvt_pk_bf16_f32 v164, v136, v137
  v_cvt_pk_bf16_f32 v165, v138, v139
  v_cvt_pk_bf16_f32 v166, v140, v141
  v_cvt_pk_bf16_f32 v167, v142, v143
  s_waitcnt vmcnt(12)
  s_setprio 3
  v_mfma_f32_32x32x16_bf16 v[128:143], v[192:195], v[48:51], 0
  s_setprio 1
  v_exp_f32 v144, v144
  v_exp_f32 v145, v145
  v_exp_f32 v146, v146
  v_exp_f32 v147, v147
  s_setprio 3
  v_mfma_f32_32x32x16_bf16 v[128:143], v[196:199], v[52:55], v[128:143]
  s_setprio 1
  v_exp_f32 v148, v148
  v_exp_f32 v149, v149
  v_exp_f32 v150, v150
  v_exp_f32 v151, v151
  s_setprio 3
  v_mfma_f32_32x32x16_bf16 v[64:79], v[224:227], v[160:163], v[64:79]
  s_setprio 1
  v_exp_f32 v152, v152
  v_exp_f32 v153, v153
  v_exp_f32 v154, v154
  v_exp_f32 v155, v155
  s_setprio 3
  v_mfma_f32_32x32x16_bf16 v[64:79], v[228:231], v[164:167], v[64:79]
  s_setprio 1
  v_exp_f32 v156, v156
  v_exp_f32 v157, v157
  v_exp_f32 v158, v158
  v_exp_f32 v159, v159
  v_cvt_pk_bf16_f32 v168, v144, v145
  v_cvt_pk_bf16_f32 v169, v146, v147
  v_cvt_pk_bf16_f32 v170, v148, v149
  v_cvt_pk_bf16_f32 v171, v150, v151
  v_cvt_pk_bf16_f32 v172, v152, v153
  v_cvt_pk_bf16_f32 v173, v154, v155
  v_cvt_pk_bf16_f32 v174, v156, v157
  v_cvt_pk_bf16_f32 v175, v158, v159
  buffer_load_dwordx2 v[184:185], v28, s[28:31], s10 offen offset:0 sc1
  buffer_load_dwordx2 v[186:187], v28, s[28:31], s10 offen offset:512 sc1
  buffer_load_dwordx2 v[188:189], v28, s[28:31], s10 offen offset:1024 sc1
  s_mov_b32 exec_hi, 0
  buffer_load_dwordx2 v[190:191], v28, s[28:31], s10 offen offset:1536 sc1
  s_mov_b64 exec, s[20:21]
  buffer_load_dwordx4 v[216:219], v31, s[28:31], s10 offen offset:1792 sc1
  buffer_load_dwordx4 v[220:223], v31, s[28:31], s10 offen offset:2688 sc1
  s_mov_b64 exec, -1
  s_add_u32 s9, s9, 3584
  s_cmp_eq_u32 s9, 57344
  s_cselect_b32 s9, 0, s9
  s_add_u32 s10, s8, s9
  s_setprio 3
  v_mfma_f32_32x32x16_bf16 v[144:159], v[192:195], v[56:59], 0
  s_setprio 1
  v_exp_f32 v128, v128
  v_exp_f32 v129, v129
  v_exp_f32 v130, v130
  v_exp_f32 v131, v131
  s_setprio 3
  v_mfma_f32_32x32x16_bf16 v[144:159], v[196:199], v[60:63], v[144:159]
  s_setprio 1
  v_exp_f32 v132, v132
  v_exp_f32 v133, v133
  v_exp_f32 v134, v134
  v_exp_f32 v135, v135
  s_setprio 3
  v_mfma_f32_32x32x16_bf16 v[80:95], v[224:227], v[168:171], v[80:95]
  s_setprio 1
  v_exp_f32 v136, v136
  v_exp_f32 v137, v137
  v_exp_f32 v138, v138
  v_exp_f32 v139, v139
  s_setprio 3
  v_mfma_f32_32x32x16_bf16 v[80:95], v[228:231], v[172:175], v[80:95]
  s_setprio 1
  v_exp_f32 v140, v140
  v_exp_f32 v141, v141
  v_exp_f32 v142, v142
  v_exp_f32 v143, v143
  v_cvt_pk_bf16_f32 v160, v128, v129
  v_cvt_pk_bf16_f32 v161, v130, v131
  v_cvt_pk_bf16_f32 v162, v132, v133
  v_cvt_pk_bf16_f32 v163, v134, v135
  v_cvt_pk_bf16_f32 v164, v136, v137
  v_cvt_pk_bf16_f32 v165, v138, v139
  v_cvt_pk_bf16_f32 v166, v140, v141
  v_cvt_pk_bf16_f32 v167, v142, v143
  s_waitcnt vmcnt(14)
  s_setprio 3
  v_mfma_f32_32x32x16_bf16 v[128:143], v[200:203], v[32:35], 0
  s_setprio 1
  v_exp_f32 v144, v144
  v_exp_f32 v145, v145
  v_exp_f32 v146, v146
  v_exp_f32 v147, v147
  s_setprio 3
  v_mfma_f32_32x32x16_bf16 v[128:143], v[204:207], v[36:39], v[128:143]
  s_setprio 1
  v_exp_f32 v148, v148
  v_exp_f32 v149, v149
  v_exp_f32 v150, v150
  v_exp_f32 v151, v151
  s_setprio 3
  v_mfma_f32_32x32x16_bf16 v[96:111], v[224:227], v[160:163], v[96:111]
  s_setprio 1
  v_exp_f32 v152, v152
  v_exp_f32 v153, v153
  v_exp_f32 v154, v154
  v_exp_f32 v155, v155
  s_setprio 3
  v_mfma_f32_32x32x16_bf16 v[96:111], v[228:231], v[164:167], v[96:111]
  s_setprio 1
  v_exp_f32 v156, v156
  v_exp_f32 v157, v157
  v_exp_f32 v158, v158
  v_exp_f32 v159, v159
  v_cvt_pk_bf16_f32 v168, v144, v145
  v_cvt_pk_bf16_f32 v169, v146, v147
  v_cvt_pk_bf16_f32 v170, v148, v149
  v_cvt_pk_bf16_f32 v171, v150, v151
  v_cvt_pk_bf16_f32 v172, v152, v153
  v_cvt_pk_bf16_f32 v173, v154, v155
  v_cvt_pk_bf16_f32 v174, v156, v157
  v_cvt_pk_bf16_f32 v175, v158, v159
  s_setprio 3
  v_mfma_f32_32x32x16_bf16 v[144:159], v[200:203], v[40:43], 0
  s_setprio 1
  v_exp_f32 v128, v128
  v_exp_f32 v129, v129
  v_exp_f32 v130, v130
  v_exp_f32 v131, v131
  s_setprio 3
  v_mfma_f32_32x32x16_bf16 v[144:159], v[204:207], v[44:47], v[144:159]
  s_setprio 1
  v_exp_f32 v132, v132
  v_exp_f32 v133, v133
  v_exp_f32 v134, v134
  v_exp_f32 v135, v135
  s_setprio 3
  v_mfma_f32_32x32x16_bf16 v[112:127], v[224:227], v[168:171], v[112:127]
  s_setprio 1
  v_exp_f32 v136, v136
  v_exp_f32 v137, v137
  v_exp_f32 v138, v138
  v_exp_f32 v139, v139
  s_setprio 3
  v_mfma_f32_32x32x16_bf16 v[112:127], v[228:231], v[172:175], v[112:127]
  s_setprio 1
  v_exp_f32 v140, v140
  v_exp_f32 v141, v141
  v_exp_f32 v142, v142
  v_exp_f32 v143, v143
  v_cvt_pk_bf16_f32 v160, v128, v129
  v_cvt_pk_bf16_f32 v161, v130, v131
  v_cvt_pk_bf16_f32 v162, v132, v133
  v_cvt_pk_bf16_f32 v163, v134, v135
  v_cvt_pk_bf16_f32 v164, v136, v137
  v_cvt_pk_bf16_f32 v165, v138, v139
  v_cvt_pk_bf16_f32 v166, v140, v141
  v_cvt_pk_bf16_f32 v167, v142, v143
  s_waitcnt vmcnt(12)
  s_setprio 3
  v_mfma_f32_32x32x16_bf16 v[128:143], v[200:203], v[48:51], 0
  s_setprio 1
  v_exp_f32 v144, v144
  v_exp_f32 v145, v145
  v_exp_f32 v146, v146
  v_exp_f32 v147, v147
  s_setprio 3
  v_mfma_f32_32x32x16_bf16 v[128:143], v[204:207], v[52:55], v[128:143]
  s_setprio 1
  v_exp_f32 v148, v148
  v_exp_f32 v149, v149
  v_exp_f32 v150, v150
  v_exp_f32 v151, v151
  s_setprio 3
  v_mfma_f32_32x32x16_bf16 v[64:79], v[232:235], v[160:163], v[64:79]
  s_setprio 1
  v_exp_f32 v152, v152
  v_exp_f32 v153, v153
  v_exp_f32 v154, v154
  v_exp_f32 v155, v155
  s_setprio 3
  v_mfma_f32_32x32x16_bf16 v[64:79], v[236:239], v[164:167], v[64:79]
  s_setprio 1
  v_exp_f32 v156, v156
  v_exp_f32 v157, v157
  v_exp_f32 v158, v158
  v_exp_f32 v159, v159
  v_cvt_pk_bf16_f32 v168, v144, v145
  v_cvt_pk_bf16_f32 v169, v146, v147
  v_cvt_pk_bf16_f32 v170, v148, v149
  v_cvt_pk_bf16_f32 v171, v150, v151
  v_cvt_pk_bf16_f32 v172, v152, v153
  v_cvt_pk_bf16_f32 v173, v154, v155
  v_cvt_pk_bf16_f32 v174, v156, v157
  v_cvt_pk_bf16_f32 v175, v158, v159
  buffer_load_dwordx2 v[192:193], v28, s[28:31], s10 offen offset:0 sc1
  buffer_load_dwordx2 v[194:195], v28, s[28:31], s10 offen offset:512 sc1
  buffer_load_dwordx2 v[196:197], v28, s[28:31], s10 offen offset:1024 sc1
  s_mov_b32 exec_hi, 0
  buffer_load_dwordx2 v[198:199], v28, s[28:31], s10 offen offset:1536 sc1
  s_mov_b64 exec, s[20:21]
  buffer_load_dwordx4 v[224:227], v31, s[28:31], s10 offen offset:1792 sc1
  buffer_load_dwordx4 v[228:231], v31, s[28:31], s10 offen offset:2688 sc1
  s_mov_b64 exec, -1
  s_add_u32 s9, s9, 3584
  s_cmp_eq_u32 s9, 57344
  s_cselect_b32 s9, 0, s9
  s_add_u32 s10, s8, s9
  s_setprio 3
  v_mfma_f32_32x32x16_bf16 v[144:159], v[200:203], v[56:59], 0
  s_setprio 1
  v_exp_f32 v128, v128
  v_exp_f32 v129, v129
  v_exp_f32 v130, v130
  v_exp_f32 v131, v131
  s_setprio 3
  v_mfma_f32_32x32x16_bf16 v[144:159], v[204:207], v[60:63], v[144:159]
  s_setprio 1
  v_exp_f32 v132, v132
  v_exp_f32 v133, v133
  v_exp_f32 v134, v134
  v_exp_f32 v135, v135
  s_setprio 3
  v_mfma_f32_32x32x16_bf16 v[80:95], v[232:235], v[168:171], v[80:95]
  s_setprio 1
  v_exp_f32 v136, v136
  v_exp_f32 v137, v137
  v_exp_f32 v138, v138
  v_exp_f32 v139, v139
  s_setprio 3
  v_mfma_f32_32x32x16_bf16 v[80:95], v[236:239], v[172:175], v[80:95]
  s_setprio 1
  v_exp_f32 v140, v140
  v_exp_f32 v141, v141
  v_exp_f32 v142, v142
  v_exp_f32 v143, v143
  v_cvt_pk_bf16_f32 v160, v128, v129
  v_cvt_pk_bf16_f32 v161, v130, v131
  v_cvt_pk_bf16_f32 v162, v132, v133
  v_cvt_pk_bf16_f32 v163, v134, v135
  v_cvt_pk_bf16_f32 v164, v136, v137
  v_cvt_pk_bf16_f32 v165, v138, v139
  v_cvt_pk_bf16_f32 v166, v140, v141
  v_cvt_pk_bf16_f32 v167, v142, v143
  s_waitcnt vmcnt(14)
  s_setprio 3
  v_mfma_f32_32x32x16_bf16 v[128:143], v[176:179], v[32:35], 0
  s_setprio 1
  v_exp_f32 v144, v144
  v_exp_f32 v145, v145
  v_exp_f32 v146, v146
  v_exp_f32 v147, v147
  s_setprio 3
  v_mfma_f32_32x32x16_bf16 v[128:143], v[180:183], v[36:39], v[128:143]
  s_setprio 1
  v_exp_f32 v148, v148
  v_exp_f32 v149, v149
  v_exp_f32 v150, v150
  v_exp_f32 v151, v151
  s_setprio 3
  v_mfma_f32_32x32x16_bf16 v[96:111], v[232:235], v[160:163], v[96:111]
  s_setprio 1
  v_exp_f32 v152, v152
  v_exp_f32 v153, v153
  v_exp_f32 v154, v154
  v_exp_f32 v155, v155
  s_setprio 3
  v_mfma_f32_32x32x16_bf16 v[96:111], v[236:239], v[164:167], v[96:111]
  s_setprio 1
  v_exp_f32 v156, v156
  v_exp_f32 v157, v157
  v_exp_f32 v158, v158
  v_exp_f32 v159, v159
  v_cvt_pk_bf16_f32 v168, v144, v145
  v_cvt_pk_bf16_f32 v169, v146, v147
  v_cvt_pk_bf16_f32 v170, v148, v149
  v_cvt_pk_bf16_f32 v171, v150, v151
  v_cvt_pk_bf16_f32 v172, v152, v153
  v_cvt_pk_bf16_f32 v173, v154, v155
  v_cvt_pk_bf16_f32 v174, v156, v157
  v_cvt_pk_bf16_f32 v175, v158, v159
  s_setprio 3
  v_mfma_f32_32x32x16_bf16 v[144:159], v[176:179], v[40:43], 0
  s_setprio 1
  v_exp_f32 v128, v128
  v_exp_f32 v129, v129
  v_exp_f32 v130, v130
  v_exp_f32 v131, v131
  s_setprio 3
  v_mfma_f32_32x32x16_bf16 v[144:159], v[180:183], v[44:47], v[144:159]
  s_setprio 1
  v_exp_f32 v132, v132
  v_exp_f32 v133, v133
  v_exp_f32 v134, v134
  v_exp_f32 v135, v135
  s_setprio 3
  v_mfma_f32_32x32x16_bf16 v[112:127], v[232:235], v[168:171], v[112:127]
  s_setprio 1
  v_exp_f32 v136, v136
  v_exp_f32 v137, v137
  v_exp_f32 v138, v138
  v_exp_f32 v139, v139
  s_setprio 3
  v_mfma_f32_32x32x16_bf16 v[112:127], v[236:239], v[172:175], v[112:127]
  s_setprio 1
  v_exp_f32 v140, v140
  v_exp_f32 v141, v141
  v_exp_f32 v142, v142
  v_exp_f32 v143, v143
  v_cvt_pk_bf16_f32 v160, v128, v129
  v_cvt_pk_bf16_f32 v161, v130, v131
  v_cvt_pk_bf16_f32 v162, v132, v133
  v_cvt_pk_bf16_f32 v163, v134, v135
  v_cvt_pk_bf16_f32 v164, v136, v137
  v_cvt_pk_bf16_f32 v165, v138, v139
  v_cvt_pk_bf16_f32 v166, v140, v141
  v_cvt_pk_bf16_f32 v167, v142, v143
  s_waitcnt vmcnt(12)
  s_setprio 3
  v_mfma_f32_32x32x16_bf16 v[128:143], v[176:179], v[48:51], 0
  s_setprio 1
  v_exp_f32 v144, v144
  v_exp_f32 v145, v145
  v_exp_f32 v146, v146
  v_exp_f32 v147, v147
  s_setprio 3
  v_mfma_f32_32x32x16_bf16 v[128:143], v[180:183], v[52:55], v[128:143]
  s_setprio 1
  v_exp_f32 v148, v148
  v_exp_f32 v149, v149
  v_exp_f32 v150, v150
  v_exp_f32 v151, v151
  s_setprio 3
  v_mfma_f32_32x32x16_bf16 v[64:79], v[208:211], v[160:163], v[64:79]
  s_setprio 1
  v_exp_f32 v152, v152
  v_exp_f32 v153, v153
  v_exp_f32 v154, v154
  v_exp_f32 v155, v155
  s_setprio 3
  v_mfma_f32_32x32x16_bf16 v[64:79], v[212:215], v[164:167], v[64:79]
  s_setprio 1
  v_exp_f32 v156, v156
  v_exp_f32 v157, v157
  v_exp_f32 v158, v158
  v_exp_f32 v159, v159
  v_cvt_pk_bf16_f32 v168, v144, v145
  v_cvt_pk_bf16_f32 v169, v146, v147
  v_cvt_pk_bf16_f32 v170, v148, v149
  v_cvt_pk_bf16_f32 v171, v150, v151
  v_cvt_pk_bf16_f32 v172, v152, v153
  v_cvt_pk_bf16_f32 v173, v154, v155
  v_cvt_pk_bf16_f32 v174, v156, v157
  v_cvt_pk_bf16_f32 v175, v158, v159
  buffer_load_dwordx2 v[200:201], v28, s[28:31], s10 offen offset:0 sc1
  buffer_load_dwordx2 v[202:203], v28, s[28:31], s10 offen offset:512 sc1
  buffer_load_dwordx2 v[204:205], v28, s[28:31], s10 offen offset:1024 sc1
  s_mov_b32 exec_hi, 0
  buffer_load_dwordx2 v[206:207], v28, s[28:31], s10 offen offset:1536 sc1
  s_mov_b64 exec, s[20:21]
  buffer_load_dwordx4 v[232:235], v31, s[28:31], s10 offen offset:1792 sc1
  buffer_load_dwordx4 v[236:239], v31, s[28:31], s10 offen offset:2688 sc1
  s_mov_b64 exec, -1
  s_add_u32 s9, s9, 3584
  s_cmp_eq_u32 s9, 57344
  s_cselect_b32 s9, 0, s9
  s_add_u32 s10, s8, s9
  s_setprio 3
  v_mfma_f32_32x32x16_bf16 v[144:159], v[176:179], v[56:59], 0
  s_setprio 1
  v_exp_f32 v128, v128
  v_exp_f32 v129, v129
  v_exp_f32 v130, v130
  v_exp_f32 v131, v131
  s_setprio 3
  v_mfma_f32_32x32x16_bf16 v[144:159], v[180:183], v[60:63], v[144:159]
  s_setprio 1
  v_exp_f32 v132, v132
  v_exp_f32 v133, v133
  v_exp_f32 v134, v134
  v_exp_f32 v135, v135
  s_setprio 3
  v_mfma_f32_32x32x16_bf16 v[80:95], v[208:211], v[168:171], v[80:95]
  s_setprio 1
  v_exp_f32 v136, v136
  v_exp_f32 v137, v137
  v_exp_f32 v138, v138
  v_exp_f32 v139, v139
  s_setprio 3
  v_mfma_f32_32x32x16_bf16 v[80:95], v[212:215], v[172:175], v[80:95]
  s_setprio 1
  v_exp_f32 v140, v140
  v_exp_f32 v141, v141
  v_exp_f32 v142, v142
  v_exp_f32 v143, v143
  v_cvt_pk_bf16_f32 v160, v128, v129
  v_cvt_pk_bf16_f32 v161, v130, v131
  v_cvt_pk_bf16_f32 v162, v132, v133
  v_cvt_pk_bf16_f32 v163, v134, v135
  v_cvt_pk_bf16_f32 v164, v136, v137
  v_cvt_pk_bf16_f32 v165, v138, v139
  v_cvt_pk_bf16_f32 v166, v140, v141
  v_cvt_pk_bf16_f32 v167, v142, v143
  s_waitcnt vmcnt(14)
  s_setprio 3
  v_mfma_f32_32x32x16_bf16 v[128:143], v[184:187], v[32:35], 0
  s_setprio 1
  v_exp_f32 v144, v144
  v_exp_f32 v145, v145
  v_exp_f32 v146, v146
  v_exp_f32 v147, v147
  s_setprio 3
  v_mfma_f32_32x32x16_bf16 v[128:143], v[188:191], v[36:39], v[128:143]
  s_setprio 1
  v_exp_f32 v148, v148
  v_exp_f32 v149, v149
  v_exp_f32 v150, v150
  v_exp_f32 v151, v151
  s_setprio 3
  v_mfma_f32_32x32x16_bf16 v[96:111], v[208:211], v[160:163], v[96:111]
  s_setprio 1
  v_exp_f32 v152, v152
  v_exp_f32 v153, v153
  v_exp_f32 v154, v154
  v_exp_f32 v155, v155
  s_setprio 3
  v_mfma_f32_32x32x16_bf16 v[96:111], v[212:215], v[164:167], v[96:111]
  s_setprio 1
  v_exp_f32 v156, v156
  v_exp_f32 v157, v157
  v_exp_f32 v158, v158
  v_exp_f32 v159, v159
  v_cvt_pk_bf16_f32 v168, v144, v145
  v_cvt_pk_bf16_f32 v169, v146, v147
  v_cvt_pk_bf16_f32 v170, v148, v149
  v_cvt_pk_bf16_f32 v171, v150, v151
  v_cvt_pk_bf16_f32 v172, v152, v153
  v_cvt_pk_bf16_f32 v173, v154, v155
  v_cvt_pk_bf16_f32 v174, v156, v157
  v_cvt_pk_bf16_f32 v175, v158, v159
  s_setprio 3
  v_mfma_f32_32x32x16_bf16 v[144:159], v[184:187], v[40:43], 0
  s_setprio 1
  v_exp_f32 v128, v128
  v_exp_f32 v129, v129
  v_exp_f32 v130, v130
  v_exp_f32 v131, v131
  s_setprio 3
  v_mfma_f32_32x32x16_bf16 v[144:159], v[188:191], v[44:47], v[144:159]
  s_setprio 1
  v_exp_f32 v132, v132
  v_exp_f32 v133, v133
  v_exp_f32 v134, v134
  v_exp_f32 v135, v135
  s_setprio 3
  v_mfma_f32_32x32x16_bf16 v[112:127], v[208:211], v[168:171], v[112:127]
  s_setprio 1
  v_exp_f32 v136, v136
  v_exp_f32 v137, v137
  v_exp_f32 v138, v138
  v_exp_f32 v139, v139
  s_setprio 3
  v_mfma_f32_32x32x16_bf16 v[112:127], v[212:215], v[172:175], v[112:127]
  s_setprio 1
  v_exp_f32 v140, v140
  v_exp_f32 v141, v141
  v_exp_f32 v142, v142
  v_exp_f32 v143, v143
  v_cvt_pk_bf16_f32 v160, v128, v129
  v_cvt_pk_bf16_f32 v161, v130, v131
  v_cvt_pk_bf16_f32 v162, v132, v133
  v_cvt_pk_bf16_f32 v163, v134, v135
  v_cvt_pk_bf16_f32 v164, v136, v137
  v_cvt_pk_bf16_f32 v165, v138, v139
  v_cvt_pk_bf16_f32 v166, v140, v141
  v_cvt_pk_bf16_f32 v167, v142, v143
  s_waitcnt vmcnt(12)
  s_setprio 3
  v_mfma_f32_32x32x16_bf16 v[128:143], v[184:187], v[48:51], 0
  s_setprio 1
  v_exp_f32 v144, v144
  v_exp_f32 v145, v145
  v_exp_f32 v146, v146
  v_exp_f32 v147, v147
  s_setprio 3
  v_mfma_f32_32x32x16_bf16 v[128:143], v[188:191], v[52:55], v[128:143]
  s_setprio 1
  v_exp_f32 v148, v148
  v_exp_f32 v149, v149
  v_exp_f32 v150, v150
  v_exp_f32 v151, v151
  s_setprio 3
  v_mfma_f32_32x32x16_bf16 v[64:79], v[216:219], v[160:163], v[64:79]
  s_setprio 1
  v_exp_f32 v152, v152
  v_exp_f32 v153, v153
  v_exp_f32 v154, v154
  v_exp_f32 v155, v155
  s_setprio 3
  v_mfma_f32_32x32x16_bf16 v[64:79], v[220:223], v[164:167], v[64:79]
  s_setprio 1
  v_exp_f32 v156, v156
  v_exp_f32 v157, v157
  v_exp_f32 v158, v158
  v_exp_f32 v159, v159
  v_cvt_pk_bf16_f32 v168, v144, v145
  v_cvt_pk_bf16_f32 v169, v146, v147
  v_cvt_pk_bf16_f32 v170, v148, v149
  v_cvt_pk_bf16_f32 v171, v150, v151
  v_cvt_pk_bf16_f32 v172, v152, v153
  v_cvt_pk_bf16_f32 v173, v154, v155
  v_cvt_pk_bf16_f32 v174, v156, v157
  v_cvt_pk_bf16_f32 v175, v158, v159
  buffer_load_dwordx2 v[176:177], v28, s[28:31], s10 offen offset:0 sc1
  buffer_load_dwordx2 v[178:179], v28, s[28:31], s10 offen offset:512 sc1
  buffer_load_dwordx2 v[180:181], v28, s[28:31], s10 offen offset:1024 sc1
  s_mov_b32 exec_hi, 0
  buffer_load_dwordx2 v[182:183], v28, s[28:31], s10 offen offset:1536 sc1
  s_mov_b64 exec, s[20:21]
  buffer_load_dwordx4 v[208:211], v31, s[28:31], s10 offen offset:1792 sc1
  buffer_load_dwordx4 v[212:215], v31, s[28:31], s10 offen offset:2688 sc1
  s_mov_b64 exec, -1
  s_add_u32 s9, s9, 3584
  s_cmp_eq_u32 s9, 57344
  s_cselect_b32 s9, 0, s9
  s_add_u32 s10, s8, s9
  s_setprio 3
  v_mfma_f32_32x32x16_bf16 v[144:159], v[184:187], v[56:59], 0
  s_setprio 1
  v_exp_f32 v128, v128
  v_exp_f32 v129, v129
  v_exp_f32 v130, v130
  v_exp_f32 v131, v131
  s_setprio 3
  v_mfma_f32_32x32x16_bf16 v[144:159], v[188:191], v[60:63], v[144:159]
  s_setprio 1
  v_exp_f32 v132, v132
  v_exp_f32 v133, v133
  v_exp_f32 v134, v134
  v_exp_f32 v135, v135
  s_setprio 3
  v_mfma_f32_32x32x16_bf16 v[80:95], v[216:219], v[168:171], v[80:95]
  s_setprio 1
  v_exp_f32 v136, v136
  v_exp_f32 v137, v137
  v_exp_f32 v138, v138
  v_exp_f32 v139, v139
  s_setprio 3
  v_mfma_f32_32x32x16_bf16 v[80:95], v[220:223], v[172:175], v[80:95]
  s_setprio 1
  v_exp_f32 v140, v140
  v_exp_f32 v141, v141
  v_exp_f32 v142, v142
  v_exp_f32 v143, v143
  v_cvt_pk_bf16_f32 v160, v128, v129
  v_cvt_pk_bf16_f32 v161, v130, v131
  v_cvt_pk_bf16_f32 v162, v132, v133
  v_cvt_pk_bf16_f32 v163, v134, v135
  v_cvt_pk_bf16_f32 v164, v136, v137
  v_cvt_pk_bf16_f32 v165, v138, v139
  v_cvt_pk_bf16_f32 v166, v140, v141
  v_cvt_pk_bf16_f32 v167, v142, v143
  s_waitcnt vmcnt(14)
  s_setprio 3
  v_mfma_f32_32x32x16_bf16 v[128:143], v[192:195], v[32:35], 0
  s_setprio 1
  v_exp_f32 v144, v144
  v_exp_f32 v145, v145
  v_exp_f32 v146, v146
  v_exp_f32 v147, v147
  s_setprio 3
  v_mfma_f32_32x32x16_bf16 v[128:143], v[196:199], v[36:39], v[128:143]
  s_setprio 1
  v_exp_f32 v148, v148
  v_exp_f32 v149, v149
  v_exp_f32 v150, v150
  v_exp_f32 v151, v151
  s_setprio 3
  v_mfma_f32_32x32x16_bf16 v[96:111], v[216:219], v[160:163], v[96:111]
  s_setprio 1
  v_exp_f32 v152, v152
  v_exp_f32 v153, v153
  v_exp_f32 v154, v154
  v_exp_f32 v155, v155
  s_setprio 3
  v_mfma_f32_32x32x16_bf16 v[96:111], v[220:223], v[164:167], v[96:111]
  s_setprio 1
  v_exp_f32 v156, v156
  v_exp_f32 v157, v157
  v_exp_f32 v158, v158
  v_exp_f32 v159, v159
  v_cvt_pk_bf16_f32 v168, v144, v145
  v_cvt_pk_bf16_f32 v169, v146, v147
  v_cvt_pk_bf16_f32 v170, v148, v149
  v_cvt_pk_bf16_f32 v171, v150, v151
  v_cvt_pk_bf16_f32 v172, v152, v153
  v_cvt_pk_bf16_f32 v173, v154, v155
  v_cvt_pk_bf16_f32 v174, v156, v157
  v_cvt_pk_bf16_f32 v175, v158, v159
  v_mfma_f32_32x32x16_bf16 v[144:159], v[192:195], v[40:43], 0
  v_exp_f32 v128, v128
  v_exp_f32 v129, v129
  v_exp_f32 v130, v130
  v_mfma_f32_32x32x16_bf16 v[144:159], v[196:199], v[44:47], v[144:159]
  v_exp_f32 v131, v131
  v_exp_f32 v132, v132
  v_exp_f32 v133, v133
  v_mfma_f32_32x32x16_bf16 v[112:127], v[216:219], v[168:171], v[112:127]
  v_exp_f32 v134, v134
  v_exp_f32 v135, v135
  v_exp_f32 v136, v136
  v_mfma_f32_32x32x16_bf16 v[112:127], v[220:223], v[172:175], v[112:127]
  v_exp_f32 v137, v137
  v_exp_f32 v138, v138
  v_exp_f32 v139, v139
  v_exp_f32 v140, v140
  v_exp_f32 v141, v141
  v_exp_f32 v142, v142
  v_exp_f32 v143, v143
  v_cvt_pk_bf16_f32 v160, v128, v129
  v_cvt_pk_bf16_f32 v161, v130, v131
  v_cvt_pk_bf16_f32 v162, v132, v133
  v_cvt_pk_bf16_f32 v163, v134, v135
  v_cvt_pk_bf16_f32 v164, v136, v137
  v_cvt_pk_bf16_f32 v165, v138, v139
  v_cvt_pk_bf16_f32 v166, v140, v141
  v_cvt_pk_bf16_f32 v167, v142, v143
  s_waitcnt vmcnt(12)
  v_mfma_f32_32x32x16_bf16 v[128:143], v[192:195], v[48:51], 0
  v_exp_f32 v144, v144
  v_exp_f32 v145, v145
  v_exp_f32 v146, v146
  v_mfma_f32_32x32x16_bf16 v[128:143], v[196:199], v[52:55], v[128:143]
  v_exp_f32 v147, v147
  v_exp_f32 v148, v148
  v_exp_f32 v149, v149
  v_mfma_f32_32x32x16_bf16 v[64:79], v[224:227], v[160:163], v[64:79]
  v_exp_f32 v150, v150
  v_exp_f32 v151, v151
  v_exp_f32 v152, v152
  v_mfma_f32_32x32x16_bf16 v[64:79], v[228:231], v[164:167], v[64:79]
  v_exp_f32 v153, v153
  v_exp_f32 v154, v154
  v_exp_f32 v155, v155
  v_exp_f32 v156, v156
  v_exp_f32 v157, v157
  v_exp_f32 v158, v158
  v_exp_f32 v159, v159
  v_cvt_pk_bf16_f32 v168, v144, v145
  v_cvt_pk_bf16_f32 v169, v146, v147
  v_cvt_pk_bf16_f32 v170, v148, v149
  v_cvt_pk_bf16_f32 v171, v150, v151
  v_cvt_pk_bf16_f32 v172, v152, v153
  v_cvt_pk_bf16_f32 v173, v154, v155
  v_cvt_pk_bf16_f32 v174, v156, v157
  v_cvt_pk_bf16_f32 v175, v158, v159
  buffer_load_dwordx2 v[184:185], v28, s[28:31], s10 offen offset:0 sc1
  buffer_load_dwordx2 v[186:187], v28, s[28:31], s10 offen offset:512 sc1
  buffer_load_dwordx2 v[188:189], v28, s[28:31], s10 offen offset:1024 sc1
  s_mov_b32 exec_hi, 0
  buffer_load_dwordx2 v[190:191], v28, s[28:31], s10 offen offset:1536 sc1
  s_mov_b64 exec, s[20:21]
  buffer_load_dwordx4 v[216:219], v31, s[28:31], s10 offen offset:1792 sc1
  buffer_load_dwordx4 v[220:223], v31, s[28:31], s10 offen offset:2688 sc1
  s_mov_b64 exec, -1
  s_add_u32 s9, s9, 3584
  s_cmp_eq_u32 s9, 57344
  s_cselect_b32 s9, 0, s9
  s_add_u32 s10, s8, s9
  v_mfma_f32_32x32x16_bf16 v[144:159], v[192:195], v[56:59], 0
  v_exp_f32 v128, v128
  v_exp_f32 v129, v129
  v_exp_f32 v130, v130
  v_mfma_f32_32x32x16_bf16 v[144:159], v[196:199], v[60:63], v[144:159]
  v_exp_f32 v131, v131
  v_exp_f32 v132, v132
  v_exp_f32 v133, v133
  v_mfma_f32_32x32x16_bf16 v[80:95], v[224:227], v[168:171], v[80:95]
  v_exp_f32 v134, v134
  v_exp_f32 v135, v135
  v_exp_f32 v136, v136
  v_mfma_f32_32x32x16_bf16 v[80:95], v[228:231], v[172:175], v[80:95]
  v_exp_f32 v137, v137
  v_exp_f32 v138, v138
  v_exp_f32 v139, v139
  v_exp_f32 v140, v140
  v_exp_f32 v141, v141
  v_exp_f32 v142, v142
  v_exp_f32 v143, v143
  v_cvt_pk_bf16_f32 v160, v128, v129
  v_cvt_pk_bf16_f32 v161, v130, v131
  v_cvt_pk_bf16_f32 v162, v132, v133
  v_cvt_pk_bf16_f32 v163, v134, v135
  v_cvt_pk_bf16_f32 v164, v136, v137
  v_cvt_pk_bf16_f32 v165, v138, v139
  v_cvt_pk_bf16_f32 v166, v140, v141
  v_cvt_pk_bf16_f32 v167, v142, v143
  s_waitcnt vmcnt(14)
  v_mfma_f32_32x32x16_bf16 v[128:143], v[200:203], v[32:35], 0
  v_exp_f32 v144, v144
  v_exp_f32 v145, v145
  v_exp_f32 v146, v146
  v_mfma_f32_32x32x16_bf16 v[128:143], v[204:207], v[36:39], v[128:143]
  v_exp_f32 v147, v147
  v_exp_f32 v148, v148
  v_exp_f32 v149, v149
  v_mfma_f32_32x32x16_bf16 v[96:111], v[224:227], v[160:163], v[96:111]
  v_exp_f32 v150, v150
  v_exp_f32 v151, v151
  v_exp_f32 v152, v152
  v_mfma_f32_32x32x16_bf16 v[96:111], v[228:231], v[164:167], v[96:111]
  v_exp_f32 v153, v153
  v_exp_f32 v154, v154
  v_exp_f32 v155, v155
  v_exp_f32 v156, v156
  v_exp_f32 v157, v157
  v_exp_f32 v158, v158
  v_exp_f32 v159, v159
  v_cvt_pk_bf16_f32 v168, v144, v145
  v_cvt_pk_bf16_f32 v169, v146, v147
  v_cvt_pk_bf16_f32 v170, v148, v149
  v_cvt_pk_bf16_f32 v171, v150, v151
  v_cvt_pk_bf16_f32 v172, v152, v153
  v_cvt_pk_bf16_f32 v173, v154, v155
  v_cvt_pk_bf16_f32 v174, v156, v157
  v_cvt_pk_bf16_f32 v175, v158, v159
  v_mfma_f32_32x32x16_bf16 v[144:159], v[200:203], v[40:43], 0
  v_exp_f32 v128, v128
  v_exp_f32 v129, v129
  v_exp_f32 v130, v130
  v_mfma_f32_32x32x16_bf16 v[144:159], v[204:207], v[44:47], v[144:159]
  v_exp_f32 v131, v131
  v_exp_f32 v132, v132
  v_exp_f32 v133, v133
  v_mfma_f32_32x32x16_bf16 v[112:127], v[224:227], v[168:171], v[112:127]
  v_exp_f32 v134, v134
  v_exp_f32 v135, v135
  v_exp_f32 v136, v136
  v_mfma_f32_32x32x16_bf16 v[112:127], v[228:231], v[172:175], v[112:127]
  v_exp_f32 v137, v137
  v_exp_f32 v138, v138
  v_exp_f32 v139, v139
  v_exp_f32 v140, v140
  v_exp_f32 v141, v141
  v_exp_f32 v142, v142
  v_exp_f32 v143, v143
  v_cvt_pk_bf16_f32 v160, v128, v129
  v_cvt_pk_bf16_f32 v161, v130, v131
  v_cvt_pk_bf16_f32 v162, v132, v133
  v_cvt_pk_bf16_f32 v163, v134, v135
  v_cvt_pk_bf16_f32 v164, v136, v137
  v_cvt_pk_bf16_f32 v165, v138, v139
  v_cvt_pk_bf16_f32 v166, v140, v141
  v_cvt_pk_bf16_f32 v167, v142, v143
  s_waitcnt vmcnt(12)
  v_mfma_f32_32x32x16_bf16 v[128:143], v[200:203], v[48:51], 0
  v_exp_f32 v144, v144
  v_exp_f32 v145, v145
  v_exp_f32 v146, v146
  v_mfma_f32_32x32x16_bf16 v[128:143], v[204:207], v[52:55], v[128:143]
  v_exp_f32 v147, v147
  v_exp_f32 v148, v148
  v_exp_f32 v149, v149
  v_mfma_f32_32x32x16_bf16 v[64:79], v[232:235], v[160:163], v[64:79]
  v_exp_f32 v150, v150
  v_exp_f32 v151, v151
  v_exp_f32 v152, v152
  v_mfma_f32_32x32x16_bf16 v[64:79], v[236:239], v[164:167], v[64:79]
  v_exp_f32 v153, v153
  v_exp_f32 v154, v154
  v_exp_f32 v155, v155
  v_exp_f32 v156, v156
  v_exp_f32 v157, v157
  v_exp_f32 v158, v158
  v_exp_f32 v159, v159
  v_cvt_pk_bf16_f32 v168, v144, v145
  v_cvt_pk_bf16_f32 v169, v146, v147
  v_cvt_pk_bf16_f32 v170, v148, v149
  v_cvt_pk_bf16_f32 v171, v150, v151
  v_cvt_pk_bf16_f32 v172, v152, v153
  v_cvt_pk_bf16_f32 v173, v154, v155
  v_cvt_pk_bf16_f32 v174, v156, v157
  v_cvt_pk_bf16_f32 v175, v158, v159
  buffer_load_dwordx2 v[192:193], v28, s[28:31], s10 offen offset:0 sc1
  buffer_load_dwordx2 v[194:195], v28, s[28:31], s10 offen offset:512 sc1
  buffer_load_dwordx2 v[196:197], v28, s[28:31], s10 offen offset:1024 sc1
  s_mov_b32 exec_hi, 0
  buffer_load_dwordx2 v[198:199], v28, s[28:31], s10 offen offset:1536 sc1
  s_mov_b64 exec, s[20:21]
  buffer_load_dwordx4 v[224:227], v31, s[28:31], s10 offen offset:1792 sc1
  buffer_load_dwordx4 v[228:231], v31, s[28:31], s10 offen offset:2688 sc1
  s_mov_b64 exec, -1
  s_add_u32 s9, s9, 3584
  s_cmp_eq_u32 s9, 57344
  s_cselect_b32 s9, 0, s9
  s_add_u32 s10, s8, s9
  v_mfma_f32_32x32x16_bf16 v[144:159], v[200:203], v[56:59], 0
  v_exp_f32 v128, v128
  v_exp_f32 v129, v129
  v_exp_f32 v130, v130
  v_mfma_f32_32x32x16_bf16 v[144:159], v[204:207], v[60:63], v[144:159]
  v_exp_f32 v131, v131
  v_exp_f32 v132, v132
  v_exp_f32 v133, v133
  v_mfma_f32_32x32x16_bf16 v[80:95], v[232:235], v[168:171], v[80:95]
  v_exp_f32 v134, v134
  v_exp_f32 v135, v135
  v_exp_f32 v136, v136
  v_mfma_f32_32x32x16_bf16 v[80:95], v[236:239], v[172:175], v[80:95]
  v_exp_f32 v137, v137
  v_exp_f32 v138, v138
  v_exp_f32 v139, v139
  v_exp_f32 v140, v140
  v_exp_f32 v141, v141
  v_exp_f32 v142, v142
  v_exp_f32 v143, v143
  v_cvt_pk_bf16_f32 v160, v128, v129
  v_cvt_pk_bf16_f32 v161, v130, v131
  v_cvt_pk_bf16_f32 v162, v132, v133
  v_cvt_pk_bf16_f32 v163, v134, v135
  v_cvt_pk_bf16_f32 v164, v136, v137
  v_cvt_pk_bf16_f32 v165, v138, v139
  v_cvt_pk_bf16_f32 v166, v140, v141
  v_cvt_pk_bf16_f32 v167, v142, v143
  s_waitcnt vmcnt(14)
  v_mfma_f32_32x32x16_bf16 v[128:143], v[176:179], v[32:35], 0
  v_exp_f32 v144, v144
  v_exp_f32 v145, v145
  v_exp_f32 v146, v146
  v_mfma_f32_32x32x16_bf16 v[128:143], v[180:183], v[36:39], v[128:143]
  v_exp_f32 v147, v147
  v_exp_f32 v148, v148
  v_exp_f32 v149, v149
  v_mfma_f32_32x32x16_bf16 v[96:111], v[232:235], v[160:163], v[96:111]
  v_exp_f32 v150, v150
  v_exp_f32 v151, v151
  v_exp_f32 v152, v152
  v_mfma_f32_32x32x16_bf16 v[96:111], v[236:239], v[164:167], v[96:111]
  v_exp_f32 v153, v153
  v_exp_f32 v154, v154
  v_exp_f32 v155, v155
  v_exp_f32 v156, v156
  v_exp_f32 v157, v157
  v_exp_f32 v158, v158
  v_exp_f32 v159, v159
  v_cvt_pk_bf16_f32 v168, v144, v145
  v_cvt_pk_bf16_f32 v169, v146, v147
  v_cvt_pk_bf16_f32 v170, v148, v149
  v_cvt_pk_bf16_f32 v171, v150, v151
  v_cvt_pk_bf16_f32 v172, v152, v153
  v_cvt_pk_bf16_f32 v173, v154, v155
  v_cvt_pk_bf16_f32 v174, v156, v157
  v_cvt_pk_bf16_f32 v175, v158, v159
  v_mfma_f32_32x32x16_bf16 v[144:159], v[176:179], v[40:43], 0
  v_exp_f32 v128, v128
  v_exp_f32 v129, v129
  v_exp_f32 v130, v130
  v_mfma_f32_32x32x16_bf16 v[144:159], v[180:183], v[44:47], v[144:159]
  v_exp_f32 v131, v131
  v_exp_f32 v132, v132
  v_exp_f32 v133, v133
  v_mfma_f32_32x32x16_bf16 v[112:127], v[232:235], v[168:171], v[112:127]
  v_exp_f32 v134, v134
  v_exp_f32 v135, v135
  v_exp_f32 v136, v136
  v_mfma_f32_32x32x16_bf16 v[112:127], v[236:239], v[172:175], v[112:127]
  v_exp_f32 v137, v137
  v_exp_f32 v138, v138
  v_exp_f32 v139, v139
  v_exp_f32 v140, v140
  v_exp_f32 v141, v141
  v_exp_f32 v142, v142
  v_exp_f32 v143, v143
  v_cvt_pk_bf16_f32 v160, v128, v129
  v_cvt_pk_bf16_f32 v161, v130, v131
  v_cvt_pk_bf16_f32 v162, v132, v133
  v_cvt_pk_bf16_f32 v163, v134, v135
  v_cvt_pk_bf16_f32 v164, v136, v137
  v_cvt_pk_bf16_f32 v165, v138, v139
  v_cvt_pk_bf16_f32 v166, v140, v141
  v_cvt_pk_bf16_f32 v167, v142, v143
  s_waitcnt vmcnt(12)
  v_mfma_f32_32x32x16_bf16 v[128:143], v[176:179], v[48:51], 0
  v_exp_f32 v144, v144
  v_exp_f32 v145, v145
  v_exp_f32 v146, v146
  v_mfma_f32_32x32x16_bf16 v[128:143], v[180:183], v[52:55], v[128:143]
  v_exp_f32 v147, v147
  v_exp_f32 v148, v148
  v_exp_f32 v149, v149
  v_mfma_f32_32x32x16_bf16 v[64:79], v[208:211], v[160:163], v[64:79]
  v_exp_f32 v150, v150
  v_exp_f32 v151, v151
  v_exp_f32 v152, v152
  v_mfma_f32_32x32x16_bf16 v[64:79], v[212:215], v[164:167], v[64:79]
  v_exp_f32 v153, v153
  v_exp_f32 v154, v154
  v_exp_f32 v155, v155
  v_exp_f32 v156, v156
  v_exp_f32 v157, v157
  v_exp_f32 v158, v158
  v_exp_f32 v159, v159
  v_cvt_pk_bf16_f32 v168, v144, v145
  v_cvt_pk_bf16_f32 v169, v146, v147
  v_cvt_pk_bf16_f32 v170, v148, v149
  v_cvt_pk_bf16_f32 v171, v150, v151
  v_cvt_pk_bf16_f32 v172, v152, v153
  v_cvt_pk_bf16_f32 v173, v154, v155
  v_cvt_pk_bf16_f32 v174, v156, v157
  v_cvt_pk_bf16_f32 v175, v158, v159
  buffer_load_dwordx2 v[200:201], v28, s[28:31], s10 offen offset:0 sc1
  buffer_load_dwordx2 v[202:203], v28, s[28:31], s10 offen offset:512 sc1
  buffer_load_dwordx2 v[204:205], v28, s[28:31], s10 offen offset:1024 sc1
  s_mov_b32 exec_hi, 0
  buffer_load_dwordx2 v[206:207], v28, s[28:31], s10 offen offset:1536 sc1
  s_mov_b64 exec, s[20:21]
  buffer_load_dwordx4 v[232:235], v31, s[28:31], s10 offen offset:1792 sc1
  buffer_load_dwordx4 v[236:239], v31, s[28:31], s10 offen offset:2688 sc1
  s_mov_b64 exec, -1
  s_add_u32 s9, s9, 3584
  s_cmp_eq_u32 s9, 57344
  s_cselect_b32 s9, 0, s9
  s_add_u32 s10, s8, s9
  v_mfma_f32_32x32x16_bf16 v[144:159], v[176:179], v[56:59], 0
  v_exp_f32 v128, v128
  v_exp_f32 v129, v129
  v_exp_f32 v130, v130
  v_mfma_f32_32x32x16_bf16 v[144:159], v[180:183], v[60:63], v[144:159]
  v_exp_f32 v131, v131
  v_exp_f32 v132, v132
  v_exp_f32 v133, v133
  v_mfma_f32_32x32x16_bf16 v[80:95], v[208:211], v[168:171], v[80:95]
  v_exp_f32 v134, v134
  v_exp_f32 v135, v135
  v_exp_f32 v136, v136
  v_mfma_f32_32x32x16_bf16 v[80:95], v[212:215], v[172:175], v[80:95]
  v_exp_f32 v137, v137
  v_exp_f32 v138, v138
  v_exp_f32 v139, v139
  v_exp_f32 v140, v140
  v_exp_f32 v141, v141
  v_exp_f32 v142, v142
  v_exp_f32 v143, v143
  v_cvt_pk_bf16_f32 v160, v128, v129
  v_cvt_pk_bf16_f32 v161, v130, v131
  v_cvt_pk_bf16_f32 v162, v132, v133
  v_cvt_pk_bf16_f32 v163, v134, v135
  v_cvt_pk_bf16_f32 v164, v136, v137
  v_cvt_pk_bf16_f32 v165, v138, v139
  v_cvt_pk_bf16_f32 v166, v140, v141
  v_cvt_pk_bf16_f32 v167, v142, v143
  s_waitcnt vmcnt(14)
  v_mfma_f32_32x32x16_bf16 v[128:143], v[184:187], v[32:35], 0
  v_exp_f32 v144, v144
  v_exp_f32 v145, v145
  v_exp_f32 v146, v146
  v_mfma_f32_32x32x16_bf16 v[128:143], v[188:191], v[36:39], v[128:143]
  v_exp_f32 v147, v147
  v_exp_f32 v148, v148
  v_exp_f32 v149, v149
  v_mfma_f32_32x32x16_bf16 v[96:111], v[208:211], v[160:163], v[96:111]
  v_exp_f32 v150, v150
  v_exp_f32 v151, v151
  v_exp_f32 v152, v152
  v_mfma_f32_32x32x16_bf16 v[96:111], v[212:215], v[164:167], v[96:111]
  v_exp_f32 v153, v153
  v_exp_f32 v154, v154
  v_exp_f32 v155, v155
  v_exp_f32 v156, v156
  v_exp_f32 v157, v157
  v_exp_f32 v158, v158
  v_exp_f32 v159, v159
  v_cvt_pk_bf16_f32 v168, v144, v145
  v_cvt_pk_bf16_f32 v169, v146, v147
  v_cvt_pk_bf16_f32 v170, v148, v149
  v_cvt_pk_bf16_f32 v171, v150, v151
  v_cvt_pk_bf16_f32 v172, v152, v153
  v_cvt_pk_bf16_f32 v173, v154, v155
  v_cvt_pk_bf16_f32 v174, v156, v157
  v_cvt_pk_bf16_f32 v175, v158, v159
  v_mfma_f32_32x32x16_bf16 v[144:159], v[184:187], v[40:43], 0
  v_exp_f32 v128, v128
  v_exp_f32 v129, v129
  v_exp_f32 v130, v130
  v_mfma_f32_32x32x16_bf16 v[144:159], v[188:191], v[44:47], v[144:159]
  v_exp_f32 v131, v131
  v_exp_f32 v132, v132
  v_exp_f32 v133, v133
  v_mfma_f32_32x32x16_bf16 v[112:127], v[208:211], v[168:171], v[112:127]
  v_exp_f32 v134, v134
  v_exp_f32 v135, v135
  v_exp_f32 v136, v136
  v_mfma_f32_32x32x16_bf16 v[112:127], v[212:215], v[172:175], v[112:127]
  v_exp_f32 v137, v137
  v_exp_f32 v138, v138
  v_exp_f32 v139, v139
  v_exp_f32 v140, v140
  v_exp_f32 v141, v141
  v_exp_f32 v142, v142
  v_exp_f32 v143, v143
  v_cvt_pk_bf16_f32 v160, v128, v129
  v_cvt_pk_bf16_f32 v161, v130, v131
  v_cvt_pk_bf16_f32 v162, v132, v133
  v_cvt_pk_bf16_f32 v163, v134, v135
  v_cvt_pk_bf16_f32 v164, v136, v137
  v_cvt_pk_bf16_f32 v165, v138, v139
  v_cvt_pk_bf16_f32 v166, v140, v141
  v_cvt_pk_bf16_f32 v167, v142, v143
  s_waitcnt vmcnt(12)
  v_mfma_f32_32x32x16_bf16 v[128:143], v[184:187], v[48:51], 0
  v_exp_f32 v144, v144
  v_exp_f32 v145, v145
  v_exp_f32 v146, v146
  v_mfma_f32_32x32x16_bf16 v[128:143], v[188:191], v[52:55], v[128:143]
  v_exp_f32 v147, v147
  v_exp_f32 v148, v148
  v_exp_f32 v149, v149
  v_mfma_f32_32x32x16_bf16 v[64:79], v[216:219], v[160:163], v[64:79]
  v_exp_f32 v150, v150
  v_exp_f32 v151, v151
  v_exp_f32 v152, v152
  v_mfma_f32_32x32x16_bf16 v[64:79], v[220:223], v[164:167], v[64:79]
  v_exp_f32 v153, v153
  v_exp_f32 v154, v154
  v_exp_f32 v155, v155
  v_exp_f32 v156, v156
  v_exp_f32 v157, v157
  v_exp_f32 v158, v158
  v_exp_f32 v159, v159
  v_cvt_pk_bf16_f32 v168, v144, v145
  v_cvt_pk_bf16_f32 v169, v146, v147
  v_cvt_pk_bf16_f32 v170, v148, v149
  v_cvt_pk_bf16_f32 v171, v150, v151
  v_cvt_pk_bf16_f32 v172, v152, v153
  v_cvt_pk_bf16_f32 v173, v154, v155
  v_cvt_pk_bf16_f32 v174, v156, v157
  v_cvt_pk_bf16_f32 v175, v158, v159
  v_mfma_f32_32x32x16_bf16 v[144:159], v[184:187], v[56:59], 0
  v_exp_f32 v128, v128
  v_exp_f32 v129, v129
  v_exp_f32 v130, v130
  v_mfma_f32_32x32x16_bf16 v[144:159], v[188:191], v[60:63], v[144:159]
  v_exp_f32 v131, v131
  v_exp_f32 v132, v132
  v_exp_f32 v133, v133
  v_mfma_f32_32x32x16_bf16 v[80:95], v[216:219], v[168:171], v[80:95]
  v_exp_f32 v134, v134
  v_exp_f32 v135, v135
  v_exp_f32 v136, v136
  v_mfma_f32_32x32x16_bf16 v[80:95], v[220:223], v[172:175], v[80:95]
  v_exp_f32 v137, v137
  v_exp_f32 v138, v138
  v_exp_f32 v139, v139
  v_exp_f32 v140, v140
  v_exp_f32 v141, v141
  v_exp_f32 v142, v142
  v_exp_f32 v143, v143
  v_cvt_pk_bf16_f32 v160, v128, v129
  v_cvt_pk_bf16_f32 v161, v130, v131
  v_cvt_pk_bf16_f32 v162, v132, v133
  v_cvt_pk_bf16_f32 v163, v134, v135
  v_cvt_pk_bf16_f32 v164, v136, v137
  v_cvt_pk_bf16_f32 v165, v138, v139
  v_cvt_pk_bf16_f32 v166, v140, v141
  v_cvt_pk_bf16_f32 v167, v142, v143
  s_waitcnt vmcnt(8)
  v_mfma_f32_32x32x16_bf16 v[128:143], v[192:195], v[32:35], 0
  v_exp_f32 v144, v144
  v_exp_f32 v145, v145
  v_exp_f32 v146, v146
  v_mfma_f32_32x32x16_bf16 v[128:143], v[196:199], v[36:39], v[128:143]
  v_exp_f32 v147, v147
  v_exp_f32 v148, v148
  v_exp_f32 v149, v149
  v_mfma_f32_32x32x16_bf16 v[96:111], v[216:219], v[160:163], v[96:111]
  v_exp_f32 v150, v150
  v_exp_f32 v151, v151
  v_exp_f32 v152, v152
  v_mfma_f32_32x32x16_bf16 v[96:111], v[220:223], v[164:167], v[96:111]
  v_exp_f32 v153, v153
  v_exp_f32 v154, v154
  v_exp_f32 v155, v155
  v_exp_f32 v156, v156
  v_exp_f32 v157, v157
  v_exp_f32 v158, v158
  v_exp_f32 v159, v159
  v_cvt_pk_bf16_f32 v168, v144, v145
  v_cvt_pk_bf16_f32 v169, v146, v147
  v_cvt_pk_bf16_f32 v170, v148, v149
  v_cvt_pk_bf16_f32 v171, v150, v151
  v_cvt_pk_bf16_f32 v172, v152, v153
  v_cvt_pk_bf16_f32 v173, v154, v155
  v_cvt_pk_bf16_f32 v174, v156, v157
  v_cvt_pk_bf16_f32 v175, v158, v159
  v_mfma_f32_32x32x16_bf16 v[144:159], v[192:195], v[40:43], 0
  v_exp_f32 v128, v128
  v_exp_f32 v129, v129
  v_exp_f32 v130, v130
  v_mfma_f32_32x32x16_bf16 v[144:159], v[196:199], v[44:47], v[144:159]
  v_exp_f32 v131, v131
  v_exp_f32 v132, v132
  v_exp_f32 v133, v133
  v_mfma_f32_32x32x16_bf16 v[112:127], v[216:219], v[168:171], v[112:127]
  v_exp_f32 v134, v134
  v_exp_f32 v135, v135
  v_exp_f32 v136, v136
  v_mfma_f32_32x32x16_bf16 v[112:127], v[220:223], v[172:175], v[112:127]
  v_exp_f32 v137, v137
  v_exp_f32 v138, v138
  v_exp_f32 v139, v139
  v_exp_f32 v140, v140
  v_exp_f32 v141, v141
  v_exp_f32 v142, v142
  v_exp_f32 v143, v143
  v_cvt_pk_bf16_f32 v160, v128, v129
  v_cvt_pk_bf16_f32 v161, v130, v131
  v_cvt_pk_bf16_f32 v162, v132, v133
  v_cvt_pk_bf16_f32 v163, v134, v135
  v_cvt_pk_bf16_f32 v164, v136, v137
  v_cvt_pk_bf16_f32 v165, v138, v139
  v_cvt_pk_bf16_f32 v166, v140, v141
  v_cvt_pk_bf16_f32 v167, v142, v143
  s_waitcnt vmcnt(6)
  v_mfma_f32_32x32x16_bf16 v[128:143], v[192:195], v[48:51], 0
  v_exp_f32 v144, v144
  v_exp_f32 v145, v145
  v_exp_f32 v146, v146
  v_mfma_f32_32x32x16_bf16 v[128:143], v[196:199], v[52:55], v[128:143]
  v_exp_f32 v147, v147
  v_exp_f32 v148, v148
  v_exp_f32 v149, v149
  v_mfma_f32_32x32x16_bf16 v[64:79], v[224:227], v[160:163], v[64:79]
  v_exp_f32 v150, v150
  v_exp_f32 v151, v151
  v_exp_f32 v152, v152
  v_mfma_f32_32x32x16_bf16 v[64:79], v[228:231], v[164:167], v[64:79]
  v_exp_f32 v153, v153
  v_exp_f32 v154, v154
  v_exp_f32 v155, v155
  v_exp_f32 v156, v156
  v_exp_f32 v157, v157
  v_exp_f32 v158, v158
  v_exp_f32 v159, v159
  v_cvt_pk_bf16_f32 v168, v144, v145
  v_cvt_pk_bf16_f32 v169, v146, v147
  v_cvt_pk_bf16_f32 v170, v148, v149
  v_cvt_pk_bf16_f32 v171, v150, v151
  v_cvt_pk_bf16_f32 v172, v152, v153
  v_cvt_pk_bf16_f32 v173, v154, v155
  v_cvt_pk_bf16_f32 v174, v156, v157
  v_cvt_pk_bf16_f32 v175, v158, v159
  v_mfma_f32_32x32x16_bf16 v[144:159], v[192:195], v[56:59], 0
  v_exp_f32 v128, v128
  v_exp_f32 v129, v129
  v_exp_f32 v130, v130
  v_mfma_f32_32x32x16_bf16 v[144:159], v[196:199], v[60:63], v[144:159]
  v_exp_f32 v131, v131
  v_exp_f32 v132, v132
  v_exp_f32 v133, v133
  v_mfma_f32_32x32x16_bf16 v[80:95], v[224:227], v[168:171], v[80:95]
  v_exp_f32 v134, v134
  v_exp_f32 v135, v135
  v_exp_f32 v136, v136
  v_mfma_f32_32x32x16_bf16 v[80:95], v[228:231], v[172:175], v[80:95]
  v_exp_f32 v137, v137
  v_exp_f32 v138, v138
  v_exp_f32 v139, v139
  v_exp_f32 v140, v140
  v_exp_f32 v141, v141
  v_exp_f32 v142, v142
  v_exp_f32 v143, v143
  v_cvt_pk_bf16_f32 v160, v128, v129
  v_cvt_pk_bf16_f32 v161, v130, v131
  v_cvt_pk_bf16_f32 v162, v132, v133
  v_cvt_pk_bf16_f32 v163, v134, v135
  v_cvt_pk_bf16_f32 v164, v136, v137
  v_cvt_pk_bf16_f32 v165, v138, v139
  v_cvt_pk_bf16_f32 v166, v140, v141
  v_cvt_pk_bf16_f32 v167, v142, v143
  s_waitcnt vmcnt(2)
  v_mfma_f32_32x32x16_bf16 v[128:143], v[200:203], v[32:35], 0
  v_exp_f32 v144, v144
  v_exp_f32 v145, v145
  v_exp_f32 v146, v146
  v_mfma_f32_32x32x16_bf16 v[128:143], v[204:207], v[36:39], v[128:143]
  v_exp_f32 v147, v147
  v_exp_f32 v148, v148
  v_exp_f32 v149, v149
  v_mfma_f32_32x32x16_bf16 v[96:111], v[224:227], v[160:163], v[96:111]
  v_exp_f32 v150, v150
  v_exp_f32 v151, v151
  v_exp_f32 v152, v152
  v_mfma_f32_32x32x16_bf16 v[96:111], v[228:231], v[164:167], v[96:111]
  v_exp_f32 v153, v153
  v_exp_f32 v154, v154
  v_exp_f32 v155, v155
  v_exp_f32 v156, v156
  v_exp_f32 v157, v157
  v_exp_f32 v158, v158
  v_exp_f32 v159, v159
  v_cvt_pk_bf16_f32 v168, v144, v145
  v_cvt_pk_bf16_f32 v169, v146, v147
  v_cvt_pk_bf16_f32 v170, v148, v149
  v_cvt_pk_bf16_f32 v171, v150, v151
  v_cvt_pk_bf16_f32 v172, v152, v153
  v_cvt_pk_bf16_f32 v173, v154, v155
  v_cvt_pk_bf16_f32 v174, v156, v157
  v_cvt_pk_bf16_f32 v175, v158, v159
  v_mfma_f32_32x32x16_bf16 v[144:159], v[200:203], v[40:43], 0
  v_exp_f32 v128, v128
  v_exp_f32 v129, v129
  v_exp_f32 v130, v130
  v_mfma_f32_32x32x16_bf16 v[144:159], v[204:207], v[44:47], v[144:159]
  v_exp_f32 v131, v131
  v_exp_f32 v132, v132
  v_exp_f32 v133, v133
  v_mfma_f32_32x32x16_bf16 v[112:127], v[224:227], v[168:171], v[112:127]
  v_exp_f32 v134, v134
  v_exp_f32 v135, v135
  v_exp_f32 v136, v136
  v_mfma_f32_32x32x16_bf16 v[112:127], v[228:231], v[172:175], v[112:127]
  v_exp_f32 v137, v137
  v_exp_f32 v138, v138
  v_exp_f32 v139, v139
  v_exp_f32 v140, v140
  v_exp_f32 v141, v141
  v_exp_f32 v142, v142
  v_exp_f32 v143, v143
  v_cvt_pk_bf16_f32 v160, v128, v129
  v_cvt_pk_bf16_f32 v161, v130, v131
  v_cvt_pk_bf16_f32 v162, v132, v133
  v_cvt_pk_bf16_f32 v163, v134, v135
  v_cvt_pk_bf16_f32 v164, v136, v137
  v_cvt_pk_bf16_f32 v165, v138, v139
  v_cvt_pk_bf16_f32 v166, v140, v141
  v_cvt_pk_bf16_f32 v167, v142, v143
  s_waitcnt vmcnt(0)
  v_mfma_f32_32x32x16_bf16 v[128:143], v[200:203], v[48:51], 0
  v_exp_f32 v144, v144
  v_exp_f32 v145, v145
  v_exp_f32 v146, v146
  v_mfma_f32_32x32x16_bf16 v[128:143], v[204:207], v[52:55], v[128:143]
  v_exp_f32 v147, v147
  v_exp_f32 v148, v148
  v_exp_f32 v149, v149
  v_mfma_f32_32x32x16_bf16 v[64:79], v[232:235], v[160:163], v[64:79]
  v_exp_f32 v150, v150
  v_exp_f32 v151, v151
  v_exp_f32 v152, v152
  v_mfma_f32_32x32x16_bf16 v[64:79], v[236:239], v[164:167], v[64:79]
  v_exp_f32 v153, v153
  v_exp_f32 v154, v154
  v_exp_f32 v155, v155
  v_exp_f32 v156, v156
  v_exp_f32 v157, v157
  v_exp_f32 v158, v158
  v_exp_f32 v159, v159
  v_cvt_pk_bf16_f32 v168, v144, v145
  v_cvt_pk_bf16_f32 v169, v146, v147
  v_cvt_pk_bf16_f32 v170, v148, v149
  v_cvt_pk_bf16_f32 v171, v150, v151
  v_cvt_pk_bf16_f32 v172, v152, v153
  v_cvt_pk_bf16_f32 v173, v154, v155
  v_cvt_pk_bf16_f32 v174, v156, v157
  v_cvt_pk_bf16_f32 v175, v158, v159
  v_mfma_f32_32x32x16_bf16 v[144:159], v[200:203], v[56:59], 0
  v_exp_f32 v128, v128
  v_exp_f32 v129, v129
  v_exp_f32 v130, v130
  v_mfma_f32_32x32x16_bf16 v[144:159], v[204:207], v[60:63], v[144:159]
  v_exp_f32 v131, v131
  v_exp_f32 v132, v132
  v_exp_f32 v133, v133
  v_mfma_f32_32x32x16_bf16 v[80:95], v[232:235], v[168:171], v[80:95]
  v_exp_f32 v134, v134
  v_exp_f32 v135, v135
  v_exp_f32 v136, v136
  v_mfma_f32_32x32x16_bf16 v[80:95], v[236:239], v[172:175], v[80:95]
  v_exp_f32 v137, v137
  v_exp_f32 v138, v138
  v_exp_f32 v139, v139
  v_exp_f32 v140, v140
  v_exp_f32 v141, v141
  v_exp_f32 v142, v142
  v_exp_f32 v143, v143
  v_cvt_pk_bf16_f32 v160, v128, v129
  v_cvt_pk_bf16_f32 v161, v130, v131
  v_cvt_pk_bf16_f32 v162, v132, v133
  v_cvt_pk_bf16_f32 v163, v134, v135
  v_cvt_pk_bf16_f32 v164, v136, v137
  v_cvt_pk_bf16_f32 v165, v138, v139
  v_cvt_pk_bf16_f32 v166, v140, v141
  v_cvt_pk_bf16_f32 v167, v142, v143
  v_mfma_f32_32x32x16_bf16 v[96:111], v[232:235], v[160:163], v[96:111]
  v_exp_f32 v144, v144
  v_exp_f32 v145, v145
  v_exp_f32 v146, v146
  v_mfma_f32_32x32x16_bf16 v[96:111], v[236:239], v[164:167], v[96:111]
  v_exp_f32 v147, v147
  v_exp_f32 v148, v148
  v_exp_f32 v149, v149
  v_exp_f32 v150, v150
  v_exp_f32 v151, v151
  v_exp_f32 v152, v152
  v_exp_f32 v153, v153
  v_exp_f32 v154, v154
  v_exp_f32 v155, v155
  v_exp_f32 v156, v156
  v_exp_f32 v157, v157
  v_exp_f32 v158, v158
  v_exp_f32 v159, v159
  v_cvt_pk_bf16_f32 v168, v144, v145
  v_cvt_pk_bf16_f32 v169, v146, v147
  v_cvt_pk_bf16_f32 v170, v148, v149
  v_cvt_pk_bf16_f32 v171, v150, v151
  v_cvt_pk_bf16_f32 v172, v152, v153
  v_cvt_pk_bf16_f32 v173, v154, v155
  v_cvt_pk_bf16_f32 v174, v156, v157
  v_cvt_pk_bf16_f32 v175, v158, v159
  s_nop 1
  v_mfma_f32_32x32x16_bf16 v[112:127], v[232:235], v[168:171], v[112:127]
  v_mfma_f32_32x32x16_bf16 v[112:127], v[236:239], v[172:175], v[112:127]
Lp20:
  ds_read_b128 v[128:131], v11 offset:16
  s_waitcnt lgkmcnt(0)
  v_min_u32 v132, v128, v129
  v_min3_u32 v132, v132, v130, v131
  s_nop 0
  v_readfirstlane_b32 s58, v132
  s_cmp_ge_u32 s58, 23
  s_cbranch_scc1 Ld21
  s_sub_u32 s54, s54, 1
  s_cmp_gt_i32 s54, 0
  s_cbranch_scc1 Lp20
Ld21:
  ds_write_b128 v20, v[80:83] offset:0
  ds_write_b128 v20, v[84:87] offset:1024
  ds_write_b128 v20, v[88:91] offset:2048
  ds_write_b128 v20, v[92:95] offset:3072
  ds_write_b128 v20, v[96:99] offset:4096
  ds_write_b128 v20, v[100:103] offset:5120
  ds_write_b128 v20, v[104:107] offset:6144
  ds_write_b128 v20, v[108:111] offset:7168
  v_mov_b32 v4, 0x53800000
  v_mov_b32 v7, 0x2b800000
  v_add_f32 v5, v76, v92
  v_min3_f32 v6, v76, v92, v108
  v_add_f32 v5, v5, v108
  ds_write_b128 v20, v[112:115] offset:8192
  ds_write_b128 v20, v[116:119] offset:9216
  ds_write_b128 v20, v[120:123] offset:10240
  ds_write_b128 v20, v[124:127] offset:11264
  v_add_f32 v5, v5, v124
  v_min_f32 v6, v6, v124
  v_cmp_nle_f32 vcc, v5, v4
  v_cmp_nge_f32 s[56:57], v6, v7
  s_nop 1
  s_or_b32 s55, s57, vcc_hi
  s_cmp_lg_u32 s55, 0
  s_cselect_b32 s55, 2, 1
  v_mov_b32 v3, s55
  ds_write_b32 v22, v3
Lp22:
  ds_read_b128 v[128:131], v21 offset:0
  s_waitcnt lgkmcnt(0)
  v_min_u32 v132, v128, v129
  v_min3_u32 v132, v132, v130, v131
  s_nop 0
  v_readfirstlane_b32 s58, v132
  s_cmp_ge_u32 s58, 1
  s_cbranch_scc1 Ld23
  s_sub_u32 s54, s54, 1
  s_cmp_gt_i32 s54, 0
  s_cbranch_scc1 Lp22
Ld23:
  ds_read_b128 v[144:147], v17 offset:0
  ds_read_b128 v[148:151], v17 offset:1024
  ds_read_b128 v[152:155], v17 offset:2048
  ds_read_b128 v[156:159], v17 offset:3072
  ds_read_b128 v[160:163], v18 offset:0
  ds_read_b128 v[164:167], v18 offset:1024
  ds_read_b128 v[168:171], v18 offset:2048
  ds_read_b128 v[172:175], v18 offset:3072
  ds_read_b128 v[176:179], v19 offset:0
  ds_read_b128 v[180:183], v19 offset:1024
  ds_read_b128 v[184:187], v19 offset:2048
  ds_read_b128 v[188:191], v19 offset:3072
  v_or3_b32 v3, v128, v129, v130
  v_or_b32 v3, v3, v131
  s_nop 0
  v_readfirstlane_b32 s55, v3
  s_andn2_b32 s55, s55, s11
  s_bitcmp1_b32 s55, 1
  s_cbranch_scc1 f_fallback
  s_waitcnt lgkmcnt(8)
  v_add_f32 v64, v64, v144
  v_add_f32 v65, v65, v145
  v_add_f32 v66, v66, v146
  v_add_f32 v67, v67, v147
  v_add_f32 v68, v68, v148
  v_add_f32 v69, v69, v149
  v_add_f32 v70, v70, v150
  v_add_f32 v71, v71, v151
  v_add_f32 v72, v72, v152
  v_add_f32 v73, v73, v153
  v_add_f32 v74, v74, v154
  v_add_f32 v75, v75, v155
  v_add_f32 v76, v76, v156
  v_add_f32 v77, v77, v157
  v_add_f32 v78, v78, v158
  v_add_f32 v79, v79, v159
  s_waitcnt lgkmcnt(4)
  v_add_f32 v64, v64, v160
  v_add_f32 v65, v65, v161
  v_add_f32 v66, v66, v162
  v_add_f32 v67, v67, v163
  v_add_f32 v68, v68, v164
  v_add_f32 v69, v69, v165
  v_add_f32 v70, v70, v166
  v_add_f32 v71, v71, v167
  v_add_f32 v72, v72, v168
  v_add_f32 v73, v73, v169
  v_add_f32 v74, v74, v170
  v_add_f32 v75, v75, v171
  v_add_f32 v76, v76, v172
  v_add_f32 v77, v77, v173
  v_add_f32 v78, v78, v174
  v_add_f32 v79, v79, v175
  s_waitcnt lgkmcnt(0)
  v_add_f32 v64, v64, v176
  v_add_f32 v65, v65, v177
  v_add_f32 v66, v66, v178
  v_add_f32 v67, v67, v179
  v_add_f32 v68, v68, v180
  v_add_f32 v69, v69, v181
  v_add_f32 v70, v70, v182
  v_add_f32 v71, v71, v183
  v_add_f32 v72, v72, v184
  v_add_f32 v73, v73, v185
  v_add_f32 v74, v74, v186
  v_add_f32 v75, v75, v187
  v_add_f32 v76, v76, v188
  v_add_f32 v77, v77, v189
  v_add_f32 v78, v78, v190
  v_add_f32 v79, v79, v191
  v_mov_b32 v3, v76
  v_mov_b32 v4, v76
  s_nop 1
  v_permlane32_swap_b32 v3, v4
  s_nop 1
  v_rcp_f32 v4, v4
  s_nop 0
  v_mul_f32 v4, v4, v23
  v_mul_f32 v64, v4, v64
  v_mul_f32 v65, v4, v65
  v_mul_f32 v66, v4, v66
  v_mul_f32 v67, v4, v67
  v_mul_f32 v68, v4, v68
  v_mul_f32 v69, v4, v69
  v_mul_f32 v70, v4, v70
  v_mul_f32 v71, v4, v71
  v_mul_f32 v72, v4, v72
  v_mul_f32 v73, v4, v73
  v_mul_f32 v74, v4, v74
  v_mul_f32 v75, v4, v75
  v_mul_f32 v76, v4, v76
  v_mul_f32 v77, v4, v77
  v_mul_f32 v78, v4, v78
  v_mul_f32 v79, v4, v79
  v_cvt_pk_bf16_f32 v144, v64, v65
  v_cvt_pk_bf16_f32 v145, v66, v67
  v_cvt_pk_bf16_f32 v146, v68, v69
  v_cvt_pk_bf16_f32 v147, v70, v71
  v_cvt_pk_bf16_f32 v148, v72, v73
  v_cvt_pk_bf16_f32 v149, v74, v75
  v_cvt_pk_bf16_f32 v150, v76, v77
  v_cvt_pk_bf16_f32 v151, v78, v79
  s_mov_b32 exec_lo, 0
  v_mov_b32 v150, 0
  v_mov_b32 v151, 0
  s_mov_b32 exec_lo, -1
  v_min_u32 v144, -2, v144
  v_min_u32 v145, -2, v145
  v_min_u32 v146, -2, v146
  v_min_u32 v147, -2, v147
  buffer_store_dwordx4 v[144:147], v2, s[28:31], s27 offen offset:0 sc1
  v_min_u32 v148, -2, v148
  v_min_u32 v149, -2, v149
  v_min_u32 v150, -2, v150
  v_min_u32 v151, -2, v151
  buffer_store_dwordx4 v[148:151], v2, s[28:31], s27 offen offset:1024 sc1
  v_mov_b32 v3, 1
  s_endpgm
f_fallback:
  s_waitcnt lgkmcnt(0)
  s_mov_b32 s11, 2
  v_mov_b32 v182, 0x3f803f80
  v_mov_b32 v183, 0x3f80
  v_mov_b32 v190, 0x3f803f80
  v_mov_b32 v191, 0x3f80
  v_mov_b32 v198, 0x3f803f80
  v_mov_b32 v199, 0x3f80
  v_mov_b32 v206, 0x3f803f80
  v_mov_b32 v207, 0x3f80
  s_mov_b32 exec_lo, 0
  v_mov_b32 v38, 0
  v_mov_b32 v39, 0
  v_mov_b32 v46, 0
  v_mov_b32 v47, 0
  v_mov_b32 v54, 0
  v_mov_b32 v55, 0
  v_mov_b32 v62, 0
  v_mov_b32 v63, 0
  s_mov_b32 exec_lo, -1
  v_mov_b32 v13, 0xff800000
  v_mov_b32 v14, 0xff800000
  v_mov_b32 v15, 0xff800000
  v_mov_b32 v16, 0xff800000
  s_mov_b32 s10, s8
  s_mov_b32 s26, 0
f_fb_loop:
  buffer_load_dwordx2 v[176:177], v28, s[28:31], s10 offen offset:0 sc1
  buffer_load_dwordx2 v[178:179], v28, s[28:31], s10 offen offset:512 sc1
  buffer_load_dwordx2 v[180:181], v28, s[28:31], s10 offen offset:1024 sc1
  s_mov_b32 exec_hi, 0
  buffer_load_dwordx2 v[182:183], v28, s[28:31], s10 offen offset:1536 sc1
  s_mov_b64 exec, -1
  s_add_u32 s10, s10, 3584
  s_waitcnt vmcnt(0)
  v_mfma_f32_32x32x16_bf16 v[64:79], v[176:179], v[32:35], 0
  v_mfma_f32_32x32x16_bf16 v[64:79], v[180:183], v[36:39], v[64:79]
  v_mfma_f32_32x32x16_bf16 v[80:95], v[176:179], v[40:43], 0
  v_mfma_f32_32x32x16_bf16 v[80:95], v[180:183], v[44:47], v[80:95]
  v_mfma_f32_32x32x16_bf16 v[96:111], v[176:179], v[48:51], 0
  v_mfma_f32_32x32x16_bf16 v[96:111], v[180:183], v[52:55], v[96:111]
  v_mfma_f32_32x32x16_bf16 v[112:127], v[176:179], v[56:59], 0
  v_mfma_f32_32x32x16_bf16 v[112:127], v[180:183], v[60:63], v[112:127]
  s_nop 7
  s_nop 7
  v_max3_f32 v13, v13, v64, v65
  v_max3_f32 v13, v13, v66, v67
  v_max3_f32 v13, v13, v68, v69
  v_max3_f32 v13, v13, v70, v71
  v_max3_f32 v13, v13, v72, v73
  v_max3_f32 v13, v13, v74, v75
  v_max3_f32 v13, v13, v76, v77
  v_max3_f32 v13, v13, v78, v79
  v_max3_f32 v14, v14, v80, v81
  v_max3_f32 v14, v14, v82, v83
  v_max3_f32 v14, v14, v84, v85
  v_max3_f32 v14, v14, v86, v87
  v_max3_f32 v14, v14, v88, v89
  v_max3_f32 v14, v14, v90, v91
  v_max3_f32 v14, v14, v92, v93
  v_max3_f32 v14, v14, v94, v95
  v_max3_f32 v15, v15, v96, v97
  v_max3_f32 v15, v15, v98, v99
  v_max3_f32 v15, v15, v100, v101
  v_max3_f32 v15, v15, v102, v103
  v_max3_f32 v15, v15, v104, v105
  v_max3_f32 v15, v15, v106, v107
  v_max3_f32 v15, v15, v108, v109
  v_max3_f32 v15, v15, v110, v111
  v_max3_f32 v16, v16, v112, v113
  v_max3_f32 v16, v16, v114, v115
  v_max3_f32 v16, v16, v116, v117
  v_max3_f32 v16, v16, v118, v119
  v_max3_f32 v16, v16, v120, v121
  v_max3_f32 v16, v16, v122, v123
  v_max3_f32 v16, v16, v124, v125
  v_max3_f32 v16, v16, v126, v127
  s_add_u32 s26, s26, 1
  s_cmp_lt_u32 s26, 16
  s_cbranch_scc1 f_fb_loop
  v_mov_b32 v6, v13
  v_mov_b32 v7, v13
  s_nop 1
  v_permlane32_swap_b32 v6, v7
  s_nop 1
  v_max_f32 v13, v6, v7
  v_mov_b32 v6, v14
  v_mov_b32 v7, v14
  s_nop 1
  v_permlane32_swap_b32 v6, v7
  s_nop 1
  v_max_f32 v14, v6, v7
  v_mov_b32 v6, v15
  v_mov_b32 v7, v15
  s_nop 1
  v_permlane32_swap_b32 v6, v7
  s_nop 1
  v_max_f32 v15, v6, v7
  v_mov_b32 v6, v16
  v_mov_b32 v7, v16
  s_nop 1
  v_permlane32_swap_b32 v6, v7
  s_nop 1
  v_max_f32 v16, v6, v7
  v_mov_b32 v3, 1
  ds_write_b32 v22, v3 offset:16
Lp24:
  ds_read_b128 v[128:131], v21 offset:16
  s_waitcnt lgkmcnt(0)
  v_min_u32 v132, v128, v129
  v_min3_u32 v132, v132, v130, v131
  s_nop 0
  v_readfirstlane_b32 s58, v132
  s_cmp_ge_u32 s58, 1
  s_cbranch_scc1 Ld25
  s_sub_u32 s54, s54, 1
  s_cmp_gt_i32 s54, 0
  s_cbranch_scc1 Lp24
Ld25:
  s_add_u32 s55, s48, 0
  s_and_b32 s55, s55, 3
  s_lshl_b32 s55, s55, 8
  s_add_u32 s55, s55, 0x10000
  v_lshl_add_u32 v24, v1, 2, s55
  s_add_u32 s55, s48, 1
  s_and_b32 s55, s55, 3
  s_lshl_b32 s55, s55, 8
  s_add_u32 s55, s55, 0x10000
  v_lshl_add_u32 v25, v1, 2, s55
  s_add_u32 s55, s48, 2
  s_and_b32 s55, s55, 3
  s_lshl_b32 s55, s55, 8
  s_add_u32 s55, s55, 0x10000
  v_lshl_add_u32 v26, v1, 2, s55
  s_add_u32 s55, s48, 3
  s_and_b32 s55, s55, 3
  s_lshl_b32 s55, s55, 8
  s_add_u32 s55, s55, 0x10000
  v_lshl_add_u32 v27, v1, 2, s55
  s_lshl_b32 s55, s48, 10
  v_add_u32 v3, s55, v24
  ds_write_b32 v3, v13
  v_add_u32 v3, s55, v25
  ds_write_b32 v3, v14
  v_add_u32 v3, s55, v26
  ds_write_b32 v3, v15
  v_add_u32 v3, s55, v27
  ds_write_b32 v3, v16
  v_mov_b32 v3, 2
  ds_write_b32 v22, v3 offset:16
Lp26:
  ds_read_b128 v[128:131], v21 offset:16
  s_waitcnt lgkmcnt(0)
  v_min_u32 v132, v128, v129
  v_min3_u32 v132, v132, v130, v131
  s_nop 0
  v_readfirstlane_b32 s58, v132
  s_cmp_ge_u32 s58, 2
  s_cbranch_scc1 Ld27
  s_sub_u32 s54, s54, 1
  s_cmp_gt_i32 s54, 0
  s_cbranch_scc1 Lp26
Ld27:
  ds_read_b32 v128, v24 offset:0
  ds_read_b32 v129, v25 offset:0
  ds_read_b32 v130, v26 offset:0
  ds_read_b32 v131, v27 offset:0
  ds_read_b32 v132, v24 offset:1024
  ds_read_b32 v133, v25 offset:1024
  ds_read_b32 v134, v26 offset:1024
  ds_read_b32 v135, v27 offset:1024
  ds_read_b32 v136, v24 offset:2048
  ds_read_b32 v137, v25 offset:2048
  ds_read_b32 v138, v26 offset:2048
  ds_read_b32 v139, v27 offset:2048
  ds_read_b32 v140, v24 offset:3072
  ds_read_b32 v141, v25 offset:3072
  ds_read_b32 v142, v26 offset:3072
  ds_read_b32 v143, v27 offset:3072
  s_waitcnt lgkmcnt(0)
  v_mov_b32 v3, 3
  ds_write_b32 v22, v3 offset:16
  v_max3_f32 v13, v128, v132, v136
  v_max_f32 v13, v13, v140
  v_max3_f32 v14, v129, v133, v137
  v_max_f32 v14, v14, v141
  v_max3_f32 v15, v130, v134, v138
  v_max_f32 v15, v15, v142
  v_max3_f32 v16, v131, v135, v139
  v_max_f32 v16, v16, v143
  v_cvt_pk_bf16_f32 v3, v13, v13
  v_lshlrev_b32 v3, 16, v3
  v_sub_f32 v4, v13, v3
  v_cvt_pk_bf16_f32 v3, v4, v4
  v_lshlrev_b32 v3, 16, v3
  v_sub_f32 v5, v4, v3
  s_mov_b32 exec_lo, 0
  v_cvt_pk_bf16_f32 v38, -v13, -v4
  v_cvt_pk_bf16_f32 v39, -v5, 0
  s_mov_b32 exec_lo, -1
  v_cvt_pk_bf16_f32 v3, v14, v14
  v_lshlrev_b32 v3, 16, v3
  v_sub_f32 v4, v14, v3
  v_cvt_pk_bf16_f32 v3, v4, v4
  v_lshlrev_b32 v3, 16, v3
  v_sub_f32 v5, v4, v3
  s_mov_b32 exec_lo, 0
  v_cvt_pk_bf16_f32 v46, -v14, -v4
  v_cvt_pk_bf16_f32 v47, -v5, 0
  s_mov_b32 exec_lo, -1
  v_cvt_pk_bf16_f32 v3, v15, v15
  v_lshlrev_b32 v3, 16, v3
  v_sub_f32 v4, v15, v3
  v_cvt_pk_bf16_f32 v3, v4, v4
  v_lshlrev_b32 v3, 16, v3
  v_sub_f32 v5, v4, v3
  s_mov_b32 exec_lo, 0
  v_cvt_pk_bf16_f32 v54, -v15, -v4
  v_cvt_pk_bf16_f32 v55, -v5, 0
  s_mov_b32 exec_lo, -1
  v_cvt_pk_bf16_f32 v3, v16, v16
  v_lshlrev_b32 v3, 16, v3
  v_sub_f32 v4, v16, v3
  v_cvt_pk_bf16_f32 v3, v4, v4
  v_lshlrev_b32 v3, 16, v3
  v_sub_f32 v5, v4, v3
  s_mov_b32 exec_lo, 0
  v_cvt_pk_bf16_f32 v62, -v16, -v4
  v_cvt_pk_bf16_f32 v63, -v5, 0
  s_mov_b32 exec_lo, -1
Lp28:
  ds_read_b128 v[128:131], v21 offset:16
  s_waitcnt lgkmcnt(0)
  v_min_u32 v132, v128, v129
  v_min3_u32 v132, v132, v130, v131
  s_nop 0
  v_readfirstlane_b32 s58, v132
  s_cmp_ge_u32 s58, 3
  s_cbranch_scc1 Ld29
  s_sub_u32 s54, s54, 1
  s_cmp_gt_i32 s54, 0
  s_cbranch_scc1 Lp28
Ld29:
  v_add_u32 v21, 32, v21
  v_add_u32 v22, 32, v22
  s_branch f_attn_main
f_gemm:
  s_sub_u32 s48, s48, 4
  s_cmp_ge_u32 s48, 2
  s_cbranch_scc1 Lz30
  s_getpc_b64 s[56:57]
f_pc:
  s_mul_i32 s55, s48, 16
  s_add_u32 s55, s55, s50
  s_and_b32 s55, s55, 31
  s_lshl_b32 s55, s55, 11
  v_lshl_add_u32 v3, v1, 7, s55
  v_min_u32 v3, f_end-f_kernel-4, v3
  s_sub_u32 s56, s56, f_pc-f_kernel
  s_subb_u32 s57, s57, 0
  s_mov_b64 exec, 0xffff
  global_load_dword v13, v3, s[56:57]
  s_mov_b64 exec, -1
Lz30:
  s_lshl_b32 s61, s51, 2
  s_add_u32 s61, s61, s48
  v_lshrrev_b32 v3, 3, v1
  v_and_b32 v4, 7, v1
  v_lshrrev_b32 v5, 4, v1
  v_xor_b32 v5, v5, v4
  s_lshl_b32 s55, s61, 5
  v_add_u32 v6, s55, v3
  v_mul_u32_u24 v6, 896, v6
  v_lshl_add_u32 v36, v5, 4, v6
  v_xor_b32 v5, 4, v5
  v_lshl_add_u32 v37, v5, 4, v6
  v_add_u32 v37, 7168, v37
  v_add_u32 v38, 14336, v36
  v_add_u32 v39, 14336, v37
  s_lshl_b32 s59, s53, 7
  s_lshl_b32 s60, s48, 14
  s_waitcnt lgkmcnt(0)
  s_mov_b32 s32, s4
  s_and_b32 s33, s5, 0xffff
  s_mov_b32 s34, 0x1c0000
  s_mov_b32 s35, 0x00020000
  s_setprio 2
  s_barrier
  s_mov_b32 s28, s24
  s_and_b32 s29, s25, 0xffff
  s_mov_b32 s30, 0x10000000
  s_mov_b32 s31, 0x00020000
  v_and_b32 v7, 31, v1
  v_lshrrev_b32 v8, 5, v1
  v_bfe_u32 v3, v1, 1, 3
  v_xor_b32 v3, v3, v8
  v_lshlrev_b32 v3, 4, v3
  v_lshl_add_u32 v3, v7, 7, v3
  v_add_u32 v32, s60, v3
  v_xor_b32 v33, 32, v32
  v_xor_b32 v34, 64, v32
  v_xor_b32 v35, 96, v32
  v_mov_b32 v11, 0x27600
  s_lshl_b32 s55, s48, 2
  v_add_u32 v12, s55, v11
  v_lshrrev_b32 v8, 5, v1
  v_bfe_u32 v6, v1, 2, 2
  v_lshl_add_u32 v3, v8, 3, v6
  v_bfe_u32 v4, v1, 4, 1
  v_and_b32 v5, 3, v1
  v_lshlrev_b32 v5, 3, v5
  v_lshl_add_u32 v6, v3, 6, v5
  v_lshl_add_u32 v6, v4, 5, v6
  v_add_u32 v18, 0x10000, v6
  v_add_u32 v19, 0x20000, v6
  v_lshl_add_u32 v6, v3, 7, v5
  v_lshl_add_u32 v6, v4, 5, v6
  v_bfe_u32 v9, v1, 3, 1
  v_lshl_add_u32 v6, v9, 6, v6
  v_add_u32 v16, 0x10000, v6
  v_xor_b32 v17, 64, v16
  s_mul_i32 s62, s61, 3584
  s_add_u32 s62, s62, 0x200000
  s_mov_b32 s36, s22
  s_and_b32 s37, s23, 0xffff
  s_mov_b32 s38, 0x100
  s_mov_b32 s39, 0x00020000
  v_mov_b32 v132, -1
  v_mov_b32 v133, -1
  v_mov_b32 v134, -1
  v_mov_b32 v135, -1
  s_lshl_b32 s55, s61, 4
  s_add_u32 s55, s55, s52
  s_lshl_b32 s55, s55, 11
  s_add_u32 s55, s55, 0x1000000
  buffer_store_dwordx4 v[132:135], v2, s[28:31], s55 offen offset:0 sc1
  buffer_store_dwordx4 v[132:135], v2, s[28:31], s55 offen offset:1024 sc1
  s_cmp_ge_u32 s52, 14
  s_cbranch_scc1 f_kvn
  s_cmp_ge_u32 s52, 7
  s_cbranch_scc1 f_kvv
  s_lshl_b32 s55, s52, 4
  v_add_u32 v3, s55, v8
  v_lshlrev_b32 v6, 3, v7
  v_add_u32 v4, 0, v3
  v_mul_u32_u24 v5, 9363, v4
  v_lshrrev_b32 v5, 16, v5
  v_lshl_add_u32 v4, v4, 8, v6
  v_mul_u32_u24 v5, 227584, v5
  v_add_u32 v20, v4, v5
  v_add_u32 v4, 2, v3
  v_mul_u32_u24 v5, 9363, v4
  v_lshrrev_b32 v5, 16, v5
  v_lshl_add_u32 v4, v4, 8, v6
  v_mul_u32_u24 v5, 227584, v5
  v_add_u32 v21, v4, v5
  v_add_u32 v4, 4, v3
  v_mul_u32_u24 v5, 9363, v4
  v_lshrrev_b32 v5, 16, v5
  v_lshl_add_u32 v4, v4, 8, v6
  v_mul_u32_u24 v5, 227584, v5
  v_add_u32 v22, v4, v5
  v_add_u32 v4, 6, v3
  v_mul_u32_u24 v5, 9363, v4
  v_lshrrev_b32 v5, 16, v5
  v_lshl_add_u32 v4, v4, 8, v6
  v_mul_u32_u24 v5, 227584, v5
  v_add_u32 v23, v4, v5
  v_add_u32 v4, 8, v3
  v_mul_u32_u24 v5, 9363, v4
  v_lshrrev_b32 v5, 16, v5
  v_lshl_add_u32 v4, v4, 8, v6
  v_mul_u32_u24 v5, 227584, v5
  v_add_u32 v24, v4, v5
  v_add_u32 v4, 10, v3
  v_mul_u32_u24 v5, 9363, v4
  v_lshrrev_b32 v5, 16, v5
  v_lshl_add_u32 v4, v4, 8, v6
  v_mul_u32_u24 v5, 227584, v5
  v_add_u32 v25, v4, v5
  v_add_u32 v4, 12, v3
  v_mul_u32_u24 v5, 9363, v4
  v_lshrrev_b32 v5, 16, v5
  v_lshl_add_u32 v4, v4, 8, v6
  v_mul_u32_u24 v5, 227584, v5
  v_add_u32 v26, v4, v5
  v_add_u32 v4, 14, v3
  v_mul_u32_u24 v5, 9363, v4
  v_lshrrev_b32 v5, 16, v5
  v_lshl_add_u32 v4, v4, 8, v6
  v_mul_u32_u24 v5, 227584, v5
  v_add_u32 v27, v4, v5
Lp31:
  ds_read_b128 v[28:31], v11 offset:0
  s_waitcnt lgkmcnt(0)
  v_min_u32 v9, v28, v29
  v_min3_u32 v9, v9, v30, v31
  s_nop 0
  v_readfirstlane_b32 s58, v9
  s_cmp_ge_u32 s58, 1
  s_cbranch_scc1 Ld32
  s_sub_u32 s54, s54, 1
  s_cmp_gt_i32 s54, 0
  s_cbranch_scc1 Lp31
Ld32:
  ds_read_b128 v[136:139], v32 offset:0
  ds_read_b128 v[140:143], v33 offset:0
  ds_read_b128 v[144:147], v34 offset:0
  ds_read_b128 v[148:151], v35 offset:0
  v_mov_b32 v10, 1
  ds_write_b32 v12, v10 offset:64
  ds_read_b64_tr_b16 v[40:41], v16 offset:0
  ds_read_b64_tr_b16 v[42:43], v16 offset:512
  ds_read_b64_tr_b16 v[44:45], v17 offset:0
  ds_read_b64_tr_b16 v[46:47], v17 offset:512
  ds_read_b64_tr_b16 v[48:49], v16 offset:2048
  ds_read_b64_tr_b16 v[50:51], v16 offset:2560
  ds_read_b64_tr_b16 v[52:53], v17 offset:2048
  ds_read_b64_tr_b16 v[54:55], v17 offset:2560
  s_waitcnt lgkmcnt(9)
  s_waitcnt lgkmcnt(6)
  v_mfma_f32_32x32x16_bf16 v[72:87], v[40:43], v[136:139], 0
  ds_read_b64_tr_b16 v[56:57], v16 offset:4096
  ds_read_b64_tr_b16 v[58:59], v16 offset:4608
  s_waitcnt lgkmcnt(6)
  v_mfma_f32_32x32x16_bf16 v[88:103], v[44:47], v[136:139], 0
  ds_read_b128 v[28:31], v11 offset:0
  ds_read_b64_tr_b16 v[60:61], v17 offset:4096
  ds_read_b64_tr_b16 v[62:63], v17 offset:4608
  s_waitcnt lgkmcnt(7)
  v_mfma_f32_32x32x16_bf16 v[72:87], v[48:51], v[140:143], v[72:87]
  ds_read_b64_tr_b16 v[64:65], v16 offset:6144
  ds_read_b64_tr_b16 v[66:67], v16 offset:6656
  s_waitcnt lgkmcnt(7)
  v_mfma_f32_32x32x16_bf16 v[88:103], v[52:55], v[140:143], v[88:103]
  ds_read_b64_tr_b16 v[68:69], v17 offset:6144
  ds_read_b64_tr_b16 v[70:71], v17 offset:6656
  s_waitcnt lgkmcnt(7)
  v_mfma_f32_32x32x16_bf16 v[72:87], v[56:59], v[144:147], v[72:87]
  s_waitcnt lgkmcnt(6)
  v_min_u32 v9, v28, v29
  v_min3_u32 v9, v9, v30, v31
  s_nop 0
  v_readfirstlane_b32 s58, v9
  s_cmp_ge_u32 s58, 2
  s_cbranch_scc1 Ld34
Lp33:
  ds_read_b128 v[28:31], v11 offset:0
  s_waitcnt lgkmcnt(0)
  v_min_u32 v9, v28, v29
  v_min3_u32 v9, v9, v30, v31
  s_nop 0
  v_readfirstlane_b32 s58, v9
  s_cmp_ge_u32 s58, 2
  s_cbranch_scc1 Ld34
  s_sub_u32 s54, s54, 1
  s_cmp_gt_i32 s54, 0
  s_cbranch_scc1 Lp33
Ld34:
  ds_read_b128 v[152:155], v32 offset:4096
  ds_read_b128 v[156:159], v33 offset:4096
  ds_read_b128 v[160:163], v34 offset:4096
  ds_read_b128 v[164:167], v35 offset:4096
  v_mov_b32 v10, 2
  ds_write_b32 v12, v10 offset:64
  ds_read_b64_tr_b16 v[40:41], v16 offset:8192
  ds_read_b64_tr_b16 v[42:43], v16 offset:8704
  s_waitcnt lgkmcnt(11)
  v_mfma_f32_32x32x16_bf16 v[88:103], v[60:63], v[144:147], v[88:103]
  ds_read_b64_tr_b16 v[44:45], v17 offset:8192
  ds_read_b64_tr_b16 v[46:47], v17 offset:8704
  s_waitcnt lgkmcnt(11)
  v_mfma_f32_32x32x16_bf16 v[72:87], v[64:67], v[148:151], v[72:87]
  ds_read_b64_tr_b16 v[48:49], v16 offset:10240
  ds_read_b64_tr_b16 v[50:51], v16 offset:10752
  s_waitcnt lgkmcnt(11)
  v_mfma_f32_32x32x16_bf16 v[88:103], v[68:71], v[148:151], v[88:103]
  v_mov_b32 v10, 1
  ds_write_b32 v12, v10 offset:16
  ds_read_b64_tr_b16 v[52:53], v17 offset:10240
  ds_read_b64_tr_b16 v[54:55], v17 offset:10752
  s_waitcnt lgkmcnt(10)
  s_waitcnt lgkmcnt(7)
  v_mfma_f32_32x32x16_bf16 v[72:87], v[40:43], v[152:155], v[72:87]
  ds_read_b64_tr_b16 v[56:57], v16 offset:12288
  ds_read_b64_tr_b16 v[58:59], v16 offset:12800
  s_waitcnt lgkmcnt(7)
  v_mfma_f32_32x32x16_bf16 v[88:103], v[44:47], v[152:155], v[88:103]
  ds_read_b128 v[28:31], v11 offset:0
  ds_read_b64_tr_b16 v[60:61], v17 offset:12288
  ds_read_b64_tr_b16 v[62:63], v17 offset:12800
  s_waitcnt lgkmcnt(8)
  v_mfma_f32_32x32x16_bf16 v[72:87], v[48:51], v[156:159], v[72:87]
  ds_read_b64_tr_b16 v[64:65], v16 offset:14336
  ds_read_b64_tr_b16 v[66:67], v16 offset:14848
  s_waitcnt lgkmcnt(7)
  v_mfma_f32_32x32x16_bf16 v[88:103], v[52:55], v[156:159], v[88:103]
  ds_read_b64_tr_b16 v[68:69], v17 offset:14336
  ds_read_b64_tr_b16 v[70:71], v17 offset:14848
  s_waitcnt lgkmcnt(7)
  v_mfma_f32_32x32x16_bf16 v[72:87], v[56:59], v[160:163], v[72:87]
  s_waitcnt lgkmcnt(6)
  v_min_u32 v9, v28, v29
  v_min3_u32 v9, v9, v30, v31
  s_nop 0
  v_readfirstlane_b32 s58, v9
  s_cmp_ge_u32 s58, 3
  s_cbranch_scc1 Ld36
Lp35:
  ds_read_b128 v[28:31], v11 offset:0
  s_waitcnt lgkmcnt(0)
  v_min_u32 v9, v28, v29
  v_min3_u32 v9, v9, v30, v31
  s_nop 0
  v_readfirstlane_b32 s58, v9
  s_cmp_ge_u32 s58, 3
  s_cbranch_scc1 Ld36
  s_sub_u32 s54, s54, 1
  s_cmp_gt_i32 s54, 0
  s_cbranch_scc1 Lp35
Ld36:
  ds_read_b128 v[168:171], v32 offset:8192
  ds_read_b128 v[172:175], v33 offset:8192
  ds_read_b128 v[176:179], v34 offset:8192
  ds_read_b128 v[180:183], v35 offset:8192
  v_mov_b32 v10, 3
  ds_write_b32 v12, v10 offset:64
  ds_read_b64_tr_b16 v[40:41], v16 offset:16384
  ds_read_b64_tr_b16 v[42:43], v16 offset:16896
  s_waitcnt lgkmcnt(11)
  v_mfma_f32_32x32x16_bf16 v[88:103], v[60:63], v[160:163], v[88:103]
  ds_read_b64_tr_b16 v[44:45], v17 offset:16384
  ds_read_b64_tr_b16 v[46:47], v17 offset:16896
  s_waitcnt lgkmcnt(11)
  v_mfma_f32_32x32x16_bf16 v[72:87], v[64:67], v[164:167], v[72:87]
  ds_read_b64_tr_b16 v[48:49], v16 offset:18432
  ds_read_b64_tr_b16 v[50:51], v16 offset:18944
  s_waitcnt lgkmcnt(11)
  v_mfma_f32_32x32x16_bf16 v[88:103], v[68:71], v[164:167], v[88:103]
  v_mov_b32 v10, 2
  ds_write_b32 v12, v10 offset:16
  ds_read_b64_tr_b16 v[52:53], v17 offset:18432
  ds_read_b64_tr_b16 v[54:55], v17 offset:18944
  s_waitcnt lgkmcnt(10)
  s_waitcnt lgkmcnt(7)
  v_mfma_f32_32x32x16_bf16 v[72:87], v[40:43], v[168:171], v[72:87]
  ds_read_b64_tr_b16 v[56:57], v16 offset:20480
  ds_read_b64_tr_b16 v[58:59], v16 offset:20992
  s_waitcnt lgkmcnt(7)
  v_mfma_f32_32x32x16_bf16 v[88:103], v[44:47], v[168:171], v[88:103]
  ds_read_b128 v[28:31], v11 offset:0
  ds_read_b64_tr_b16 v[60:61], v17 offset:20480
  ds_read_b64_tr_b16 v[62:63], v17 offset:20992
  s_waitcnt lgkmcnt(8)
  v_mfma_f32_32x32x16_bf16 v[72:87], v[48:51], v[172:175], v[72:87]
  ds_read_b64_tr_b16 v[64:65], v16 offset:22528
  ds_read_b64_tr_b16 v[66:67], v16 offset:23040
  s_waitcnt lgkmcnt(7)
  v_mfma_f32_32x32x16_bf16 v[88:103], v[52:55], v[172:175], v[88:103]
  ds_read_b64_tr_b16 v[68:69], v17 offset:22528
  ds_read_b64_tr_b16 v[70:71], v17 offset:23040
  s_waitcnt lgkmcnt(7)
  v_mfma_f32_32x32x16_bf16 v[72:87], v[56:59], v[176:179], v[72:87]
  s_waitcnt lgkmcnt(6)
  v_min_u32 v9, v28, v29
  v_min3_u32 v9, v9, v30, v31
  s_nop 0
  v_readfirstlane_b32 s58, v9
  s_cmp_ge_u32 s58, 4
  s_cbranch_scc1 Ld38
Lp37:
  ds_read_b128 v[28:31], v11 offset:0
  s_waitcnt lgkmcnt(0)
  v_min_u32 v9, v28, v29
  v_min3_u32 v9, v9, v30, v31
  s_nop 0
  v_readfirstlane_b32 s58, v9
  s_cmp_ge_u32 s58, 4
  s_cbranch_scc1 Ld38
  s_sub_u32 s54, s54, 1
  s_cmp_gt_i32 s54, 0
  s_cbranch_scc1 Lp37
Ld38:
  ds_read_b128 v[184:187], v32 offset:12288
  ds_read_b128 v[188:191], v33 offset:12288
  ds_read_b128 v[192:195], v34 offset:12288
  ds_read_b128 v[196:199], v35 offset:12288
  ds_read_b64_tr_b16 v[40:41], v16 offset:24576
  ds_read_b64_tr_b16 v[42:43], v16 offset:25088
  s_waitcnt lgkmcnt(10)
  v_mfma_f32_32x32x16_bf16 v[88:103], v[60:63], v[176:179], v[88:103]
  ds_read_b64_tr_b16 v[44:45], v17 offset:24576
  ds_read_b64_tr_b16 v[46:47], v17 offset:25088
  s_waitcnt lgkmcnt(10)
  v_mfma_f32_32x32x16_bf16 v[72:87], v[64:67], v[180:183], v[72:87]
  ds_read_b64_tr_b16 v[48:49], v16 offset:26624
  ds_read_b64_tr_b16 v[50:51], v16 offset:27136
  s_waitcnt lgkmcnt(10)
  v_mfma_f32_32x32x16_bf16 v[88:103], v[68:71], v[180:183], v[88:103]
  v_mov_b32 v10, 3
  ds_write_b32 v12, v10 offset:16
  ds_read_b64_tr_b16 v[52:53], v17 offset:26624
  ds_read_b64_tr_b16 v[54:55], v17 offset:27136
  s_waitcnt lgkmcnt(9)
  s_waitcnt lgkmcnt(7)
  v_mfma_f32_32x32x16_bf16 v[72:87], v[40:43], v[184:187], v[72:87]
  ds_read_b64_tr_b16 v[56:57], v16 offset:28672
  ds_read_b64_tr_b16 v[58:59], v16 offset:29184
  s_waitcnt lgkmcnt(7)
  v_mfma_f32_32x32x16_bf16 v[88:103], v[44:47], v[184:187], v[88:103]
  ds_read_b128 v[28:31], v11 offset:0
  ds_read_b64_tr_b16 v[60:61], v17 offset:28672
  ds_read_b64_tr_b16 v[62:63], v17 offset:29184
  s_waitcnt lgkmcnt(8)
  v_mfma_f32_32x32x16_bf16 v[72:87], v[48:51], v[188:191], v[72:87]
  ds_read_b64_tr_b16 v[64:65], v16 offset:30720
  ds_read_b64_tr_b16 v[66:67], v16 offset:31232
  s_waitcnt lgkmcnt(7)
  v_mfma_f32_32x32x16_bf16 v[88:103], v[52:55], v[188:191], v[88:103]
  ds_read_b64_tr_b16 v[68:69], v17 offset:30720
  ds_read_b64_tr_b16 v[70:71], v17 offset:31232
  s_waitcnt lgkmcnt(7)
  v_mfma_f32_32x32x16_bf16 v[72:87], v[56:59], v[192:195], v[72:87]
  s_waitcnt lgkmcnt(6)
  v_min_u32 v9, v28, v29
  v_min3_u32 v9, v9, v30, v31
  s_nop 0
  v_readfirstlane_b32 s58, v9
  s_cmp_ge_u32 s58, 5
  s_cbranch_scc1 Ld40
Lp39:
  ds_read_b128 v[28:31], v11 offset:0
  s_waitcnt lgkmcnt(0)
  v_min_u32 v9, v28, v29
  v_min3_u32 v9, v9, v30, v31
  s_nop 0
  v_readfirstlane_b32 s58, v9
  s_cmp_ge_u32 s58, 5
  s_cbranch_scc1 Ld40
  s_sub_u32 s54, s54, 1
  s_cmp_gt_i32 s54, 0
  s_cbranch_scc1 Lp39
Ld40:
  ds_read_b128 v[200:203], v32 offset:0
  ds_read_b128 v[204:207], v33 offset:0
  ds_read_b128 v[208:211], v34 offset:0
  ds_read_b128 v[212:215], v35 offset:0
  ds_read_b64_tr_b16 v[40:41], v16 offset:32768
  ds_read_b64_tr_b16 v[42:43], v16 offset:33280
  s_waitcnt lgkmcnt(10)
  v_mfma_f32_32x32x16_bf16 v[88:103], v[60:63], v[192:195], v[88:103]
  ds_read_b64_tr_b16 v[44:45], v17 offset:32768
  ds_read_b64_tr_b16 v[46:47], v17 offset:33280
  s_waitcnt lgkmcnt(10)
  v_mfma_f32_32x32x16_bf16 v[72:87], v[64:67], v[196:199], v[72:87]
  ds_read_b64_tr_b16 v[48:49], v16 offset:34816
  ds_read_b64_tr_b16 v[50:51], v16 offset:35328
  s_waitcnt lgkmcnt(10)
  v_mfma_f32_32x32x16_bf16 v[88:103], v[68:71], v[196:199], v[88:103]
  v_mov_b32 v10, 4
  ds_write_b32 v12, v10 offset:16
  ds_read_b64_tr_b16 v[52:53], v17 offset:34816
  ds_read_b64_tr_b16 v[54:55], v17 offset:35328
  s_waitcnt lgkmcnt(9)
  s_waitcnt lgkmcnt(7)
  v_mfma_f32_32x32x16_bf16 v[72:87], v[40:43], v[200:203], v[72:87]
  ds_read_b64_tr_b16 v[56:57], v16 offset:36864
  ds_read_b64_tr_b16 v[58:59], v16 offset:37376
  s_waitcnt lgkmcnt(7)
  v_mfma_f32_32x32x16_bf16 v[88:103], v[44:47], v[200:203], v[88:103]
  ds_read_b128 v[28:31], v11 offset:0
  ds_read_b64_tr_b16 v[60:61], v17 offset:36864
  ds_read_b64_tr_b16 v[62:63], v17 offset:37376
  s_waitcnt lgkmcnt(8)
  v_mfma_f32_32x32x16_bf16 v[72:87], v[48:51], v[204:207], v[72:87]
  ds_read_b64_tr_b16 v[64:65], v16 offset:38912
  ds_read_b64_tr_b16 v[66:67], v16 offset:39424
  s_waitcnt lgkmcnt(7)
  v_mfma_f32_32x32x16_bf16 v[88:103], v[52:55], v[204:207], v[88:103]
  ds_read_b64_tr_b16 v[68:69], v17 offset:38912
  ds_read_b64_tr_b16 v[70:71], v17 offset:39424
  s_waitcnt lgkmcnt(7)
  v_mfma_f32_32x32x16_bf16 v[72:87], v[56:59], v[208:211], v[72:87]
  s_waitcnt lgkmcnt(6)
  v_min_u32 v9, v28, v29
  v_min3_u32 v9, v9, v30, v31
  s_nop 0
  v_readfirstlane_b32 s58, v9
  s_cmp_ge_u32 s58, 6
  s_cbranch_scc1 Ld42
Lp41:
  ds_read_b128 v[28:31], v11 offset:0
  s_waitcnt lgkmcnt(0)
  v_min_u32 v9, v28, v29
  v_min3_u32 v9, v9, v30, v31
  s_nop 0
  v_readfirstlane_b32 s58, v9
  s_cmp_ge_u32 s58, 6
  s_cbranch_scc1 Ld42
  s_sub_u32 s54, s54, 1
  s_cmp_gt_i32 s54, 0
  s_cbranch_scc1 Lp41
Ld42:
  ds_read_b128 v[216:219], v32 offset:4096
  ds_read_b128 v[220:223], v33 offset:4096
  ds_read_b128 v[224:227], v34 offset:4096
  ds_read_b128 v[228:231], v35 offset:4096
  ds_read_b64_tr_b16 v[40:41], v16 offset:40960
  ds_read_b64_tr_b16 v[42:43], v16 offset:41472
  s_waitcnt lgkmcnt(10)
  v_mfma_f32_32x32x16_bf16 v[88:103], v[60:63], v[208:211], v[88:103]
  ds_read_b64_tr_b16 v[44:45], v17 offset:40960
  ds_read_b64_tr_b16 v[46:47], v17 offset:41472
  s_waitcnt lgkmcnt(10)
  v_mfma_f32_32x32x16_bf16 v[72:87], v[64:67], v[212:215], v[72:87]
  ds_read_b64_tr_b16 v[48:49], v16 offset:43008
  ds_read_b64_tr_b16 v[50:51], v16 offset:43520
  s_waitcnt lgkmcnt(10)
  v_mfma_f32_32x32x16_bf16 v[88:103], v[68:71], v[212:215], v[88:103]
  v_mov_b32 v10, 5
  ds_write_b32 v12, v10 offset:16
  ds_read_b64_tr_b16 v[52:53], v17 offset:43008
  ds_read_b64_tr_b16 v[54:55], v17 offset:43520
  s_waitcnt lgkmcnt(9)
  s_waitcnt lgkmcnt(7)
  v_mfma_f32_32x32x16_bf16 v[72:87], v[40:43], v[216:219], v[72:87]
  ds_read_b64_tr_b16 v[56:57], v16 offset:45056
  ds_read_b64_tr_b16 v[58:59], v16 offset:45568
  s_waitcnt lgkmcnt(7)
  v_mfma_f32_32x32x16_bf16 v[88:103], v[44:47], v[216:219], v[88:103]
  ds_read_b128 v[28:31], v11 offset:0
  ds_read_b64_tr_b16 v[60:61], v17 offset:45056
  ds_read_b64_tr_b16 v[62:63], v17 offset:45568
  s_waitcnt lgkmcnt(8)
  v_mfma_f32_32x32x16_bf16 v[72:87], v[48:51], v[220:223], v[72:87]
  ds_read_b64_tr_b16 v[64:65], v16 offset:47104
  ds_read_b64_tr_b16 v[66:67], v16 offset:47616
  s_waitcnt lgkmcnt(7)
  v_mfma_f32_32x32x16_bf16 v[88:103], v[52:55], v[220:223], v[88:103]
  ds_read_b64_tr_b16 v[68:69], v17 offset:47104
  ds_read_b64_tr_b16 v[70:71], v17 offset:47616
  s_waitcnt lgkmcnt(7)
  v_mfma_f32_32x32x16_bf16 v[72:87], v[56:59], v[224:227], v[72:87]
  s_waitcnt lgkmcnt(6)
  v_min_u32 v9, v28, v29
  v_min3_u32 v9, v9, v30, v31
  s_nop 0
  v_readfirstlane_b32 s58, v9
  s_cmp_ge_u32 s58, 7
  s_cbranch_scc1 Ld44
Lp43:
  ds_read_b128 v[28:31], v11 offset:0
  s_waitcnt lgkmcnt(0)
  v_min_u32 v9, v28, v29
  v_min3_u32 v9, v9, v30, v31
  s_nop 0
  v_readfirstlane_b32 s58, v9
  s_cmp_ge_u32 s58, 7
  s_cbranch_scc1 Ld44
  s_sub_u32 s54, s54, 1
  s_cmp_gt_i32 s54, 0
  s_cbranch_scc1 Lp43
Ld44:
  ds_read_b128 v[232:235], v32 offset:8192
  ds_read_b128 v[236:239], v33 offset:8192
  ds_read_b128 v[240:243], v34 offset:8192
  ds_read_b128 v[244:247], v35 offset:8192
  ds_read_b64_tr_b16 v[40:41], v16 offset:49152
  ds_read_b64_tr_b16 v[42:43], v16 offset:49664
  s_waitcnt lgkmcnt(10)
  v_mfma_f32_32x32x16_bf16 v[88:103], v[60:63], v[224:227], v[88:103]
  ds_read_b64_tr_b16 v[44:45], v17 offset:49152
  ds_read_b64_tr_b16 v[46:47], v17 offset:49664
  s_waitcnt lgkmcnt(10)
  v_mfma_f32_32x32x16_bf16 v[72:87], v[64:67], v[228:231], v[72:87]
  ds_read_b64_tr_b16 v[48:49], v16 offset:51200
  ds_read_b64_tr_b16 v[50:51], v16 offset:51712
  s_waitcnt lgkmcnt(10)
  v_mfma_f32_32x32x16_bf16 v[88:103], v[68:71], v[228:231], v[88:103]
  v_mov_b32 v10, 6
  ds_write_b32 v12, v10 offset:16
  ds_read_b64_tr_b16 v[52:53], v17 offset:51200
  ds_read_b64_tr_b16 v[54:55], v17 offset:51712
  s_waitcnt lgkmcnt(9)
  s_waitcnt lgkmcnt(7)
  v_mfma_f32_32x32x16_bf16 v[72:87], v[40:43], v[232:235], v[72:87]
  ds_read_b64_tr_b16 v[56:57], v16 offset:53248
  ds_read_b64_tr_b16 v[58:59], v16 offset:53760
  s_waitcnt lgkmcnt(7)
  v_mfma_f32_32x32x16_bf16 v[88:103], v[44:47], v[232:235], v[88:103]
  ds_read_b64_tr_b16 v[60:61], v17 offset:53248
  ds_read_b64_tr_b16 v[62:63], v17 offset:53760
  s_waitcnt lgkmcnt(7)
  v_mfma_f32_32x32x16_bf16 v[72:87], v[48:51], v[236:239], v[72:87]
  ds_read_b64_tr_b16 v[64:65], v16 offset:55296
  ds_read_b64_tr_b16 v[66:67], v16 offset:55808
  s_waitcnt lgkmcnt(6)
  v_mfma_f32_32x32x16_bf16 v[88:103], v[52:55], v[236:239], v[88:103]
  ds_read_b64_tr_b16 v[68:69], v17 offset:55296
  ds_read_b64_tr_b16 v[70:71], v17 offset:55808
  s_waitcnt lgkmcnt(6)
  v_mfma_f32_32x32x16_bf16 v[72:87], v[56:59], v[240:243], v[72:87]
  s_waitcnt lgkmcnt(4)
  v_mfma_f32_32x32x16_bf16 v[88:103], v[60:63], v[240:243], v[88:103]
  s_waitcnt lgkmcnt(2)
  v_mfma_f32_32x32x16_bf16 v[72:87], v[64:67], v[244:247], v[72:87]
  s_waitcnt lgkmcnt(0)
  v_mfma_f32_32x32x16_bf16 v[88:103], v[68:71], v[244:247], v[88:103]
  v_mov_b32 v10, 7
  ds_write_b32 v12, v10 offset:16
  s_nop 7
  s_nop 1
  v_cvt_pk_bf16_f32 v72, v72, v73
  v_cvt_pk_bf16_f32 v73, v74, v75
  buffer_store_dwordx2 v[72:73], v20, s[28:31], s62 offen sc1
  v_cvt_pk_bf16_f32 v76, v76, v77
  v_cvt_pk_bf16_f32 v77, v78, v79
  buffer_store_dwordx2 v[76:77], v21, s[28:31], s62 offen sc1
  v_cvt_pk_bf16_f32 v80, v80, v81
  v_cvt_pk_bf16_f32 v81, v82, v83
  buffer_store_dwordx2 v[80:81], v22, s[28:31], s62 offen sc1
  v_cvt_pk_bf16_f32 v84, v84, v85
  v_cvt_pk_bf16_f32 v85, v86, v87
  buffer_store_dwordx2 v[84:85], v23, s[28:31], s62 offen sc1
  s_nop 2
  v_cvt_pk_bf16_f32 v88, v88, v89
  v_cvt_pk_bf16_f32 v89, v90, v91
  buffer_store_dwordx2 v[88:89], v24, s[28:31], s62 offen sc1
  v_cvt_pk_bf16_f32 v92, v92, v93
  v_cvt_pk_bf16_f32 v93, v94, v95
  buffer_store_dwordx2 v[92:93], v25, s[28:31], s62 offen sc1
  v_cvt_pk_bf16_f32 v96, v96, v97
  v_cvt_pk_bf16_f32 v97, v98, v99
  buffer_store_dwordx2 v[96:97], v26, s[28:31], s62 offen sc1
  v_cvt_pk_bf16_f32 v100, v100, v101
  v_cvt_pk_bf16_f32 v101, v102, v103
  buffer_store_dwordx2 v[100:101], v27, s[28:31], s62 offen sc1
  s_branch f_kvj
f_kvv:
  s_lshl_b32 s55, s52, 6
  s_sub_u32 s55, s55, 448
  v_add_u32 v3, s55, v7
  v_mul_u32_u24 v6, 448, v8
  v_add_u32 v6, 1792, v6
  v_add_u32 v4, 0, v3
  v_mul_u32_u24 v5, 2341, v4
  v_lshrrev_b32 v5, 16, v5
  v_lshl_add_u32 v4, v4, 4, v6
  v_mul_u32_u24 v5, 228928, v5
  v_add_u32 v20, v4, v5
  v_add_u32 v4, 32, v3
  v_mul_u32_u24 v5, 2341, v4
  v_lshrrev_b32 v5, 16, v5
  v_lshl_add_u32 v4, v4, 4, v6
  v_mul_u32_u24 v5, 228928, v5
  v_add_u32 v21, v4, v5
Lp45:
  ds_read_b128 v[28:31], v11 offset:0
  s_waitcnt lgkmcnt(0)
  v_min_u32 v9, v28, v29
  v_min3_u32 v9, v9, v30, v31
  s_nop 0
  v_readfirstlane_b32 s58, v9
  s_cmp_ge_u32 s58, 1
  s_cbranch_scc1 Ld46
  s_sub_u32 s54, s54, 1
  s_cmp_gt_i32 s54, 0
  s_cbranch_scc1 Lp45
Ld46:
  ds_read_b128 v[136:139], v32 offset:0
  ds_read_b128 v[140:143], v33 offset:0
  ds_read_b128 v[144:147], v34 offset:0
  ds_read_b128 v[148:151], v35 offset:0
  v_mov_b32 v10, 1
  ds_write_b32 v12, v10 offset:64
  ds_read_b64_tr_b16 v[40:41], v16 offset:0
  ds_read_b64_tr_b16 v[42:43], v16 offset:512
  ds_read_b64_tr_b16 v[44:45], v17 offset:0
  ds_read_b64_tr_b16 v[46:47], v17 offset:512
  ds_read_b64_tr_b16 v[48:49], v16 offset:2048
  ds_read_b64_tr_b16 v[50:51], v16 offset:2560
  ds_read_b64_tr_b16 v[52:53], v17 offset:2048
  ds_read_b64_tr_b16 v[54:55], v17 offset:2560
  s_waitcnt lgkmcnt(9)
  s_waitcnt lgkmcnt(6)
  v_mfma_f32_32x32x16_bf16 v[72:87], v[136:139], v[40:43], 0
  ds_read_b64_tr_b16 v[56:57], v16 offset:4096
  ds_read_b64_tr_b16 v[58:59], v16 offset:4608
  s_waitcnt lgkmcnt(6)
  v_mfma_f32_32x32x16_bf16 v[88:103], v[136:139], v[44:47], 0
  ds_read_b128 v[28:31], v11 offset:0
  ds_read_b64_tr_b16 v[60:61], v17 offset:4096
  ds_read_b64_tr_b16 v[62:63], v17 offset:4608
  s_waitcnt lgkmcnt(7)
  v_mfma_f32_32x32x16_bf16 v[72:87], v[140:143], v[48:51], v[72:87]
  ds_read_b64_tr_b16 v[64:65], v16 offset:6144
  ds_read_b64_tr_b16 v[66:67], v16 offset:6656
  s_waitcnt lgkmcnt(7)
  v_mfma_f32_32x32x16_bf16 v[88:103], v[140:143], v[52:55], v[88:103]
  ds_read_b64_tr_b16 v[68:69], v17 offset:6144
  ds_read_b64_tr_b16 v[70:71], v17 offset:6656
  s_waitcnt lgkmcnt(7)
  v_mfma_f32_32x32x16_bf16 v[72:87], v[144:147], v[56:59], v[72:87]
  s_waitcnt lgkmcnt(6)
  v_min_u32 v9, v28, v29
  v_min3_u32 v9, v9, v30, v31
  s_nop 0
  v_readfirstlane_b32 s58, v9
  s_cmp_ge_u32 s58, 2
  s_cbranch_scc1 Ld48
Lp47:
  ds_read_b128 v[28:31], v11 offset:0
  s_waitcnt lgkmcnt(0)
  v_min_u32 v9, v28, v29
  v_min3_u32 v9, v9, v30, v31
  s_nop 0
  v_readfirstlane_b32 s58, v9
  s_cmp_ge_u32 s58, 2
  s_cbranch_scc1 Ld48
  s_sub_u32 s54, s54, 1
  s_cmp_gt_i32 s54, 0
  s_cbranch_scc1 Lp47
Ld48:
  ds_read_b128 v[152:155], v32 offset:4096
  ds_read_b128 v[156:159], v33 offset:4096
  ds_read_b128 v[160:163], v34 offset:4096
  ds_read_b128 v[164:167], v35 offset:4096
  v_mov_b32 v10, 2
  ds_write_b32 v12, v10 offset:64
  ds_read_b64_tr_b16 v[40:41], v16 offset:8192
  ds_read_b64_tr_b16 v[42:43], v16 offset:8704
  s_waitcnt lgkmcnt(11)
  v_mfma_f32_32x32x16_bf16 v[88:103], v[144:147], v[60:63], v[88:103]
  ds_read_b64_tr_b16 v[44:45], v17 offset:8192
  ds_read_b64_tr_b16 v[46:47], v17 offset:8704
  s_waitcnt lgkmcnt(11)
  v_mfma_f32_32x32x16_bf16 v[72:87], v[148:151], v[64:67], v[72:87]
  ds_read_b64_tr_b16 v[48:49], v16 offset:10240
  ds_read_b64_tr_b16 v[50:51], v16 offset:10752
  s_waitcnt lgkmcnt(11)
  v_mfma_f32_32x32x16_bf16 v[88:103], v[148:151], v[68:71], v[88:103]
  v_mov_b32 v10, 1
  ds_write_b32 v12, v10 offset:16
  ds_read_b64_tr_b16 v[52:53], v17 offset:10240
  ds_read_b64_tr_b16 v[54:55], v17 offset:10752
  s_waitcnt lgkmcnt(10)
  s_waitcnt lgkmcnt(7)
  v_mfma_f32_32x32x16_bf16 v[72:87], v[152:155], v[40:43], v[72:87]
  ds_read_b64_tr_b16 v[56:57], v16 offset:12288
  ds_read_b64_tr_b16 v[58:59], v16 offset:12800
  s_waitcnt lgkmcnt(7)
  v_mfma_f32_32x32x16_bf16 v[88:103], v[152:155], v[44:47], v[88:103]
  ds_read_b128 v[28:31], v11 offset:0
  ds_read_b64_tr_b16 v[60:61], v17 offset:12288
  ds_read_b64_tr_b16 v[62:63], v17 offset:12800
  s_waitcnt lgkmcnt(8)
  v_mfma_f32_32x32x16_bf16 v[72:87], v[156:159], v[48:51], v[72:87]
  ds_read_b64_tr_b16 v[64:65], v16 offset:14336
  ds_read_b64_tr_b16 v[66:67], v16 offset:14848
  s_waitcnt lgkmcnt(7)
  v_mfma_f32_32x32x16_bf16 v[88:103], v[156:159], v[52:55], v[88:103]
  ds_read_b64_tr_b16 v[68:69], v17 offset:14336
  ds_read_b64_tr_b16 v[70:71], v17 offset:14848
  s_waitcnt lgkmcnt(7)
  v_mfma_f32_32x32x16_bf16 v[72:87], v[160:163], v[56:59], v[72:87]
  s_waitcnt lgkmcnt(6)
  v_min_u32 v9, v28, v29
  v_min3_u32 v9, v9, v30, v31
  s_nop 0
  v_readfirstlane_b32 s58, v9
  s_cmp_ge_u32 s58, 3
  s_cbranch_scc1 Ld50
Lp49:
  ds_read_b128 v[28:31], v11 offset:0
  s_waitcnt lgkmcnt(0)
  v_min_u32 v9, v28, v29
  v_min3_u32 v9, v9, v30, v31
  s_nop 0
  v_readfirstlane_b32 s58, v9
  s_cmp_ge_u32 s58, 3
  s_cbranch_scc1 Ld50
  s_sub_u32 s54, s54, 1
  s_cmp_gt_i32 s54, 0
  s_cbranch_scc1 Lp49
Ld50:
  ds_read_b128 v[168:171], v32 offset:8192
  ds_read_b128 v[172:175], v33 offset:8192
  ds_read_b128 v[176:179], v34 offset:8192
  ds_read_b128 v[180:183], v35 offset:8192
  v_mov_b32 v10, 3
  ds_write_b32 v12, v10 offset:64
  ds_read_b64_tr_b16 v[40:41], v16 offset:16384
  ds_read_b64_tr_b16 v[42:43], v16 offset:16896
  s_waitcnt lgkmcnt(11)
  v_mfma_f32_32x32x16_bf16 v[88:103], v[160:163], v[60:63], v[88:103]
  ds_read_b64_tr_b16 v[44:45], v17 offset:16384
  ds_read_b64_tr_b16 v[46:47], v17 offset:16896
  s_waitcnt lgkmcnt(11)
  v_mfma_f32_32x32x16_bf16 v[72:87], v[164:167], v[64:67], v[72:87]
  ds_read_b64_tr_b16 v[48:49], v16 offset:18432
  ds_read_b64_tr_b16 v[50:51], v16 offset:18944
  s_waitcnt lgkmcnt(11)
  v_mfma_f32_32x32x16_bf16 v[88:103], v[164:167], v[68:71], v[88:103]
  v_mov_b32 v10, 2
  ds_write_b32 v12, v10 offset:16
  ds_read_b64_tr_b16 v[52:53], v17 offset:18432
  ds_read_b64_tr_b16 v[54:55], v17 offset:18944
  s_waitcnt lgkmcnt(10)
  s_waitcnt lgkmcnt(7)
  v_mfma_f32_32x32x16_bf16 v[72:87], v[168:171], v[40:43], v[72:87]
  ds_read_b64_tr_b16 v[56:57], v16 offset:20480
  ds_read_b64_tr_b16 v[58:59], v16 offset:20992
  s_waitcnt lgkmcnt(7)
  v_mfma_f32_32x32x16_bf16 v[88:103], v[168:171], v[44:47], v[88:103]
  ds_read_b128 v[28:31], v11 offset:0
  ds_read_b64_tr_b16 v[60:61], v17 offset:20480
  ds_read_b64_tr_b16 v[62:63], v17 offset:20992
  s_waitcnt lgkmcnt(8)
  v_mfma_f32_32x32x16_bf16 v[72:87], v[172:175], v[48:51], v[72:87]
  ds_read_b64_tr_b16 v[64:65], v16 offset:22528
  ds_read_b64_tr_b16 v[66:67], v16 offset:23040
  s_waitcnt lgkmcnt(7)
  v_mfma_f32_32x32x16_bf16 v[88:103], v[172:175], v[52:55], v[88:103]
  ds_read_b64_tr_b16 v[68:69], v17 offset:22528
  ds_read_b64_tr_b16 v[70:71], v17 offset:23040
  s_waitcnt lgkmcnt(7)
  v_mfma_f32_32x32x16_bf16 v[72:87], v[176:179], v[56:59], v[72:87]
  s_waitcnt lgkmcnt(6)
  v_min_u32 v9, v28, v29
  v_min3_u32 v9, v9, v30, v31
  s_nop 0
  v_readfirstlane_b32 s58, v9
  s_cmp_ge_u32 s58, 4
  s_cbranch_scc1 Ld52
Lp51:
  ds_read_b128 v[28:31], v11 offset:0
  s_waitcnt lgkmcnt(0)
  v_min_u32 v9, v28, v29
  v_min3_u32 v9, v9, v30, v31
  s_nop 0
  v_readfirstlane_b32 s58, v9
  s_cmp_ge_u32 s58, 4
  s_cbranch_scc1 Ld52
  s_sub_u32 s54, s54, 1
  s_cmp_gt_i32 s54, 0
  s_cbranch_scc1 Lp51
Ld52:
  ds_read_b128 v[184:187], v32 offset:12288
  ds_read_b128 v[188:191], v33 offset:12288
  ds_read_b128 v[192:195], v34 offset:12288
  ds_read_b128 v[196:199], v35 offset:12288
  ds_read_b64_tr_b16 v[40:41], v16 offset:24576
  ds_read_b64_tr_b16 v[42:43], v16 offset:25088
  s_waitcnt lgkmcnt(10)
  v_mfma_f32_32x32x16_bf16 v[88:103], v[176:179], v[60:63], v[88:103]
  ds_read_b64_tr_b16 v[44:45], v17 offset:24576
  ds_read_b64_tr_b16 v[46:47], v17 offset:25088
  s_waitcnt lgkmcnt(10)
  v_mfma_f32_32x32x16_bf16 v[72:87], v[180:183], v[64:67], v[72:87]
  ds_read_b64_tr_b16 v[48:49], v16 offset:26624
  ds_read_b64_tr_b16 v[50:51], v16 offset:27136
  s_waitcnt lgkmcnt(10)
  v_mfma_f32_32x32x16_bf16 v[88:103], v[180:183], v[68:71], v[88:103]
  v_mov_b32 v10, 3
  ds_write_b32 v12, v10 offset:16
  ds_read_b64_tr_b16 v[52:53], v17 offset:26624
  ds_read_b64_tr_b16 v[54:55], v17 offset:27136
  s_waitcnt lgkmcnt(9)
  s_waitcnt lgkmcnt(7)
  v_mfma_f32_32x32x16_bf16 v[72:87], v[184:187], v[40:43], v[72:87]
  ds_read_b64_tr_b16 v[56:57], v16 offset:28672
  ds_read_b64_tr_b16 v[58:59], v16 offset:29184
  s_waitcnt lgkmcnt(7)
  v_mfma_f32_32x32x16_bf16 v[88:103], v[184:187], v[44:47], v[88:103]
  ds_read_b128 v[28:31], v11 offset:0
  ds_read_b64_tr_b16 v[60:61], v17 offset:28672
  ds_read_b64_tr_b16 v[62:63], v17 offset:29184
  s_waitcnt lgkmcnt(8)
  v_mfma_f32_32x32x16_bf16 v[72:87], v[188:191], v[48:51], v[72:87]
  ds_read_b64_tr_b16 v[64:65], v16 offset:30720
  ds_read_b64_tr_b16 v[66:67], v16 offset:31232
  s_waitcnt lgkmcnt(7)
  v_mfma_f32_32x32x16_bf16 v[88:103], v[188:191], v[52:55], v[88:103]
  ds_read_b64_tr_b16 v[68:69], v17 offset:30720
  ds_read_b64_tr_b16 v[70:71], v17 offset:31232
  s_waitcnt lgkmcnt(7)
  v_mfma_f32_32x32x16_bf16 v[72:87], v[192:195], v[56:59], v[72:87]
  s_waitcnt lgkmcnt(6)
  v_min_u32 v9, v28, v29
  v_min3_u32 v9, v9, v30, v31
  s_nop 0
  v_readfirstlane_b32 s58, v9
  s_cmp_ge_u32 s58, 5
  s_cbranch_scc1 Ld54
Lp53:
  ds_read_b128 v[28:31], v11 offset:0
  s_waitcnt lgkmcnt(0)
  v_min_u32 v9, v28, v29
  v_min3_u32 v9, v9, v30, v31
  s_nop 0
  v_readfirstlane_b32 s58, v9
  s_cmp_ge_u32 s58, 5
  s_cbranch_scc1 Ld54
  s_sub_u32 s54, s54, 1
  s_cmp_gt_i32 s54, 0
  s_cbranch_scc1 Lp53
Ld54:
  ds_read_b128 v[200:203], v32 offset:0
  ds_read_b128 v[204:207], v33 offset:0
  ds_read_b128 v[208:211], v34 offset:0
  ds_read_b128 v[212:215], v35 offset:0
  ds_read_b64_tr_b16 v[40:41], v16 offset:32768
  ds_read_b64_tr_b16 v[42:43], v16 offset:33280
  s_waitcnt lgkmcnt(10)
  v_mfma_f32_32x32x16_bf16 v[88:103], v[192:195], v[60:63], v[88:103]
  ds_read_b64_tr_b16 v[44:45], v17 offset:32768
  ds_read_b64_tr_b16 v[46:47], v17 offset:33280
  s_waitcnt lgkmcnt(10)
  v_mfma_f32_32x32x16_bf16 v[72:87], v[196:199], v[64:67], v[72:87]
  ds_read_b64_tr_b16 v[48:49], v16 offset:34816
  ds_read_b64_tr_b16 v[50:51], v16 offset:35328
  s_waitcnt lgkmcnt(10)
  v_mfma_f32_32x32x16_bf16 v[88:103], v[196:199], v[68:71], v[88:103]
  v_mov_b32 v10, 4
  ds_write_b32 v12, v10 offset:16
  ds_read_b64_tr_b16 v[52:53], v17 offset:34816
  ds_read_b64_tr_b16 v[54:55], v17 offset:35328
  s_waitcnt lgkmcnt(9)
  s_waitcnt lgkmcnt(7)
  v_mfma_f32_32x32x16_bf16 v[72:87], v[200:203], v[40:43], v[72:87]
  ds_read_b64_tr_b16 v[56:57], v16 offset:36864
  ds_read_b64_tr_b16 v[58:59], v16 offset:37376
  s_waitcnt lgkmcnt(7)
  v_mfma_f32_32x32x16_bf16 v[88:103], v[200:203], v[44:47], v[88:103]
  ds_read_b128 v[28:31], v11 offset:0
  ds_read_b64_tr_b16 v[60:61], v17 offset:36864
  ds_read_b64_tr_b16 v[62:63], v17 offset:37376
  s_waitcnt lgkmcnt(8)
  v_mfma_f32_32x32x16_bf16 v[72:87], v[204:207], v[48:51], v[72:87]
  ds_read_b64_tr_b16 v[64:65], v16 offset:38912
  ds_read_b64_tr_b16 v[66:67], v16 offset:39424
  s_waitcnt lgkmcnt(7)
  v_mfma_f32_32x32x16_bf16 v[88:103], v[204:207], v[52:55], v[88:103]
  ds_read_b64_tr_b16 v[68:69], v17 offset:38912
  ds_read_b64_tr_b16 v[70:71], v17 offset:39424
  s_waitcnt lgkmcnt(7)
  v_mfma_f32_32x32x16_bf16 v[72:87], v[208:211], v[56:59], v[72:87]
  s_waitcnt lgkmcnt(6)
  v_min_u32 v9, v28, v29
  v_min3_u32 v9, v9, v30, v31
  s_nop 0
  v_readfirstlane_b32 s58, v9
  s_cmp_ge_u32 s58, 6
  s_cbranch_scc1 Ld56
Lp55:
  ds_read_b128 v[28:31], v11 offset:0
  s_waitcnt lgkmcnt(0)
  v_min_u32 v9, v28, v29
  v_min3_u32 v9, v9, v30, v31
  s_nop 0
  v_readfirstlane_b32 s58, v9
  s_cmp_ge_u32 s58, 6
  s_cbranch_scc1 Ld56
  s_sub_u32 s54, s54, 1
  s_cmp_gt_i32 s54, 0
  s_cbranch_scc1 Lp55
Ld56:
  ds_read_b128 v[216:219], v32 offset:4096
  ds_read_b128 v[220:223], v33 offset:4096
  ds_read_b128 v[224:227], v34 offset:4096
  ds_read_b128 v[228:231], v35 offset:4096
  ds_read_b64_tr_b16 v[40:41], v16 offset:40960
  ds_read_b64_tr_b16 v[42:43], v16 offset:41472
  s_waitcnt lgkmcnt(10)
  v_mfma_f32_32x32x16_bf16 v[88:103], v[208:211], v[60:63], v[88:103]
  ds_read_b64_tr_b16 v[44:45], v17 offset:40960
  ds_read_b64_tr_b16 v[46:47], v17 offset:41472
  s_waitcnt lgkmcnt(10)
  v_mfma_f32_32x32x16_bf16 v[72:87], v[212:215], v[64:67], v[72:87]
  ds_read_b64_tr_b16 v[48:49], v16 offset:43008
  ds_read_b64_tr_b16 v[50:51], v16 offset:43520
  s_waitcnt lgkmcnt(10)
  v_mfma_f32_32x32x16_bf16 v[88:103], v[212:215], v[68:71], v[88:103]
  v_mov_b32 v10, 5
  ds_write_b32 v12, v10 offset:16
  ds_read_b64_tr_b16 v[52:53], v17 offset:43008
  ds_read_b64_tr_b16 v[54:55], v17 offset:43520
  s_waitcnt lgkmcnt(9)
  s_waitcnt lgkmcnt(7)
  v_mfma_f32_32x32x16_bf16 v[72:87], v[216:219], v[40:43], v[72:87]
  ds_read_b64_tr_b16 v[56:57], v16 offset:45056
  ds_read_b64_tr_b16 v[58:59], v16 offset:45568
  s_waitcnt lgkmcnt(7)
  v_mfma_f32_32x32x16_bf16 v[88:103], v[216:219], v[44:47], v[88:103]
  ds_read_b128 v[28:31], v11 offset:0
  ds_read_b64_tr_b16 v[60:61], v17 offset:45056
  ds_read_b64_tr_b16 v[62:63], v17 offset:45568
  s_waitcnt lgkmcnt(8)
  v_mfma_f32_32x32x16_bf16 v[72:87], v[220:223], v[48:51], v[72:87]
  ds_read_b64_tr_b16 v[64:65], v16 offset:47104
  ds_read_b64_tr_b16 v[66:67], v16 offset:47616
  s_waitcnt lgkmcnt(7)
  v_mfma_f32_32x32x16_bf16 v[88:103], v[220:223], v[52:55], v[88:103]
  ds_read_b64_tr_b16 v[68:69], v17 offset:47104
  ds_read_b64_tr_b16 v[70:71], v17 offset:47616
  s_waitcnt lgkmcnt(7)
  v_mfma_f32_32x32x16_bf16 v[72:87], v[224:227], v[56:59], v[72:87]
  s_waitcnt lgkmcnt(6)
  v_min_u32 v9, v28, v29
  v_min3_u32 v9, v9, v30, v31
  s_nop 0
  v_readfirstlane_b32 s58, v9
  s_cmp_ge_u32 s58, 7
  s_cbranch_scc1 Ld58
Lp57:
  ds_read_b128 v[28:31], v11 offset:0
  s_waitcnt lgkmcnt(0)
  v_min_u32 v9, v28, v29
  v_min3_u32 v9, v9, v30, v31
  s_nop 0
  v_readfirstlane_b32 s58, v9
  s_cmp_ge_u32 s58, 7
  s_cbranch_scc1 Ld58
  s_sub_u32 s54, s54, 1
  s_cmp_gt_i32 s54, 0
  s_cbranch_scc1 Lp57
Ld58:
  ds_read_b128 v[232:235], v32 offset:8192
  ds_read_b128 v[236:239], v33 offset:8192
  ds_read_b128 v[240:243], v34 offset:8192
  ds_read_b128 v[244:247], v35 offset:8192
  ds_read_b64_tr_b16 v[40:41], v16 offset:49152
  ds_read_b64_tr_b16 v[42:43], v16 offset:49664
  s_waitcnt lgkmcnt(10)
  v_mfma_f32_32x32x16_bf16 v[88:103], v[224:227], v[60:63], v[88:103]
  ds_read_b64_tr_b16 v[44:45], v17 offset:49152
  ds_read_b64_tr_b16 v[46:47], v17 offset:49664
  s_waitcnt lgkmcnt(10)
  v_mfma_f32_32x32x16_bf16 v[72:87], v[228:231], v[64:67], v[72:87]
  ds_read_b64_tr_b16 v[48:49], v16 offset:51200
  ds_read_b64_tr_b16 v[50:51], v16 offset:51712
  s_waitcnt lgkmcnt(10)
  v_mfma_f32_32x32x16_bf16 v[88:103], v[228:231], v[68:71], v[88:103]
  v_mov_b32 v10, 6
  ds_write_b32 v12, v10 offset:16
  ds_read_b64_tr_b16 v[52:53], v17 offset:51200
  ds_read_b64_tr_b16 v[54:55], v17 offset:51712
  s_waitcnt lgkmcnt(9)
  s_waitcnt lgkmcnt(7)
  v_mfma_f32_32x32x16_bf16 v[72:87], v[232:235], v[40:43], v[72:87]
  ds_read_b64_tr_b16 v[56:57], v16 offset:53248
  ds_read_b64_tr_b16 v[58:59], v16 offset:53760
  s_waitcnt lgkmcnt(7)
  v_mfma_f32_32x32x16_bf16 v[88:103], v[232:235], v[44:47], v[88:103]
  ds_read_b64_tr_b16 v[60:61], v17 offset:53248
  ds_read_b64_tr_b16 v[62:63], v17 offset:53760
  s_waitcnt lgkmcnt(7)
  v_mfma_f32_32x32x16_bf16 v[72:87], v[236:239], v[48:51], v[72:87]
  ds_read_b64_tr_b16 v[64:65], v16 offset:55296
  ds_read_b64_tr_b16 v[66:67], v16 offset:55808
  s_waitcnt lgkmcnt(6)
  v_mfma_f32_32x32x16_bf16 v[88:103], v[236:239], v[52:55], v[88:103]
  ds_read_b64_tr_b16 v[68:69], v17 offset:55296
  ds_read_b64_tr_b16 v[70:71], v17 offset:55808
  s_waitcnt lgkmcnt(6)
  v_mfma_f32_32x32x16_bf16 v[72:87], v[240:243], v[56:59], v[72:87]
  s_waitcnt lgkmcnt(4)
  v_mfma_f32_32x32x16_bf16 v[88:103], v[240:243], v[60:63], v[88:103]
  s_waitcnt lgkmcnt(2)
  v_mfma_f32_32x32x16_bf16 v[72:87], v[244:247], v[64:67], v[72:87]
  s_waitcnt lgkmcnt(0)
  v_mfma_f32_32x32x16_bf16 v[88:103], v[244:247], v[68:71], v[88:103]
  v_mov_b32 v10, 7
  ds_write_b32 v12, v10 offset:16
  s_nop 7
  s_nop 1
  v_cvt_pk_bf16_f32 v72, v72, v73
  v_cvt_pk_bf16_f32 v73, v74, v75
  v_cvt_pk_bf16_f32 v74, v76, v77
  v_cvt_pk_bf16_f32 v75, v78, v79
  buffer_store_dwordx4 v[72:75], v20, s[28:31], s62 offen offset:0 sc1
  v_cvt_pk_bf16_f32 v80, v80, v81
  v_cvt_pk_bf16_f32 v81, v82, v83
  v_cvt_pk_bf16_f32 v82, v84, v85
  v_cvt_pk_bf16_f32 v83, v86, v87
  buffer_store_dwordx4 v[80:83], v20, s[28:31], s62 offen offset:896 sc1
  v_cvt_pk_bf16_f32 v88, v88, v89
  v_cvt_pk_bf16_f32 v89, v90, v91
  v_cvt_pk_bf16_f32 v90, v92, v93
  v_cvt_pk_bf16_f32 v91, v94, v95
  buffer_store_dwordx4 v[88:91], v21, s[28:31], s62 offen offset:0 sc1
  v_cvt_pk_bf16_f32 v96, v96, v97
  v_cvt_pk_bf16_f32 v97, v98, v99
  v_cvt_pk_bf16_f32 v98, v100, v101
  v_cvt_pk_bf16_f32 v99, v102, v103
  buffer_store_dwordx4 v[96:99], v21, s[28:31], s62 offen offset:896 sc1
  s_branch f_kvj
f_kvn:
Lp59:
  ds_read_b128 v[28:31], v11 offset:0
  s_waitcnt lgkmcnt(0)
  v_min_u32 v9, v28, v29
  v_min3_u32 v9, v9, v30, v31
  s_nop 0
  v_readfirstlane_b32 s58, v9
  s_cmp_ge_u32 s58, 1
  s_cbranch_scc1 Ld60
  s_sub_u32 s54, s54, 1
  s_cmp_gt_i32 s54, 0
  s_cbranch_scc1 Lp59
Ld60:
  ds_read_b128 v[136:139], v32 offset:0
  ds_read_b128 v[140:143], v33 offset:0
  ds_read_b128 v[144:147], v34 offset:0
  ds_read_b128 v[148:151], v35 offset:0
  v_mov_b32 v10, 1
  ds_write_b32 v12, v10 offset:64
  s_waitcnt lgkmcnt(1)
Lp61:
  ds_read_b128 v[28:31], v11 offset:0
  s_waitcnt lgkmcnt(0)
  v_min_u32 v9, v28, v29
  v_min3_u32 v9, v9, v30, v31
  s_nop 0
  v_readfirstlane_b32 s58, v9
  s_cmp_ge_u32 s58, 2
  s_cbranch_scc1 Ld62
  s_sub_u32 s54, s54, 1
  s_cmp_gt_i32 s54, 0
  s_cbranch_scc1 Lp61
Ld62:
  ds_read_b128 v[152:155], v32 offset:4096
  ds_read_b128 v[156:159], v33 offset:4096
  ds_read_b128 v[160:163], v34 offset:4096
  ds_read_b128 v[164:167], v35 offset:4096
  v_mov_b32 v10, 2
  ds_write_b32 v12, v10 offset:64
  s_waitcnt lgkmcnt(1)
Lp63:
  ds_read_b128 v[28:31], v11 offset:0
  s_waitcnt lgkmcnt(0)
  v_min_u32 v9, v28, v29
  v_min3_u32 v9, v9, v30, v31
  s_nop 0
  v_readfirstlane_b32 s58, v9
  s_cmp_ge_u32 s58, 3
  s_cbranch_scc1 Ld64
  s_sub_u32 s54, s54, 1
  s_cmp_gt_i32 s54, 0
  s_cbranch_scc1 Lp63
Ld64:
  ds_read_b128 v[168:171], v32 offset:8192
  ds_read_b128 v[172:175], v33 offset:8192
  ds_read_b128 v[176:179], v34 offset:8192
  ds_read_b128 v[180:183], v35 offset:8192
  v_mov_b32 v10, 3
  ds_write_b32 v12, v10 offset:64
  s_waitcnt lgkmcnt(1)
Lp65:
  ds_read_b128 v[28:31], v11 offset:0
  s_waitcnt lgkmcnt(0)
  v_min_u32 v9, v28, v29
  v_min3_u32 v9, v9, v30, v31
  s_nop 0
  v_readfirstlane_b32 s58, v9
  s_cmp_ge_u32 s58, 4
  s_cbranch_scc1 Ld66
  s_sub_u32 s54, s54, 1
  s_cmp_gt_i32 s54, 0
  s_cbranch_scc1 Lp65
Ld66:
  ds_read_b128 v[184:187], v32 offset:12288
  ds_read_b128 v[188:191], v33 offset:12288
  ds_read_b128 v[192:195], v34 offset:12288
  ds_read_b128 v[196:199], v35 offset:12288
  s_waitcnt lgkmcnt(0)
Lp67:
  ds_read_b128 v[28:31], v11 offset:0
  s_waitcnt lgkmcnt(0)
  v_min_u32 v9, v28, v29
  v_min3_u32 v9, v9, v30, v31
  s_nop 0
  v_readfirstlane_b32 s58, v9
  s_cmp_ge_u32 s58, 5
  s_cbranch_scc1 Ld68
  s_sub_u32 s54, s54, 1
  s_cmp_gt_i32 s54, 0
  s_cbranch_scc1 Lp67
Ld68:
  ds_read_b128 v[200:203], v32 offset:0
  ds_read_b128 v[204:207], v33 offset:0
  ds_read_b128 v[208:211], v34 offset:0
  ds_read_b128 v[212:215], v35 offset:0
  s_waitcnt lgkmcnt(0)
Lp69:
  ds_read_b128 v[28:31], v11 offset:0
  s_waitcnt lgkmcnt(0)
  v_min_u32 v9, v28, v29
  v_min3_u32 v9, v9, v30, v31
  s_nop 0
  v_readfirstlane_b32 s58, v9
  s_cmp_ge_u32 s58, 6
  s_cbranch_scc1 Ld70
  s_sub_u32 s54, s54, 1
  s_cmp_gt_i32 s54, 0
  s_cbranch_scc1 Lp69
Ld70:
  ds_read_b128 v[216:219], v32 offset:4096
  ds_read_b128 v[220:223], v33 offset:4096
  ds_read_b128 v[224:227], v34 offset:4096
  ds_read_b128 v[228:231], v35 offset:4096
  s_waitcnt lgkmcnt(0)
Lp71:
  ds_read_b128 v[28:31], v11 offset:0
  s_waitcnt lgkmcnt(0)
  v_min_u32 v9, v28, v29
  v_min3_u32 v9, v9, v30, v31
  s_nop 0
  v_readfirstlane_b32 s58, v9
  s_cmp_ge_u32 s58, 7
  s_cbranch_scc1 Ld72
  s_sub_u32 s54, s54, 1
  s_cmp_gt_i32 s54, 0
  s_cbranch_scc1 Lp71
Ld72:
  ds_read_b128 v[232:235], v32 offset:8192
  ds_read_b128 v[236:239], v33 offset:8192
  ds_read_b128 v[240:243], v34 offset:8192
  ds_read_b128 v[244:247], v35 offset:8192
  s_waitcnt lgkmcnt(0)
  s_sleep 28
f_kvj:
  v_mov_b32 v15, 0
  buffer_load_dword v14, v15, s[36:39], 0 offen sc1
  s_waitcnt lgkmcnt(0)
  v_mov_b32 v10, 8
  ds_write_b32 v12, v10 offset:16
  s_lshl_b32 s55, s52, 6
  s_add_u32 s55, s55, s61
  s_lshl_b32 s55, s55, 2
  s_add_u32 s62, s55, 0x1c00000
  ds_read_b128 v[28:31], v11 offset:0
  s_waitcnt lgkmcnt(0)
  v_min_u32 v9, v28, v29
  v_min3_u32 v9, v9, v30, v31
  s_nop 0
  v_readfirstlane_b32 s58, v9
  s_cmp_ge_u32 s58, 8
  s_cbranch_scc1 Ld74
Lp73:
  ds_read_b128 v[28:31], v11 offset:0
  s_waitcnt lgkmcnt(0)
  v_min_u32 v9, v28, v29
  v_min3_u32 v9, v9, v30, v31
  s_nop 0
  v_readfirstlane_b32 s58, v9
  s_cmp_ge_u32 s58, 8
  s_cbranch_scc1 Ld74
  s_sub_u32 s54, s54, 1
  s_cmp_gt_i32 s54, 0
  s_cbranch_scc1 Lp73
Ld74:
  ds_read_b64_tr_b16 v[40:41], v18 offset:57344
  ds_read_b64_tr_b16 v[42:43], v18 offset:57600
  ds_read_b64_tr_b16 v[44:45], v18 offset:58368
  ds_read_b64_tr_b16 v[46:47], v18 offset:58624
  ds_read_b64_tr_b16 v[48:49], v18 offset:59392
  ds_read_b64_tr_b16 v[50:51], v18 offset:59648
  s_waitcnt lgkmcnt(4)
  v_mfma_f32_32x32x16_bf16 v[104:119], v[40:43], v[136:139], 0
  ds_read_b128 v[28:31], v11 offset:0
  ds_read_b64_tr_b16 v[52:53], v18 offset:60416
  ds_read_b64_tr_b16 v[54:55], v18 offset:60672
  s_waitcnt lgkmcnt(5)
  v_mfma_f32_32x32x16_bf16 v[120:135], v[44:47], v[140:143], 0
  s_waitcnt lgkmcnt(2)
  v_min_u32 v9, v28, v29
  v_min3_u32 v9, v9, v30, v31
  s_nop 0
  v_readfirstlane_b32 s58, v9
  s_cmp_ge_u32 s58, 9
  s_cbranch_scc1 Ld76
Lp75:
  ds_read_b128 v[28:31], v11 offset:0
  s_waitcnt lgkmcnt(0)
  v_min_u32 v9, v28, v29
  v_min3_u32 v9, v9, v30, v31
  s_nop 0
  v_readfirstlane_b32 s58, v9
  s_cmp_ge_u32 s58, 9
  s_cbranch_scc1 Ld76
  s_sub_u32 s54, s54, 1
  s_cmp_gt_i32 s54, 0
  s_cbranch_scc1 Lp75
Ld76:
  ds_read_b64_tr_b16 v[56:57], v18 offset:61440
  ds_read_b64_tr_b16 v[58:59], v18 offset:61696
  v_mfma_f32_32x32x16_bf16 v[104:119], v[48:51], v[144:147], v[104:119]
  ds_read_b64_tr_b16 v[60:61], v18 offset:62464
  ds_read_b64_tr_b16 v[62:63], v18 offset:62720
  s_waitcnt lgkmcnt(4)
  v_mfma_f32_32x32x16_bf16 v[120:135], v[52:55], v[148:151], v[120:135]
  ds_read_b64_tr_b16 v[64:65], v18 offset:63488
  ds_read_b64_tr_b16 v[66:67], v18 offset:63744
  s_waitcnt lgkmcnt(4)
  v_mfma_f32_32x32x16_bf16 v[104:119], v[56:59], v[152:155], v[104:119]
  ds_read_b128 v[28:31], v11 offset:0
  ds_read_b64_tr_b16 v[68:69], v18 offset:64512
  ds_read_b64_tr_b16 v[70:71], v18 offset:64768
  s_waitcnt lgkmcnt(5)
  v_mfma_f32_32x32x16_bf16 v[120:135], v[60:63], v[156:159], v[120:135]
  s_waitcnt lgkmcnt(2)
  v_min_u32 v9, v28, v29
  v_min3_u32 v9, v9, v30, v31
  s_nop 0
  v_readfirstlane_b32 s58, v9
  s_cmp_ge_u32 s58, 10
  s_cbranch_scc1 Ld78
Lp77:
  ds_read_b128 v[28:31], v11 offset:0
  s_waitcnt lgkmcnt(0)
  v_min_u32 v9, v28, v29
  v_min3_u32 v9, v9, v30, v31
  s_nop 0
  v_readfirstlane_b32 s58, v9
  s_cmp_ge_u32 s58, 10
  s_cbranch_scc1 Ld78
  s_sub_u32 s54, s54, 1
  s_cmp_gt_i32 s54, 0
  s_cbranch_scc1 Lp77
Ld78:
  ds_read_b64_tr_b16 v[40:41], v19 offset:0
  ds_read_b64_tr_b16 v[42:43], v19 offset:256
  v_mfma_f32_32x32x16_bf16 v[104:119], v[64:67], v[160:163], v[104:119]
  ds_read_b64_tr_b16 v[44:45], v19 offset:1024
  ds_read_b64_tr_b16 v[46:47], v19 offset:1280
  s_waitcnt lgkmcnt(4)
  v_mfma_f32_32x32x16_bf16 v[120:135], v[68:71], v[164:167], v[120:135]
  ds_read_b64_tr_b16 v[48:49], v19 offset:2048
  ds_read_b64_tr_b16 v[50:51], v19 offset:2304
  s_waitcnt lgkmcnt(4)
  v_mfma_f32_32x32x16_bf16 v[104:119], v[40:43], v[168:171], v[104:119]
  ds_read_b128 v[28:31], v11 offset:0
  ds_read_b64_tr_b16 v[52:53], v19 offset:3072
  ds_read_b64_tr_b16 v[54:55], v19 offset:3328
  s_waitcnt lgkmcnt(5)
  v_mfma_f32_32x32x16_bf16 v[120:135], v[44:47], v[172:175], v[120:135]
  s_waitcnt lgkmcnt(2)
  v_min_u32 v9, v28, v29
  v_min3_u32 v9, v9, v30, v31
  s_nop 0
  v_readfirstlane_b32 s58, v9
  s_cmp_ge_u32 s58, 11
  s_cbranch_scc1 Ld80
Lp79:
  ds_read_b128 v[28:31], v11 offset:0
  s_waitcnt lgkmcnt(0)
  v_min_u32 v9, v28, v29
  v_min3_u32 v9, v9, v30, v31
  s_nop 0
  v_readfirstlane_b32 s58, v9
  s_cmp_ge_u32 s58, 11
  s_cbranch_scc1 Ld80
  s_sub_u32 s54, s54, 1
  s_cmp_gt_i32 s54, 0
  s_cbranch_scc1 Lp79
Ld80:
  ds_read_b64_tr_b16 v[56:57], v19 offset:4096
  ds_read_b64_tr_b16 v[58:59], v19 offset:4352
  v_mfma_f32_32x32x16_bf16 v[104:119], v[48:51], v[176:179], v[104:119]
  ds_read_b64_tr_b16 v[60:61], v19 offset:5120
  ds_read_b64_tr_b16 v[62:63], v19 offset:5376
  s_waitcnt lgkmcnt(4)
  v_mfma_f32_32x32x16_bf16 v[120:135], v[52:55], v[180:183], v[120:135]
  ds_read_b64_tr_b16 v[64:65], v19 offset:6144
  ds_read_b64_tr_b16 v[66:67], v19 offset:6400
  s_waitcnt lgkmcnt(4)
  v_mfma_f32_32x32x16_bf16 v[104:119], v[56:59], v[184:187], v[104:119]
  ds_read_b128 v[28:31], v11 offset:0
  ds_read_b64_tr_b16 v[68:69], v19 offset:7168
  ds_read_b64_tr_b16 v[70:71], v19 offset:7424
  s_waitcnt lgkmcnt(5)
  v_mfma_f32_32x32x16_bf16 v[120:135], v[60:63], v[188:191], v[120:135]
  s_waitcnt lgkmcnt(2)
  v_min_u32 v9, v28, v29
  v_min3_u32 v9, v9, v30, v31
  s_nop 0
  v_readfirstlane_b32 s58, v9
  s_cmp_ge_u32 s58, 12
  s_cbranch_scc1 Ld82
Lp81:
  ds_read_b128 v[28:31], v11 offset:0
  s_waitcnt lgkmcnt(0)
  v_min_u32 v9, v28, v29
  v_min3_u32 v9, v9, v30, v31
  s_nop 0
  v_readfirstlane_b32 s58, v9
  s_cmp_ge_u32 s58, 12
  s_cbranch_scc1 Ld82
  s_sub_u32 s54, s54, 1
  s_cmp_gt_i32 s54, 0
  s_cbranch_scc1 Lp81
Ld82:
  ds_read_b64_tr_b16 v[40:41], v19 offset:8192
  ds_read_b64_tr_b16 v[42:43], v19 offset:8448
  v_mfma_f32_32x32x16_bf16 v[104:119], v[64:67], v[192:195], v[104:119]
  ds_read_b64_tr_b16 v[44:45], v19 offset:9216
  ds_read_b64_tr_b16 v[46:47], v19 offset:9472
  s_waitcnt lgkmcnt(4)
  v_mfma_f32_32x32x16_bf16 v[120:135], v[68:71], v[196:199], v[120:135]
  ds_read_b64_tr_b16 v[48:49], v19 offset:10240
  ds_read_b64_tr_b16 v[50:51], v19 offset:10496
  s_waitcnt lgkmcnt(4)
  v_mfma_f32_32x32x16_bf16 v[104:119], v[40:43], v[200:203], v[104:119]
  ds_read_b128 v[28:31], v11 offset:0
  ds_read_b64_tr_b16 v[52:53], v19 offset:11264
  ds_read_b64_tr_b16 v[54:55], v19 offset:11520
  s_waitcnt lgkmcnt(5)
  v_mfma_f32_32x32x16_bf16 v[120:135], v[44:47], v[204:207], v[120:135]
  s_waitcnt lgkmcnt(2)
  v_min_u32 v9, v28, v29
  v_min3_u32 v9, v9, v30, v31
  s_nop 0
  v_readfirstlane_b32 s58, v9
  s_cmp_ge_u32 s58, 13
  s_cbranch_scc1 Ld84
Lp83:
  ds_read_b128 v[28:31], v11 offset:0
  s_waitcnt lgkmcnt(0)
  v_min_u32 v9, v28, v29
  v_min3_u32 v9, v9, v30, v31
  s_nop 0
  v_readfirstlane_b32 s58, v9
  s_cmp_ge_u32 s58, 13
  s_cbranch_scc1 Ld84
  s_sub_u32 s54, s54, 1
  s_cmp_gt_i32 s54, 0
  s_cbranch_scc1 Lp83
Ld84:
  ds_read_b64_tr_b16 v[56:57], v19 offset:12288
  ds_read_b64_tr_b16 v[58:59], v19 offset:12544
  v_mfma_f32_32x32x16_bf16 v[104:119], v[48:51], v[208:211], v[104:119]
  ds_read_b64_tr_b16 v[60:61], v19 offset:13312
  ds_read_b64_tr_b16 v[62:63], v19 offset:13568
  s_waitcnt lgkmcnt(4)
  v_mfma_f32_32x32x16_bf16 v[120:135], v[52:55], v[212:215], v[120:135]
  ds_read_b64_tr_b16 v[64:65], v19 offset:14336
  ds_read_b64_tr_b16 v[66:67], v19 offset:14592
  s_waitcnt lgkmcnt(4)
  v_mfma_f32_32x32x16_bf16 v[104:119], v[56:59], v[216:219], v[104:119]
  ds_read_b128 v[28:31], v11 offset:0
  ds_read_b64_tr_b16 v[68:69], v19 offset:15360
  ds_read_b64_tr_b16 v[70:71], v19 offset:15616
  s_waitcnt vmcnt(0)
  v_cmp_le_u32 vcc, 1, v14
  s_nop 1
  s_cmp_eq_u64 vcc, exec
  s_cbranch_scc1 Le86
Lg85:
  buffer_load_dword v14, v15, s[36:39], 0 offen sc1
  s_waitcnt vmcnt(0)
  v_cmp_le_u32 vcc, 1, v14
  s_nop 1
  s_cmp_eq_u64 vcc, exec
  s_cbranch_scc1 Le86
  s_sleep 2
  s_sub_u32 s54, s54, 1
  s_cmp_gt_i32 s54, 0
  s_cbranch_scc1 Lg85
Le86:
  v_mov_b32 v9, 1
  v_mov_b32 v10, 0
  s_mov_b64 exec, 1
  buffer_store_dword v9, v10, s[28:31], s62 offen sc1
  s_mov_b64 exec, -1
  s_waitcnt lgkmcnt(5)
  v_mfma_f32_32x32x16_bf16 v[120:135], v[60:63], v[220:223], v[120:135]
  s_waitcnt lgkmcnt(2)
  v_min_u32 v9, v28, v29
  v_min3_u32 v9, v9, v30, v31
  s_nop 0
  v_readfirstlane_b32 s58, v9
  s_cmp_ge_u32 s58, 14
  s_cbranch_scc1 Ld88
Lp87:
  ds_read_b128 v[28:31], v11 offset:0
  s_waitcnt lgkmcnt(0)
  v_min_u32 v9, v28, v29
  v_min3_u32 v9, v9, v30, v31
  s_nop 0
  v_readfirstlane_b32 s58, v9
  s_cmp_ge_u32 s58, 14
  s_cbranch_scc1 Ld88
  s_sub_u32 s54, s54, 1
  s_cmp_gt_i32 s54, 0
  s_cbranch_scc1 Lp87
Ld88:
  ds_read_b64_tr_b16 v[40:41], v19 offset:16384
  ds_read_b64_tr_b16 v[42:43], v19 offset:16640
  v_mfma_f32_32x32x16_bf16 v[104:119], v[64:67], v[224:227], v[104:119]
  ds_read_b64_tr_b16 v[44:45], v19 offset:17408
  ds_read_b64_tr_b16 v[46:47], v19 offset:17664
  s_waitcnt lgkmcnt(4)
  v_mfma_f32_32x32x16_bf16 v[120:135], v[68:71], v[228:231], v[120:135]
  ds_read_b64_tr_b16 v[48:49], v19 offset:18432
  ds_read_b64_tr_b16 v[50:51], v19 offset:18688
  s_waitcnt lgkmcnt(4)
  v_mfma_f32_32x32x16_bf16 v[104:119], v[40:43], v[232:235], v[104:119]
  ds_read_b64_tr_b16 v[52:53], v19 offset:19456
  ds_read_b64_tr_b16 v[54:55], v19 offset:19712
  s_waitcnt lgkmcnt(4)
  v_mfma_f32_32x32x16_bf16 v[120:135], v[44:47], v[236:239], v[120:135]
  s_waitcnt lgkmcnt(2)
  v_mfma_f32_32x32x16_bf16 v[104:119], v[48:51], v[240:243], v[104:119]
  s_waitcnt lgkmcnt(0)
  v_mfma_f32_32x32x16_bf16 v[120:135], v[52:55], v[244:247], v[120:135]
  v_mov_b32 v10, 9
  ds_write_b32 v12, v10 offset:16
  s_nop 7
  s_nop 3
  v_add_f32 v104, v104, v120
  v_add_f32 v105, v105, v121
  v_add_f32 v106, v106, v122
  v_add_f32 v107, v107, v123
  v_add_f32 v108, v108, v124
  v_add_f32 v109, v109, v125
  v_add_f32 v110, v110, v126
  v_add_f32 v111, v111, v127
  v_add_f32 v112, v112, v128
  v_add_f32 v113, v113, v129
  v_add_f32 v114, v114, v130
  v_add_f32 v115, v115, v131
  v_add_f32 v116, v116, v132
  v_add_f32 v117, v117, v133
  v_add_f32 v118, v118, v134
  v_add_f32 v119, v119, v135
  v_mov_b32 v3, v116
  v_mov_b32 v4, v116
  v_mul_f32 v104, 0x3e8b97f6, v104
  v_mul_f32 v105, 0x3e8b97f6, v105
  v_mul_f32 v106, 0x3e8b97f6, v106
  v_mul_f32 v107, 0x3e8b97f6, v107
  v_mul_f32 v108, 0x3e8b97f6, v108
  v_mul_f32 v109, 0x3e8b97f6, v109
  v_mul_f32 v110, 0x3e8b97f6, v110
  v_mul_f32 v111, 0x3e8b97f6, v111
  v_mul_f32 v112, 0x3e8b97f6, v112
  v_mul_f32 v113, 0x3e8b97f6, v113
  v_mul_f32 v114, 0x3e8b97f6, v114
  v_mul_f32 v115, 0x3e8b97f6, v115
  v_mul_f32 v116, 0x3e8b97f6, v116
  v_mul_f32 v117, 0x3e8b97f6, v117
  v_mul_f32 v118, 0x3e8b97f6, v118
  v_mul_f32 v119, 0x3e8b97f6, v119
  v_permlane32_swap_b32 v3, v4
  v_cvt_pk_bf16_f32 v104, v104, v105
  v_cvt_pk_bf16_f32 v105, v106, v107
  v_cvt_pk_bf16_f32 v106, v108, v109
  v_cvt_pk_bf16_f32 v107, v110, v111
  v_cvt_pk_bf16_f32 v108, v112, v113
  v_cvt_pk_bf16_f32 v109, v114, v115
  v_cvt_pk_bf16_f32 v110, v116, v117
  v_cvt_pk_bf16_f32 v111, v118, v119
  s_mov_b32 exec_lo, 0
  v_mov_b32 v110, 0
  v_mov_b32 v111, 0
  s_mov_b32 exec_lo, -1
  v_mul_f32 v4, 0x3fb8aa3b, v4
  s_nop 0
  v_exp_f32 v5, v4
  v_exp_f32 v6, -v4
  v_and_b32 v3, 31, v1
  v_add_f32 v13, 1.0, v5
  v_add_f32 v6, 1.0, v6
  v_min_f32 v13, 0x7f61b1e6, v13
  v_rcp_f32 v6, v6
  s_lshl_b32 s55, s48, 7
  s_add_u32 s55, s55, 0x27400
  v_lshl_add_u32 v3, v3, 2, s55
  ds_write_b32 v3, v6
  s_lshl_b32 s55, s48, 11
  s_add_u32 s55, s55, 0x25400
  v_add_u32 v3, s55, v2
  v_mov_b32 v4, 1
  ds_write_b128 v3, v[104:107]
  ds_write_b128 v3, v[108:111] offset:1024
  ds_write_b32 v12, v4 offset:32
  v_lshrrev_b32 v8, 5, v1
  v_bfe_u32 v6, v1, 2, 2
  v_lshl_add_u32 v3, v8, 3, v6
  v_bfe_u32 v4, v1, 4, 1
  v_and_b32 v5, 3, v1
  v_lshlrev_b32 v5, 3, v5
  v_bfe_u32 v6, v1, 3, 1
  v_lshl_add_u32 v6, v4, 1, v6
  v_lshl_add_u32 v6, v6, 5, v5
  v_lshl_add_u32 v6, v3, 7, v6
  v_lshl_add_u32 v16, v4, 13, v6
  v_xor_b32 v17, 32, v16
  v_xor_b32 v18, 64, v16
  v_xor_b32 v19, 96, v16
  v_add_u32 v20, 0x10000, v16
  v_add_u32 v21, 0x10000, v17
  v_add_u32 v22, 0x10000, v18
  v_add_u32 v23, 0x10000, v19
  s_mul_i32 s63, s61, 112
  s_lshl_b32 s55, s52, 2
  s_add_u32 s63, s63, s55
  s_lshl_b32 s63, s63, 10
  s_add_u32 s63, s63, 0x800000
  s_cmp_lt_u32 s48, 2
  s_cselect_b32 s57, s12, s14
  s_cselect_b32 s58, s13, s15
  s_mov_b32 s40, s57
  s_and_b32 s41, s58, 0xffff
  s_mov_b32 s42, 0x188000
  s_mov_b32 s43, 0x00020000
  s_and_b32 s55, s48, 1
  s_mul_i32 s55, s55, 114688
  s_mul_i32 s56, s52, 96
  s_add_u32 s55, s55, s56
  s_add_u32 s55, s55, 2048
  v_add_u32 v3, 0, v1
  v_mul_u32_u24 v4, 10923, v3
  v_lshrrev_b32 v4, 16, v4
  v_mul_u32_u24 v5, 6, v4
  v_sub_u32 v5, v3, v5
  v_mul_u32_u24 v4, 3584, v4
  v_lshl_add_u32 v4, v5, 4, v4
  v_add_u32 v24, s55, v4
  v_add_u32 v3, 64, v1
  v_mul_u32_u24 v4, 10923, v3
  v_lshrrev_b32 v4, 16, v4
  v_mul_u32_u24 v5, 6, v4
  v_sub_u32 v5, v3, v5
  v_mul_u32_u24 v4, 3584, v4
  v_lshl_add_u32 v4, v5, 4, v4
  v_add_u32 v25, s55, v4
  v_add_u32 v3, 128, v1
  v_mul_u32_u24 v4, 10923, v3
  v_lshrrev_b32 v4, 16, v4
  v_mul_u32_u24 v5, 6, v4
  v_sub_u32 v5, v3, v5
  v_mul_u32_u24 v4, 3584, v4
  v_lshl_add_u32 v4, v5, 4, v4
  v_add_u32 v26, s55, v4
  s_lshr_b32 s55, s48, 1
  s_mul_i32 s60, s55, 6272
  s_and_b32 s55, s48, 1
  s_mul_i32 s55, s55, 3072
  s_add_u32 s60, s60, s55
  s_mul_i32 s59, s53, 229376
  s_waitcnt lgkmcnt(0)
  ds_read_b128 v[28:31], v11 offset:0
  s_waitcnt lgkmcnt(0)
  v_min_u32 v9, v28, v29
  v_min3_u32 v9, v9, v30, v31
  s_nop 0
  v_readfirstlane_b32 s58, v9
  s_cmp_ge_u32 s58, 15
  s_cbranch_scc1 Ld90
Lp89:
  ds_read_b128 v[28:31], v11 offset:0
  s_waitcnt lgkmcnt(0)
  v_min_u32 v9, v28, v29
  v_min3_u32 v9, v9, v30, v31
  s_nop 0
  v_readfirstlane_b32 s58, v9
  s_cmp_ge_u32 s58, 15
  s_cbranch_scc1 Ld90
  s_sub_u32 s54, s54, 1
  s_cmp_gt_i32 s54, 0
  s_cbranch_scc1 Lp89
Ld90:
  ds_read_b64_tr_b16 v[40:41], v20 offset:0
  ds_read_b64_tr_b16 v[42:43], v20 offset:512
  ds_read_b64_tr_b16 v[44:45], v21 offset:0
  ds_read_b64_tr_b16 v[46:47], v21 offset:512
  ds_read_b64_tr_b16 v[48:49], v22 offset:0
  ds_read_b64_tr_b16 v[50:51], v22 offset:512
  ds_read_b64_tr_b16 v[52:53], v23 offset:0
  ds_read_b64_tr_b16 v[54:55], v23 offset:512
  ds_read_b64_tr_b16 v[56:57], v20 offset:2048
  ds_read_b64_tr_b16 v[58:59], v20 offset:2560
  ds_read_b64_tr_b16 v[60:61], v21 offset:2048
  ds_read_b64_tr_b16 v[62:63], v21 offset:2560
  s_waitcnt lgkmcnt(10)
  v_mfma_f32_32x32x16_bf16 v[72:87], v[40:43], v[136:139], 0
  ds_read_b64_tr_b16 v[64:65], v22 offset:2048
  ds_read_b64_tr_b16 v[66:67], v22 offset:2560
  s_waitcnt lgkmcnt(10)
  v_mfma_f32_32x32x16_bf16 v[88:103], v[44:47], v[136:139], 0
  ds_read_b64_tr_b16 v[68:69], v23 offset:2048
  ds_read_b64_tr_b16 v[70:71], v23 offset:2560
  s_waitcnt lgkmcnt(10)
  v_mfma_f32_32x32x16_bf16 v[104:119], v[48:51], v[136:139], 0
  ds_read_b64_tr_b16 v[40:41], v20 offset:4096
  ds_read_b64_tr_b16 v[42:43], v20 offset:4608
  s_waitcnt lgkmcnt(10)
  v_mfma_f32_32x32x16_bf16 v[120:135], v[52:55], v[136:139], 0
  ds_read_b64_tr_b16 v[44:45], v21 offset:4096
  ds_read_b64_tr_b16 v[46:47], v21 offset:4608
  s_waitcnt lgkmcnt(10)
  v_mfma_f32_32x32x16_bf16 v[72:87], v[56:59], v[140:143], v[72:87]
  ds_read_b64_tr_b16 v[48:49], v22 offset:4096
  ds_read_b64_tr_b16 v[50:51], v22 offset:4608
  s_waitcnt lgkmcnt(10)
  v_mfma_f32_32x32x16_bf16 v[88:103], v[60:63], v[140:143], v[88:103]
  ds_read_b64_tr_b16 v[52:53], v23 offset:4096
  ds_read_b64_tr_b16 v[54:55], v23 offset:4608
  s_waitcnt lgkmcnt(10)
  v_mfma_f32_32x32x16_bf16 v[104:119], v[64:67], v[140:143], v[104:119]
  ds_read_b64_tr_b16 v[56:57], v20 offset:6144
  ds_read_b64_tr_b16 v[58:59], v20 offset:6656
  s_waitcnt lgkmcnt(10)
  v_mfma_f32_32x32x16_bf16 v[120:135], v[68:71], v[140:143], v[120:135]
  ds_read_b128 v[28:31], v11 offset:0
  ds_read_b64_tr_b16 v[60:61], v21 offset:6144
  ds_read_b64_tr_b16 v[62:63], v21 offset:6656
  s_waitcnt lgkmcnt(11)
  v_mfma_f32_32x32x16_bf16 v[72:87], v[40:43], v[144:147], v[72:87]
  ds_read_b64_tr_b16 v[64:65], v22 offset:6144
  ds_read_b64_tr_b16 v[66:67], v22 offset:6656
  s_waitcnt lgkmcnt(11)
  v_mfma_f32_32x32x16_bf16 v[88:103], v[44:47], v[144:147], v[88:103]
  ds_read_b64_tr_b16 v[68:69], v23 offset:6144
  ds_read_b64_tr_b16 v[70:71], v23 offset:6656
  s_waitcnt lgkmcnt(11)
  v_mfma_f32_32x32x16_bf16 v[104:119], v[48:51], v[144:147], v[104:119]
  s_waitcnt lgkmcnt(6)
  v_min_u32 v9, v28, v29
  v_min3_u32 v9, v9, v30, v31
  s_nop 0
  v_readfirstlane_b32 s58, v9
  s_cmp_ge_u32 s58, 16
  s_cbranch_scc1 Ld92
Lp91:
  ds_read_b128 v[28:31], v11 offset:0
  s_waitcnt lgkmcnt(0)
  v_min_u32 v9, v28, v29
  v_min3_u32 v9, v9, v30, v31
  s_nop 0
  v_readfirstlane_b32 s58, v9
  s_cmp_ge_u32 s58, 16
  s_cbranch_scc1 Ld92
  s_sub_u32 s54, s54, 1
  s_cmp_gt_i32 s54, 0
  s_cbranch_scc1 Lp91
Ld92:
  ds_read_b64_tr_b16 v[40:41], v20 offset:16384
  ds_read_b64_tr_b16 v[42:43], v20 offset:16896
  v_mfma_f32_32x32x16_bf16 v[120:135], v[52:55], v[144:147], v[120:135]
  ds_read_b64_tr_b16 v[44:45], v21 offset:16384
  ds_read_b64_tr_b16 v[46:47], v21 offset:16896
  v_mfma_f32_32x32x16_bf16 v[72:87], v[56:59], v[148:151], v[72:87]
  ds_read_b64_tr_b16 v[48:49], v22 offset:16384
  ds_read_b64_tr_b16 v[50:51], v22 offset:16896
  s_waitcnt lgkmcnt(10)
  v_mfma_f32_32x32x16_bf16 v[88:103], v[60:63], v[148:151], v[88:103]
  ds_read_b64_tr_b16 v[52:53], v23 offset:16384
  ds_read_b64_tr_b16 v[54:55], v23 offset:16896
  s_waitcnt lgkmcnt(10)
  v_mfma_f32_32x32x16_bf16 v[104:119], v[64:67], v[148:151], v[104:119]
  ds_read_b64_tr_b16 v[56:57], v20 offset:18432
  ds_read_b64_tr_b16 v[58:59], v20 offset:18944
  s_waitcnt lgkmcnt(10)
  v_mfma_f32_32x32x16_bf16 v[120:135], v[68:71], v[148:151], v[120:135]
  v_mov_b32 v10, 10
  ds_write_b32 v12, v10 offset:16
  ds_read_b64_tr_b16 v[60:61], v21 offset:18432
  ds_read_b64_tr_b16 v[62:63], v21 offset:18944
  s_waitcnt lgkmcnt(11)
  v_mfma_f32_32x32x16_bf16 v[72:87], v[40:43], v[152:155], v[72:87]
  ds_read_b64_tr_b16 v[64:65], v22 offset:18432
  ds_read_b64_tr_b16 v[66:67], v22 offset:18944
  s_waitcnt lgkmcnt(11)
  v_mfma_f32_32x32x16_bf16 v[88:103], v[44:47], v[152:155], v[88:103]
  ds_read_b64_tr_b16 v[68:69], v23 offset:18432
  ds_read_b64_tr_b16 v[70:71], v23 offset:18944
  s_waitcnt lgkmcnt(11)
  v_mfma_f32_32x32x16_bf16 v[104:119], v[48:51], v[152:155], v[104:119]
  ds_read_b64_tr_b16 v[40:41], v20 offset:20480
  ds_read_b64_tr_b16 v[42:43], v20 offset:20992
  s_waitcnt lgkmcnt(11)
  v_mfma_f32_32x32x16_bf16 v[120:135], v[52:55], v[152:155], v[120:135]
  ds_read_b64_tr_b16 v[44:45], v21 offset:20480
  ds_read_b64_tr_b16 v[46:47], v21 offset:20992
  s_waitcnt lgkmcnt(11)
  v_mfma_f32_32x32x16_bf16 v[72:87], v[56:59], v[156:159], v[72:87]
  ds_read_b64_tr_b16 v[48:49], v22 offset:20480
  ds_read_b64_tr_b16 v[50:51], v22 offset:20992
  s_waitcnt lgkmcnt(10)
  v_mfma_f32_32x32x16_bf16 v[88:103], v[60:63], v[156:159], v[88:103]
  ds_read_b64_tr_b16 v[52:53], v23 offset:20480
  ds_read_b64_tr_b16 v[54:55], v23 offset:20992
  s_waitcnt lgkmcnt(10)
  v_mfma_f32_32x32x16_bf16 v[104:119], v[64:67], v[156:159], v[104:119]
  ds_read_b64_tr_b16 v[56:57], v20 offset:22528
  ds_read_b64_tr_b16 v[58:59], v20 offset:23040
  s_waitcnt lgkmcnt(10)
  v_mfma_f32_32x32x16_bf16 v[120:135], v[68:71], v[156:159], v[120:135]
  ds_read_b128 v[28:31], v11 offset:0
  ds_read_b64_tr_b16 v[60:61], v21 offset:22528
  ds_read_b64_tr_b16 v[62:63], v21 offset:23040
  s_waitcnt lgkmcnt(11)
  v_mfma_f32_32x32x16_bf16 v[72:87], v[40:43], v[160:163], v[72:87]
  ds_read_b64_tr_b16 v[64:65], v22 offset:22528
  ds_read_b64_tr_b16 v[66:67], v22 offset:23040
  s_waitcnt lgkmcnt(11)
  v_mfma_f32_32x32x16_bf16 v[88:103], v[44:47], v[160:163], v[88:103]
  ds_read_b64_tr_b16 v[68:69], v23 offset:22528
  ds_read_b64_tr_b16 v[70:71], v23 offset:23040
  s_waitcnt lgkmcnt(11)
  v_mfma_f32_32x32x16_bf16 v[104:119], v[48:51], v[160:163], v[104:119]
  s_waitcnt lgkmcnt(6)
  v_min_u32 v9, v28, v29
  v_min3_u32 v9, v9, v30, v31
  s_nop 0
  v_readfirstlane_b32 s58, v9
  s_cmp_ge_u32 s58, 17
  s_cbranch_scc1 Ld94
Lp93:
  ds_read_b128 v[28:31], v11 offset:0
  s_waitcnt lgkmcnt(0)
  v_min_u32 v9, v28, v29
  v_min3_u32 v9, v9, v30, v31
  s_nop 0
  v_readfirstlane_b32 s58, v9
  s_cmp_ge_u32 s58, 17
  s_cbranch_scc1 Ld94
  s_sub_u32 s54, s54, 1
  s_cmp_gt_i32 s54, 0
  s_cbranch_scc1 Lp93
Ld94:
  ds_read_b64_tr_b16 v[40:41], v20 offset:32768
  ds_read_b64_tr_b16 v[42:43], v20 offset:33280
  v_mfma_f32_32x32x16_bf16 v[120:135], v[52:55], v[160:163], v[120:135]
  ds_read_b64_tr_b16 v[44:45], v21 offset:32768
  ds_read_b64_tr_b16 v[46:47], v21 offset:33280
  v_mfma_f32_32x32x16_bf16 v[72:87], v[56:59], v[164:167], v[72:87]
  ds_read_b64_tr_b16 v[48:49], v22 offset:32768
  ds_read_b64_tr_b16 v[50:51], v22 offset:33280
  s_waitcnt lgkmcnt(10)
  v_mfma_f32_32x32x16_bf16 v[88:103], v[60:63], v[164:167], v[88:103]
  ds_read_b64_tr_b16 v[52:53], v23 offset:32768
  ds_read_b64_tr_b16 v[54:55], v23 offset:33280
  s_waitcnt lgkmcnt(10)
  v_mfma_f32_32x32x16_bf16 v[104:119], v[64:67], v[164:167], v[104:119]
  ds_read_b64_tr_b16 v[56:57], v20 offset:34816
  ds_read_b64_tr_b16 v[58:59], v20 offset:35328
  s_waitcnt lgkmcnt(10)
  v_mfma_f32_32x32x16_bf16 v[120:135], v[68:71], v[164:167], v[120:135]
  v_mov_b32 v10, 11
  ds_write_b32 v12, v10 offset:16
  ds_read_b64_tr_b16 v[60:61], v21 offset:34816
  ds_read_b64_tr_b16 v[62:63], v21 offset:35328
  s_waitcnt lgkmcnt(11)
  v_mfma_f32_32x32x16_bf16 v[72:87], v[40:43], v[168:171], v[72:87]
  ds_read_b64_tr_b16 v[64:65], v22 offset:34816
  ds_read_b64_tr_b16 v[66:67], v22 offset:35328
  s_waitcnt lgkmcnt(11)
  v_mfma_f32_32x32x16_bf16 v[88:103], v[44:47], v[168:171], v[88:103]
  ds_read_b64_tr_b16 v[68:69], v23 offset:34816
  ds_read_b64_tr_b16 v[70:71], v23 offset:35328
  s_waitcnt lgkmcnt(11)
  v_mfma_f32_32x32x16_bf16 v[104:119], v[48:51], v[168:171], v[104:119]
  ds_read_b64_tr_b16 v[40:41], v20 offset:36864
  ds_read_b64_tr_b16 v[42:43], v20 offset:37376
  s_waitcnt lgkmcnt(11)
  v_mfma_f32_32x32x16_bf16 v[120:135], v[52:55], v[168:171], v[120:135]
  ds_read_b64_tr_b16 v[44:45], v21 offset:36864
  ds_read_b64_tr_b16 v[46:47], v21 offset:37376
  s_waitcnt lgkmcnt(11)
  v_mfma_f32_32x32x16_bf16 v[72:87], v[56:59], v[172:175], v[72:87]
  ds_read_b64_tr_b16 v[48:49], v22 offset:36864
  ds_read_b64_tr_b16 v[50:51], v22 offset:37376
  s_waitcnt lgkmcnt(10)
  v_mfma_f32_32x32x16_bf16 v[88:103], v[60:63], v[172:175], v[88:103]
  ds_read_b64_tr_b16 v[52:53], v23 offset:36864
  ds_read_b64_tr_b16 v[54:55], v23 offset:37376
  s_waitcnt lgkmcnt(10)
  v_mfma_f32_32x32x16_bf16 v[104:119], v[64:67], v[172:175], v[104:119]
  ds_read_b64_tr_b16 v[56:57], v20 offset:38912
  ds_read_b64_tr_b16 v[58:59], v20 offset:39424
  s_waitcnt lgkmcnt(10)
  v_mfma_f32_32x32x16_bf16 v[120:135], v[68:71], v[172:175], v[120:135]
  ds_read_b128 v[28:31], v11 offset:0
  ds_read_b64_tr_b16 v[60:61], v21 offset:38912
  ds_read_b64_tr_b16 v[62:63], v21 offset:39424
  s_waitcnt lgkmcnt(11)
  v_mfma_f32_32x32x16_bf16 v[72:87], v[40:43], v[176:179], v[72:87]
  ds_read_b64_tr_b16 v[64:65], v22 offset:38912
  ds_read_b64_tr_b16 v[66:67], v22 offset:39424
  s_waitcnt lgkmcnt(11)
  v_mfma_f32_32x32x16_bf16 v[88:103], v[44:47], v[176:179], v[88:103]
  ds_read_b64_tr_b16 v[68:69], v23 offset:38912
  ds_read_b64_tr_b16 v[70:71], v23 offset:39424
  s_waitcnt lgkmcnt(11)
  v_mfma_f32_32x32x16_bf16 v[104:119], v[48:51], v[176:179], v[104:119]
  s_waitcnt lgkmcnt(6)
  v_min_u32 v9, v28, v29
  v_min3_u32 v9, v9, v30, v31
  s_nop 0
  v_readfirstlane_b32 s58, v9
  s_cmp_ge_u32 s58, 18
  s_cbranch_scc1 Ld96
Lp95:
  ds_read_b128 v[28:31], v11 offset:0
  s_waitcnt lgkmcnt(0)
  v_min_u32 v9, v28, v29
  v_min3_u32 v9, v9, v30, v31
  s_nop 0
  v_readfirstlane_b32 s58, v9
  s_cmp_ge_u32 s58, 18
  s_cbranch_scc1 Ld96
  s_sub_u32 s54, s54, 1
  s_cmp_gt_i32 s54, 0
  s_cbranch_scc1 Lp95
Ld96:
  ds_read_b64_tr_b16 v[40:41], v16 offset:0
  ds_read_b64_tr_b16 v[42:43], v16 offset:512
  v_mfma_f32_32x32x16_bf16 v[120:135], v[52:55], v[176:179], v[120:135]
  ds_read_b64_tr_b16 v[44:45], v17 offset:0
  ds_read_b64_tr_b16 v[46:47], v17 offset:512
  v_mfma_f32_32x32x16_bf16 v[72:87], v[56:59], v[180:183], v[72:87]
  ds_read_b64_tr_b16 v[48:49], v18 offset:0
  ds_read_b64_tr_b16 v[50:51], v18 offset:512
  s_waitcnt lgkmcnt(10)
  v_mfma_f32_32x32x16_bf16 v[88:103], v[60:63], v[180:183], v[88:103]
  ds_read_b64_tr_b16 v[52:53], v19 offset:0
  ds_read_b64_tr_b16 v[54:55], v19 offset:512
  s_waitcnt lgkmcnt(10)
  v_mfma_f32_32x32x16_bf16 v[104:119], v[64:67], v[180:183], v[104:119]
  ds_read_b64_tr_b16 v[56:57], v16 offset:2048
  ds_read_b64_tr_b16 v[58:59], v16 offset:2560
  s_waitcnt lgkmcnt(10)
  v_mfma_f32_32x32x16_bf16 v[120:135], v[68:71], v[180:183], v[120:135]
  v_mov_b32 v10, 12
  ds_write_b32 v12, v10 offset:16
  ds_read_b64_tr_b16 v[60:61], v17 offset:2048
  ds_read_b64_tr_b16 v[62:63], v17 offset:2560
  s_waitcnt lgkmcnt(11)
  v_mfma_f32_32x32x16_bf16 v[72:87], v[40:43], v[184:187], v[72:87]
  ds_read_b64_tr_b16 v[64:65], v18 offset:2048
  ds_read_b64_tr_b16 v[66:67], v18 offset:2560
  s_waitcnt lgkmcnt(11)
  v_mfma_f32_32x32x16_bf16 v[88:103], v[44:47], v[184:187], v[88:103]
  ds_read_b64_tr_b16 v[68:69], v19 offset:2048
  ds_read_b64_tr_b16 v[70:71], v19 offset:2560
  s_waitcnt lgkmcnt(11)
  v_mfma_f32_32x32x16_bf16 v[104:119], v[48:51], v[184:187], v[104:119]
  ds_read_b64_tr_b16 v[40:41], v16 offset:4096
  ds_read_b64_tr_b16 v[42:43], v16 offset:4608
  s_waitcnt lgkmcnt(11)
  v_mfma_f32_32x32x16_bf16 v[120:135], v[52:55], v[184:187], v[120:135]
  ds_read_b64_tr_b16 v[44:45], v17 offset:4096
  ds_read_b64_tr_b16 v[46:47], v17 offset:4608
  s_waitcnt lgkmcnt(11)
  v_mfma_f32_32x32x16_bf16 v[72:87], v[56:59], v[188:191], v[72:87]
  ds_read_b64_tr_b16 v[48:49], v18 offset:4096
  ds_read_b64_tr_b16 v[50:51], v18 offset:4608
  s_waitcnt lgkmcnt(10)
  v_mfma_f32_32x32x16_bf16 v[88:103], v[60:63], v[188:191], v[88:103]
  ds_read_b64_tr_b16 v[52:53], v19 offset:4096
  ds_read_b64_tr_b16 v[54:55], v19 offset:4608
  s_waitcnt lgkmcnt(10)
  v_mfma_f32_32x32x16_bf16 v[104:119], v[64:67], v[188:191], v[104:119]
  ds_read_b64_tr_b16 v[56:57], v16 offset:6144
  ds_read_b64_tr_b16 v[58:59], v16 offset:6656
  s_waitcnt lgkmcnt(10)
  v_mfma_f32_32x32x16_bf16 v[120:135], v[68:71], v[188:191], v[120:135]
  ds_read_b128 v[28:31], v11 offset:0
  ds_read_b64_tr_b16 v[60:61], v17 offset:6144
  ds_read_b64_tr_b16 v[62:63], v17 offset:6656
  s_waitcnt lgkmcnt(11)
  v_mfma_f32_32x32x16_bf16 v[72:87], v[40:43], v[192:195], v[72:87]
  ds_read_b64_tr_b16 v[64:65], v18 offset:6144
  ds_read_b64_tr_b16 v[66:67], v18 offset:6656
  s_waitcnt lgkmcnt(11)
  v_mfma_f32_32x32x16_bf16 v[88:103], v[44:47], v[192:195], v[88:103]
  ds_read_b64_tr_b16 v[68:69], v19 offset:6144
  ds_read_b64_tr_b16 v[70:71], v19 offset:6656
  s_waitcnt lgkmcnt(11)
  v_mfma_f32_32x32x16_bf16 v[104:119], v[48:51], v[192:195], v[104:119]
  s_waitcnt lgkmcnt(6)
  v_min_u32 v9, v28, v29
  v_min3_u32 v9, v9, v30, v31
  s_nop 0
  v_readfirstlane_b32 s58, v9
  s_cmp_ge_u32 s58, 19
  s_cbranch_scc1 Ld98
Lp97:
  ds_read_b128 v[28:31], v11 offset:0
  s_waitcnt lgkmcnt(0)
  v_min_u32 v9, v28, v29
  v_min3_u32 v9, v9, v30, v31
  s_nop 0
  v_readfirstlane_b32 s58, v9
  s_cmp_ge_u32 s58, 19
  s_cbranch_scc1 Ld98
  s_sub_u32 s54, s54, 1
  s_cmp_gt_i32 s54, 0
  s_cbranch_scc1 Lp97
Ld98:
  ds_read_b64_tr_b16 v[40:41], v16 offset:16384
  ds_read_b64_tr_b16 v[42:43], v16 offset:16896
  v_mfma_f32_32x32x16_bf16 v[120:135], v[52:55], v[192:195], v[120:135]
  ds_read_b64_tr_b16 v[44:45], v17 offset:16384
  ds_read_b64_tr_b16 v[46:47], v17 offset:16896
  v_mfma_f32_32x32x16_bf16 v[72:87], v[56:59], v[196:199], v[72:87]
  ds_read_b64_tr_b16 v[48:49], v18 offset:16384
  ds_read_b64_tr_b16 v[50:51], v18 offset:16896
  s_waitcnt lgkmcnt(10)
  v_mfma_f32_32x32x16_bf16 v[88:103], v[60:63], v[196:199], v[88:103]
  ds_read_b64_tr_b16 v[52:53], v19 offset:16384
  ds_read_b64_tr_b16 v[54:55], v19 offset:16896
  s_waitcnt lgkmcnt(10)
  v_mfma_f32_32x32x16_bf16 v[104:119], v[64:67], v[196:199], v[104:119]
  ds_read_b64_tr_b16 v[56:57], v16 offset:18432
  ds_read_b64_tr_b16 v[58:59], v16 offset:18944
  s_waitcnt lgkmcnt(10)
  v_mfma_f32_32x32x16_bf16 v[120:135], v[68:71], v[196:199], v[120:135]
  v_mov_b32 v10, 13
  ds_write_b32 v12, v10 offset:16
  ds_read_b64_tr_b16 v[60:61], v17 offset:18432
  ds_read_b64_tr_b16 v[62:63], v17 offset:18944
  s_waitcnt lgkmcnt(11)
  v_mfma_f32_32x32x16_bf16 v[72:87], v[40:43], v[200:203], v[72:87]
  ds_read_b64_tr_b16 v[64:65], v18 offset:18432
  ds_read_b64_tr_b16 v[66:67], v18 offset:18944
  s_waitcnt lgkmcnt(11)
  v_mfma_f32_32x32x16_bf16 v[88:103], v[44:47], v[200:203], v[88:103]
  ds_read_b64_tr_b16 v[68:69], v19 offset:18432
  ds_read_b64_tr_b16 v[70:71], v19 offset:18944
  s_waitcnt lgkmcnt(11)
  v_mfma_f32_32x32x16_bf16 v[104:119], v[48:51], v[200:203], v[104:119]
  ds_read_b64_tr_b16 v[40:41], v16 offset:20480
  ds_read_b64_tr_b16 v[42:43], v16 offset:20992
  s_waitcnt lgkmcnt(11)
  v_mfma_f32_32x32x16_bf16 v[120:135], v[52:55], v[200:203], v[120:135]
  ds_read_b64_tr_b16 v[44:45], v17 offset:20480
  ds_read_b64_tr_b16 v[46:47], v17 offset:20992
  s_waitcnt lgkmcnt(11)
  v_mfma_f32_32x32x16_bf16 v[72:87], v[56:59], v[204:207], v[72:87]
  ds_read_b64_tr_b16 v[48:49], v18 offset:20480
  ds_read_b64_tr_b16 v[50:51], v18 offset:20992
  s_waitcnt lgkmcnt(10)
  v_mfma_f32_32x32x16_bf16 v[88:103], v[60:63], v[204:207], v[88:103]
  ds_read_b64_tr_b16 v[52:53], v19 offset:20480
  ds_read_b64_tr_b16 v[54:55], v19 offset:20992
  s_waitcnt lgkmcnt(10)
  v_mfma_f32_32x32x16_bf16 v[104:119], v[64:67], v[204:207], v[104:119]
  ds_read_b64_tr_b16 v[56:57], v16 offset:22528
  ds_read_b64_tr_b16 v[58:59], v16 offset:23040
  s_waitcnt lgkmcnt(10)
  v_mfma_f32_32x32x16_bf16 v[120:135], v[68:71], v[204:207], v[120:135]
  ds_read_b128 v[28:31], v11 offset:0
  ds_read_b64_tr_b16 v[60:61], v17 offset:22528
  ds_read_b64_tr_b16 v[62:63], v17 offset:23040
  s_waitcnt lgkmcnt(11)
  v_mfma_f32_32x32x16_bf16 v[72:87], v[40:43], v[208:211], v[72:87]
  ds_read_b64_tr_b16 v[64:65], v18 offset:22528
  ds_read_b64_tr_b16 v[66:67], v18 offset:23040
  s_waitcnt lgkmcnt(11)
  v_mfma_f32_32x32x16_bf16 v[88:103], v[44:47], v[208:211], v[88:103]
  ds_read_b64_tr_b16 v[68:69], v19 offset:22528
  ds_read_b64_tr_b16 v[70:71], v19 offset:23040
  s_waitcnt lgkmcnt(11)
  v_mfma_f32_32x32x16_bf16 v[104:119], v[48:51], v[208:211], v[104:119]
  s_waitcnt lgkmcnt(6)
  v_min_u32 v9, v28, v29
  v_min3_u32 v9, v9, v30, v31
  s_nop 0
  v_readfirstlane_b32 s58, v9
  s_cmp_ge_u32 s58, 20
  s_cbranch_scc1 Ld100
Lp99:
  ds_read_b128 v[28:31], v11 offset:0
  s_waitcnt lgkmcnt(0)
  v_min_u32 v9, v28, v29
  v_min3_u32 v9, v9, v30, v31
  s_nop 0
  v_readfirstlane_b32 s58, v9
  s_cmp_ge_u32 s58, 20
  s_cbranch_scc1 Ld100
  s_sub_u32 s54, s54, 1
  s_cmp_gt_i32 s54, 0
  s_cbranch_scc1 Lp99
Ld100:
  ds_read_b64_tr_b16 v[40:41], v16 offset:32768
  ds_read_b64_tr_b16 v[42:43], v16 offset:33280
  v_mfma_f32_32x32x16_bf16 v[120:135], v[52:55], v[208:211], v[120:135]
  ds_read_b64_tr_b16 v[44:45], v17 offset:32768
  ds_read_b64_tr_b16 v[46:47], v17 offset:33280
  v_mfma_f32_32x32x16_bf16 v[72:87], v[56:59], v[212:215], v[72:87]
  ds_read_b64_tr_b16 v[48:49], v18 offset:32768
  ds_read_b64_tr_b16 v[50:51], v18 offset:33280
  s_waitcnt lgkmcnt(10)
  v_mfma_f32_32x32x16_bf16 v[88:103], v[60:63], v[212:215], v[88:103]
  ds_read_b64_tr_b16 v[52:53], v19 offset:32768
  ds_read_b64_tr_b16 v[54:55], v19 offset:33280
  s_waitcnt lgkmcnt(10)
  v_mfma_f32_32x32x16_bf16 v[104:119], v[64:67], v[212:215], v[104:119]
  ds_read_b64_tr_b16 v[56:57], v16 offset:34816
  ds_read_b64_tr_b16 v[58:59], v16 offset:35328
  s_waitcnt lgkmcnt(10)
  v_mfma_f32_32x32x16_bf16 v[120:135], v[68:71], v[212:215], v[120:135]
  v_mov_b32 v10, 14
  ds_write_b32 v12, v10 offset:16
  ds_read_b64_tr_b16 v[60:61], v17 offset:34816
  ds_read_b64_tr_b16 v[62:63], v17 offset:35328
  s_waitcnt lgkmcnt(11)
  v_mfma_f32_32x32x16_bf16 v[72:87], v[40:43], v[216:219], v[72:87]
  ds_read_b64_tr_b16 v[64:65], v18 offset:34816
  ds_read_b64_tr_b16 v[66:67], v18 offset:35328
  s_waitcnt lgkmcnt(11)
  v_mfma_f32_32x32x16_bf16 v[88:103], v[44:47], v[216:219], v[88:103]
  ds_read_b64_tr_b16 v[68:69], v19 offset:34816
  ds_read_b64_tr_b16 v[70:71], v19 offset:35328
  ds_read_b128 v[32:35], v11 offset:16
  s_waitcnt lgkmcnt(12)
  v_mfma_f32_32x32x16_bf16 v[104:119], v[48:51], v[216:219], v[104:119]
  ds_read_b64_tr_b16 v[40:41], v16 offset:36864
  ds_read_b64_tr_b16 v[42:43], v16 offset:37376
  s_waitcnt lgkmcnt(12)
  v_mfma_f32_32x32x16_bf16 v[120:135], v[52:55], v[216:219], v[120:135]
  ds_read_b64_tr_b16 v[44:45], v17 offset:36864
  ds_read_b64_tr_b16 v[46:47], v17 offset:37376
  s_waitcnt lgkmcnt(12)
  v_mfma_f32_32x32x16_bf16 v[72:87], v[56:59], v[220:223], v[72:87]
  ds_read_b64_tr_b16 v[48:49], v18 offset:36864
  ds_read_b64_tr_b16 v[50:51], v18 offset:37376
  s_waitcnt lgkmcnt(6)
  v_min_u32 v9, v32, v33
  v_min3_u32 v9, v9, v34, v35
  s_nop 0
  v_readfirstlane_b32 s58, v9
  s_cmp_ge_u32 s58, 9
  s_cbranch_scc1 Ld102
Lp101:
  ds_read_b128 v[32:35], v11 offset:16
  s_waitcnt lgkmcnt(0)
  v_min_u32 v9, v32, v33
  v_min3_u32 v9, v9, v34, v35
  s_nop 0
  v_readfirstlane_b32 s58, v9
  s_cmp_ge_u32 s58, 9
  s_cbranch_scc1 Ld102
  s_sub_u32 s54, s54, 1
  s_cmp_gt_i32 s54, 0
  s_cbranch_scc1 Lp101
Ld102:
  s_add_u32 m0, s60, 0x1c000
  s_nop 0
  buffer_load_dwordx4 v24, s[40:43], s59 offen lds
  s_add_u32 m0, s60, 0x1c400
  s_nop 0
  buffer_load_dwordx4 v25, s[40:43], s59 offen lds
  s_add_u32 m0, s60, 0x1c800
  s_nop 0
  buffer_load_dwordx4 v26, s[40:43], s59 offen lds
  s_add_u32 s59, s59, 229376
  s_cmp_eq_u32 s59, 1605632
  s_cselect_b32 s59, 0, s59
  v_mfma_f32_32x32x16_bf16 v[88:103], v[60:63], v[220:223], v[88:103]
  ds_read_b64_tr_b16 v[52:53], v19 offset:36864
  ds_read_b64_tr_b16 v[54:55], v19 offset:37376
  ds_read_b128 v[32:35], v11 offset:16
  v_mfma_f32_32x32x16_bf16 v[104:119], v[64:67], v[220:223], v[104:119]
  ds_read_b64_tr_b16 v[56:57], v16 offset:38912
  ds_read_b64_tr_b16 v[58:59], v16 offset:39424
  v_mfma_f32_32x32x16_bf16 v[120:135], v[68:71], v[220:223], v[120:135]
  ds_read_b128 v[28:31], v11 offset:0
  ds_read_b64_tr_b16 v[60:61], v17 offset:38912
  ds_read_b64_tr_b16 v[62:63], v17 offset:39424
  s_waitcnt lgkmcnt(12)
  v_mfma_f32_32x32x16_bf16 v[72:87], v[40:43], v[224:227], v[72:87]
  ds_read_b64_tr_b16 v[64:65], v18 offset:38912
  ds_read_b64_tr_b16 v[66:67], v18 offset:39424
  s_waitcnt lgkmcnt(7)
  v_min_u32 v9, v32, v33
  v_min3_u32 v9, v9, v34, v35
  s_nop 0
  v_readfirstlane_b32 s58, v9
  s_cmp_ge_u32 s58, 9
  s_cbranch_scc1 Ld104
Lp103:
  ds_read_b128 v[32:35], v11 offset:16
  s_waitcnt lgkmcnt(0)
  v_min_u32 v9, v32, v33
  v_min3_u32 v9, v9, v34, v35
  s_nop 0
  v_readfirstlane_b32 s58, v9
  s_cmp_ge_u32 s58, 9
  s_cbranch_scc1 Ld104
  s_sub_u32 s54, s54, 1
  s_cmp_gt_i32 s54, 0
  s_cbranch_scc1 Lp103
Ld104:
  s_add_u32 m0, s60, 0x1f100
  s_nop 0
  buffer_load_dwordx4 v24, s[40:43], s59 offen lds
  s_add_u32 m0, s60, 0x1f500
  s_nop 0
  buffer_load_dwordx4 v25, s[40:43], s59 offen lds
  s_add_u32 m0, s60, 0x1f900
  s_nop 0
  buffer_load_dwordx4 v26, s[40:43], s59 offen lds
  s_add_u32 s59, s59, 229376
  s_cmp_eq_u32 s59, 1605632
  s_cselect_b32 s59, 0, s59
  v_mfma_f32_32x32x16_bf16 v[88:103], v[44:47], v[224:227], v[88:103]
  ds_read_b64_tr_b16 v[68:69], v19 offset:38912
  ds_read_b64_tr_b16 v[70:71], v19 offset:39424
  ds_read_b128 v[32:35], v11 offset:16
  v_mfma_f32_32x32x16_bf16 v[104:119], v[48:51], v[224:227], v[104:119]
  s_waitcnt lgkmcnt(7)
  v_min_u32 v9, v28, v29
  v_min3_u32 v9, v9, v30, v31
  s_nop 0
  v_readfirstlane_b32 s58, v9
  s_cmp_ge_u32 s58, 21
  s_cbranch_scc1 Ld106
Lp105:
  ds_read_b128 v[28:31], v11 offset:0
  s_waitcnt lgkmcnt(0)
  v_min_u32 v9, v28, v29
  v_min3_u32 v9, v9, v30, v31
  s_nop 0
  v_readfirstlane_b32 s58, v9
  s_cmp_ge_u32 s58, 21
  s_cbranch_scc1 Ld106
  s_sub_u32 s54, s54, 1
  s_cmp_gt_i32 s54, 0
  s_cbranch_scc1 Lp105
Ld106:
  ds_read_b64_tr_b16 v[40:41], v16 offset:49152
  ds_read_b64_tr_b16 v[42:43], v16 offset:49664
  v_mfma_f32_32x32x16_bf16 v[120:135], v[52:55], v[224:227], v[120:135]
  ds_read_b64_tr_b16 v[44:45], v17 offset:49152
  ds_read_b64_tr_b16 v[46:47], v17 offset:49664
  v_mfma_f32_32x32x16_bf16 v[72:87], v[56:59], v[228:231], v[72:87]
  ds_read_b64_tr_b16 v[48:49], v18 offset:49152
  ds_read_b64_tr_b16 v[50:51], v18 offset:49664
  s_waitcnt lgkmcnt(6)
  v_min_u32 v9, v32, v33
  v_min3_u32 v9, v9, v34, v35
  s_nop 0
  v_readfirstlane_b32 s58, v9
  s_cmp_ge_u32 s58, 9
  s_cbranch_scc1 Ld108
Lp107:
  ds_read_b128 v[32:35], v11 offset:16
  s_waitcnt lgkmcnt(0)
  v_min_u32 v9, v32, v33
  v_min3_u32 v9, v9, v34, v35
  s_nop 0
  v_readfirstlane_b32 s58, v9
  s_cmp_ge_u32 s58, 9
  s_cbranch_scc1 Ld108
  s_sub_u32 s54, s54, 1
  s_cmp_gt_i32 s54, 0
  s_cbranch_scc1 Lp107
Ld108:
  s_add_u32 m0, s60, 0x22200
  s_nop 0
  buffer_load_dwordx4 v24, s[40:43], s59 offen lds
  s_add_u32 m0, s60, 0x22600
  s_nop 0
  buffer_load_dwordx4 v25, s[40:43], s59 offen lds
  s_add_u32 m0, s60, 0x22a00
  s_nop 0
  buffer_load_dwordx4 v26, s[40:43], s59 offen lds
  s_add_u32 s59, s59, 229376
  s_cmp_eq_u32 s59, 1605632
  s_cselect_b32 s59, 0, s59
  v_mfma_f32_32x32x16_bf16 v[88:103], v[60:63], v[228:231], v[88:103]
  ds_read_b64_tr_b16 v[52:53], v19 offset:49152
  ds_read_b64_tr_b16 v[54:55], v19 offset:49664
  ds_read_b128 v[32:35], v11 offset:16
  v_mfma_f32_32x32x16_bf16 v[104:119], v[64:67], v[228:231], v[104:119]
  ds_read_b64_tr_b16 v[56:57], v16 offset:51200
  ds_read_b64_tr_b16 v[58:59], v16 offset:51712
  v_mfma_f32_32x32x16_bf16 v[120:135], v[68:71], v[228:231], v[120:135]
  v_mov_b32 v10, 15
  ds_write_b32 v12, v10 offset:16
  ds_read_b64_tr_b16 v[60:61], v17 offset:51200
  ds_read_b64_tr_b16 v[62:63], v17 offset:51712
  s_waitcnt lgkmcnt(12)
  v_mfma_f32_32x32x16_bf16 v[72:87], v[40:43], v[232:235], v[72:87]
  ds_read_b64_tr_b16 v[64:65], v18 offset:51200
  ds_read_b64_tr_b16 v[66:67], v18 offset:51712
  s_waitcnt lgkmcnt(7)
  v_min_u32 v9, v32, v33
  v_min3_u32 v9, v9, v34, v35
  s_nop 0
  v_readfirstlane_b32 s58, v9
  s_cmp_ge_u32 s58, 10
  s_cbranch_scc1 Ld110
Lp109:
  ds_read_b128 v[32:35], v11 offset:16
  s_waitcnt lgkmcnt(0)
  v_min_u32 v9, v32, v33
  v_min3_u32 v9, v9, v34, v35
  s_nop 0
  v_readfirstlane_b32 s58, v9
  s_cmp_ge_u32 s58, 10
  s_cbranch_scc1 Ld110
  s_sub_u32 s54, s54, 1
  s_cmp_gt_i32 s54, 0
  s_cbranch_scc1 Lp109
Ld110:
  s_add_u32 m0, s60, 0x10000
  s_nop 0
  buffer_load_dwordx4 v24, s[40:43], s59 offen lds
  s_add_u32 m0, s60, 0x10400
  s_nop 0
  buffer_load_dwordx4 v25, s[40:43], s59 offen lds
  s_add_u32 m0, s60, 0x10800
  s_nop 0
  buffer_load_dwordx4 v26, s[40:43], s59 offen lds
  s_add_u32 s59, s59, 229376
  s_cmp_eq_u32 s59, 1605632
  s_cselect_b32 s59, 0, s59
  v_mfma_f32_32x32x16_bf16 v[88:103], v[44:47], v[232:235], v[88:103]
  ds_read_b64_tr_b16 v[68:69], v19 offset:51200
  ds_read_b64_tr_b16 v[70:71], v19 offset:51712
  ds_read_b128 v[32:35], v11 offset:16
  v_mfma_f32_32x32x16_bf16 v[104:119], v[48:51], v[232:235], v[104:119]
  ds_read_b64_tr_b16 v[40:41], v16 offset:53248
  ds_read_b64_tr_b16 v[42:43], v16 offset:53760
  v_mfma_f32_32x32x16_bf16 v[120:135], v[52:55], v[232:235], v[120:135]
  ds_read_b64_tr_b16 v[44:45], v17 offset:53248
  ds_read_b64_tr_b16 v[46:47], v17 offset:53760
  s_waitcnt lgkmcnt(12)
  v_mfma_f32_32x32x16_bf16 v[72:87], v[56:59], v[236:239], v[72:87]
  ds_read_b64_tr_b16 v[48:49], v18 offset:53248
  ds_read_b64_tr_b16 v[50:51], v18 offset:53760
  s_waitcnt lgkmcnt(6)
  v_min_u32 v9, v32, v33
  v_min3_u32 v9, v9, v34, v35
  s_nop 0
  v_readfirstlane_b32 s58, v9
  s_cmp_ge_u32 s58, 11
  s_cbranch_scc1 Ld112
Lp111:
  ds_read_b128 v[32:35], v11 offset:16
  s_waitcnt lgkmcnt(0)
  v_min_u32 v9, v32, v33
  v_min3_u32 v9, v9, v34, v35
  s_nop 0
  v_readfirstlane_b32 s58, v9
  s_cmp_ge_u32 s58, 11
  s_cbranch_scc1 Ld112
  s_sub_u32 s54, s54, 1
  s_cmp_gt_i32 s54, 0
  s_cbranch_scc1 Lp111
Ld112:
  s_add_u32 m0, s60, 0x14000
  s_nop 0
  buffer_load_dwordx4 v24, s[40:43], s59 offen lds
  s_add_u32 m0, s60, 0x14400
  s_nop 0
  buffer_load_dwordx4 v25, s[40:43], s59 offen lds
  s_add_u32 m0, s60, 0x14800
  s_nop 0
  buffer_load_dwordx4 v26, s[40:43], s59 offen lds
  s_add_u32 s59, s59, 229376
  s_cmp_eq_u32 s59, 1605632
  s_cselect_b32 s59, 0, s59
  v_mfma_f32_32x32x16_bf16 v[88:103], v[60:63], v[236:239], v[88:103]
  ds_read_b64_tr_b16 v[52:53], v19 offset:53248
  ds_read_b64_tr_b16 v[54:55], v19 offset:53760
  ds_read_b128 v[32:35], v11 offset:16
  v_mfma_f32_32x32x16_bf16 v[104:119], v[64:67], v[236:239], v[104:119]
  ds_read_b64_tr_b16 v[56:57], v16 offset:55296
  ds_read_b64_tr_b16 v[58:59], v16 offset:55808
  v_mfma_f32_32x32x16_bf16 v[120:135], v[68:71], v[236:239], v[120:135]
  ds_read_b64_tr_b16 v[60:61], v17 offset:55296
  ds_read_b64_tr_b16 v[62:63], v17 offset:55808
  s_waitcnt lgkmcnt(11)
  v_mfma_f32_32x32x16_bf16 v[72:87], v[40:43], v[240:243], v[72:87]
  ds_read_b64_tr_b16 v[64:65], v18 offset:55296
  ds_read_b64_tr_b16 v[66:67], v18 offset:55808
  s_waitcnt lgkmcnt(6)
  v_min_u32 v9, v32, v33
  v_min3_u32 v9, v9, v34, v35
  s_nop 0
  v_readfirstlane_b32 s58, v9
  s_cmp_ge_u32 s58, 12
  s_cbranch_scc1 Ld114
Lp113:
  ds_read_b128 v[32:35], v11 offset:16
  s_waitcnt lgkmcnt(0)
  v_min_u32 v9, v32, v33
  v_min3_u32 v9, v9, v34, v35
  s_nop 0
  v_readfirstlane_b32 s58, v9
  s_cmp_ge_u32 s58, 12
  s_cbranch_scc1 Ld114
  s_sub_u32 s54, s54, 1
  s_cmp_gt_i32 s54, 0
  s_cbranch_scc1 Lp113
Ld114:
  s_add_u32 m0, s60, 0x18000
  s_nop 0
  buffer_load_dwordx4 v24, s[40:43], s59 offen lds
  s_add_u32 m0, s60, 0x18400
  s_nop 0
  buffer_load_dwordx4 v25, s[40:43], s59 offen lds
  s_add_u32 m0, s60, 0x18800
  s_nop 0
  buffer_load_dwordx4 v26, s[40:43], s59 offen lds
  s_add_u32 s59, s59, 229376
  s_cmp_eq_u32 s59, 1605632
  s_cselect_b32 s59, 0, s59
  v_mfma_f32_32x32x16_bf16 v[88:103], v[44:47], v[240:243], v[88:103]
  ds_read_b64_tr_b16 v[68:69], v19 offset:55296
  ds_read_b64_tr_b16 v[70:71], v19 offset:55808
  ds_read_b128 v[32:35], v11 offset:16
  v_mfma_f32_32x32x16_bf16 v[104:119], v[48:51], v[240:243], v[104:119]
  v_mfma_f32_32x32x16_bf16 v[120:135], v[52:55], v[240:243], v[120:135]
  s_waitcnt lgkmcnt(7)
  v_mfma_f32_32x32x16_bf16 v[72:87], v[56:59], v[244:247], v[72:87]
  s_waitcnt lgkmcnt(0)
  v_min_u32 v9, v32, v33
  v_min3_u32 v9, v9, v34, v35
  s_nop 0
  v_readfirstlane_b32 s58, v9
  s_cmp_ge_u32 s58, 13
  s_cbranch_scc1 Ld116
Lp115:
  ds_read_b128 v[32:35], v11 offset:16
  s_waitcnt lgkmcnt(0)
  v_min_u32 v9, v32, v33
  v_min3_u32 v9, v9, v34, v35
  s_nop 0
  v_readfirstlane_b32 s58, v9
  s_cmp_ge_u32 s58, 13
  s_cbranch_scc1 Ld116
  s_sub_u32 s54, s54, 1
  s_cmp_gt_i32 s54, 0
  s_cbranch_scc1 Lp115
Ld116:
  s_add_u32 m0, s60, 0x0
  s_nop 0
  buffer_load_dwordx4 v24, s[40:43], s59 offen lds
  s_add_u32 m0, s60, 0x400
  s_nop 0
  buffer_load_dwordx4 v25, s[40:43], s59 offen lds
  s_add_u32 m0, s60, 0x800
  s_nop 0
  buffer_load_dwordx4 v26, s[40:43], s59 offen lds
  s_add_u32 s59, s59, 229376
  s_cmp_eq_u32 s59, 1605632
  s_cselect_b32 s59, 0, s59
  v_mfma_f32_32x32x16_bf16 v[88:103], v[60:63], v[244:247], v[88:103]
  v_mfma_f32_32x32x16_bf16 v[104:119], v[64:67], v[244:247], v[104:119]
  v_mfma_f32_32x32x16_bf16 v[120:135], v[68:71], v[244:247], v[120:135]
  v_mov_b32 v10, 16
  ds_write_b32 v12, v10 offset:16
  s_waitcnt vmcnt(6)
  v_mov_b32 v10, 5
  ds_write_b32 v12, v10 offset:80
  s_lshr_b32 s55, s61, 1
  s_lshl_b32 s55, s55, 5
  s_lshr_b32 s56, s52, 2
  s_lshl_b32 s56, s56, 3
  s_add_u32 s55, s55, s56
  s_and_b32 s56, s61, 1
  s_lshl_b32 s56, s56, 2
  s_add_u32 s55, s55, s56
  s_and_b32 s56, s52, 3
  s_add_u32 s55, s55, s56
  s_lshl_b32 s55, s55, 2
  s_add_u32 s62, s55, 0x1c01000
  v_mul_f32 v72, 0xbfb8aa3b, v72
  v_mul_f32 v73, 0xbfb8aa3b, v73
  v_mul_f32 v74, 0xbfb8aa3b, v74
  v_mul_f32 v75, 0xbfb8aa3b, v75
  v_mul_f32 v76, 0xbfb8aa3b, v76
  v_mul_f32 v77, 0xbfb8aa3b, v77
  v_mul_f32 v78, 0xbfb8aa3b, v78
  v_mul_f32 v79, 0xbfb8aa3b, v79
  v_exp_f32 v72, v72
  v_exp_f32 v73, v73
  v_exp_f32 v74, v74
  v_exp_f32 v75, v75
  v_exp_f32 v76, v76
  v_exp_f32 v77, v77
  v_exp_f32 v78, v78
  v_exp_f32 v79, v79
  v_fma_f32 v72, v72, v13, v13
  v_fma_f32 v73, v73, v13, v13
  v_fma_f32 v74, v74, v13, v13
  v_fma_f32 v75, v75, v13, v13
  v_fma_f32 v76, v76, v13, v13
  v_fma_f32 v77, v77, v13, v13
  v_fma_f32 v78, v78, v13, v13
  v_fma_f32 v79, v79, v13, v13
  v_rcp_f32 v72, v72
  v_rcp_f32 v73, v73
  v_rcp_f32 v74, v74
  v_rcp_f32 v75, v75
  v_rcp_f32 v76, v76
  v_rcp_f32 v77, v77
  v_rcp_f32 v78, v78
  v_rcp_f32 v79, v79
  v_mul_f32 v80, v72, v80
  v_mul_f32 v81, v73, v81
  v_mul_f32 v82, v74, v82
  v_mul_f32 v83, v75, v83
  v_mul_f32 v84, v76, v84
  v_mul_f32 v85, v77, v85
  v_mul_f32 v86, v78, v86
  v_mul_f32 v87, v79, v87
  v_cvt_pk_bf16_f32 v72, v80, v81
  v_cvt_pk_bf16_f32 v73, v82, v83
  v_cvt_pk_bf16_f32 v74, v84, v85
  v_cvt_pk_bf16_f32 v75, v86, v87
  buffer_store_dwordx4 v[72:75], v2, s[28:31], s63 offen offset:0 sc1
  v_mul_f32 v88, 0xbfb8aa3b, v88
  v_mul_f32 v89, 0xbfb8aa3b, v89
  v_mul_f32 v90, 0xbfb8aa3b, v90
  v_mul_f32 v91, 0xbfb8aa3b, v91
  v_mul_f32 v92, 0xbfb8aa3b, v92
  v_mul_f32 v93, 0xbfb8aa3b, v93
  v_mul_f32 v94, 0xbfb8aa3b, v94
  v_mul_f32 v95, 0xbfb8aa3b, v95
  v_exp_f32 v88, v88
  v_exp_f32 v89, v89
  v_exp_f32 v90, v90
  v_exp_f32 v91, v91
  v_exp_f32 v92, v92
  v_exp_f32 v93, v93
  v_exp_f32 v94, v94
  v_exp_f32 v95, v95
  v_fma_f32 v88, v88, v13, v13
  v_fma_f32 v89, v89, v13, v13
  v_fma_f32 v90, v90, v13, v13
  v_fma_f32 v91, v91, v13, v13
  v_fma_f32 v92, v92, v13, v13
  v_fma_f32 v93, v93, v13, v13
  v_fma_f32 v94, v94, v13, v13
  v_fma_f32 v95, v95, v13, v13
  v_rcp_f32 v88, v88
  v_rcp_f32 v89, v89
  v_rcp_f32 v90, v90
  v_rcp_f32 v91, v91
  v_rcp_f32 v92, v92
  v_rcp_f32 v93, v93
  v_rcp_f32 v94, v94
  v_rcp_f32 v95, v95
  v_mul_f32 v96, v88, v96
  v_mul_f32 v97, v89, v97
  v_mul_f32 v98, v90, v98
  v_mul_f32 v99, v91, v99
  v_mul_f32 v100, v92, v100
  v_mul_f32 v101, v93, v101
  v_mul_f32 v102, v94, v102
  v_mul_f32 v103, v95, v103
  v_cvt_pk_bf16_f32 v88, v96, v97
  v_cvt_pk_bf16_f32 v89, v98, v99
  v_cvt_pk_bf16_f32 v90, v100, v101
  v_cvt_pk_bf16_f32 v91, v102, v103
  buffer_store_dwordx4 v[88:91], v2, s[28:31], s63 offen offset:1024 sc1
  v_mul_f32 v104, 0xbfb8aa3b, v104
  v_mul_f32 v105, 0xbfb8aa3b, v105
  v_mul_f32 v106, 0xbfb8aa3b, v106
  v_mul_f32 v107, 0xbfb8aa3b, v107
  v_mul_f32 v108, 0xbfb8aa3b, v108
  v_mul_f32 v109, 0xbfb8aa3b, v109
  v_mul_f32 v110, 0xbfb8aa3b, v110
  v_mul_f32 v111, 0xbfb8aa3b, v111
  v_exp_f32 v104, v104
  v_exp_f32 v105, v105
  v_exp_f32 v106, v106
  v_exp_f32 v107, v107
  v_exp_f32 v108, v108
  v_exp_f32 v109, v109
  v_exp_f32 v110, v110
  v_exp_f32 v111, v111
  v_fma_f32 v104, v104, v13, v13
  v_fma_f32 v105, v105, v13, v13
  v_fma_f32 v106, v106, v13, v13
  v_fma_f32 v107, v107, v13, v13
  v_fma_f32 v108, v108, v13, v13
  v_fma_f32 v109, v109, v13, v13
  v_fma_f32 v110, v110, v13, v13
  v_fma_f32 v111, v111, v13, v13
  v_rcp_f32 v104, v104
  v_rcp_f32 v105, v105
  v_rcp_f32 v106, v106
  v_rcp_f32 v107, v107
  v_rcp_f32 v108, v108
  v_rcp_f32 v109, v109
  v_rcp_f32 v110, v110
  v_rcp_f32 v111, v111
  v_mul_f32 v112, v104, v112
  v_mul_f32 v113, v105, v113
  v_mul_f32 v114, v106, v114
  v_mul_f32 v115, v107, v115
  v_mul_f32 v116, v108, v116
  v_mul_f32 v117, v109, v117
  v_mul_f32 v118, v110, v118
  v_mul_f32 v119, v111, v119
  v_cvt_pk_bf16_f32 v104, v112, v113
  v_cvt_pk_bf16_f32 v105, v114, v115
  v_cvt_pk_bf16_f32 v106, v116, v117
  v_cvt_pk_bf16_f32 v107, v118, v119
  buffer_store_dwordx4 v[104:107], v2, s[28:31], s63 offen offset:2048 sc1
  v_mul_f32 v120, 0xbfb8aa3b, v120
  v_mul_f32 v121, 0xbfb8aa3b, v121
  v_mul_f32 v122, 0xbfb8aa3b, v122
  v_mul_f32 v123, 0xbfb8aa3b, v123
  v_mul_f32 v124, 0xbfb8aa3b, v124
  v_mul_f32 v125, 0xbfb8aa3b, v125
  v_mul_f32 v126, 0xbfb8aa3b, v126
  v_mul_f32 v127, 0xbfb8aa3b, v127
  v_exp_f32 v120, v120
  v_exp_f32 v121, v121
  v_exp_f32 v122, v122
  v_exp_f32 v123, v123
  v_exp_f32 v124, v124
  v_exp_f32 v125, v125
  v_exp_f32 v126, v126
  v_exp_f32 v127, v127
  v_fma_f32 v120, v120, v13, v13
  v_fma_f32 v121, v121, v13, v13
  v_fma_f32 v122, v122, v13, v13
  v_fma_f32 v123, v123, v13, v13
  v_fma_f32 v124, v124, v13, v13
  v_fma_f32 v125, v125, v13, v13
  v_fma_f32 v126, v126, v13, v13
  v_fma_f32 v127, v127, v13, v13
  v_rcp_f32 v120, v120
  v_rcp_f32 v121, v121
  v_rcp_f32 v122, v122
  v_rcp_f32 v123, v123
  v_rcp_f32 v124, v124
  v_rcp_f32 v125, v125
  v_rcp_f32 v126, v126
  v_rcp_f32 v127, v127
  v_mul_f32 v128, v120, v128
  v_mul_f32 v129, v121, v129
  v_mul_f32 v130, v122, v130
  v_mul_f32 v131, v123, v131
  v_mul_f32 v132, v124, v132
  v_mul_f32 v133, v125, v133
  v_mul_f32 v134, v126, v134
  v_mul_f32 v135, v127, v135
  v_cvt_pk_bf16_f32 v120, v128, v129
  v_cvt_pk_bf16_f32 v121, v130, v131
  v_cvt_pk_bf16_f32 v122, v132, v133
  v_cvt_pk_bf16_f32 v123, v134, v135
  buffer_store_dwordx4 v[120:123], v2, s[28:31], s63 offen offset:3072 sc1
  s_waitcnt vmcnt(4)
  v_mov_b32 v10, 7
  ds_write_b32 v12, v10 offset:80
  v_lshrrev_b32 v8, 5, v1
  v_bfe_u32 v6, v1, 2, 2
  v_lshl_add_u32 v3, v8, 3, v6
  v_bfe_u32 v4, v1, 4, 1
  v_and_b32 v5, 3, v1
  v_lshlrev_b32 v5, 3, v5
  v_mul_u32_u24 v6, 96, v3
  v_add_u32 v6, v6, v5
  v_mul_u32_u24 v7, 6272, v4
  v_add_u32 v16, v6, v7
  v_add_u32 v17, 0x10000, v16
  v_add_u32 v18, 0x20000, v16
  s_mul_i32 s63, s61, 112
  s_mul_i32 s55, s52, 3
  s_add_u32 s63, s63, s55
  s_add_u32 s63, s63, 64
  s_lshl_b32 s63, s63, 10
  s_add_u32 s63, s63, 0x800000
  s_min_u32 s58, s50, 27
  s_mul_i32 s55, s58, 37
  s_lshr_b32 s55, s55, 8
  s_mul_i32 s56, s55, 7
  s_sub_u32 s60, s58, s56
  s_lshl_b32 s57, s49, 2
  s_add_u32 s59, s55, s57
  s_mov_b32 s40, s16
  s_and_b32 s41, s17, 0xffff
  s_mov_b32 s42, 0x188000
  s_mov_b32 s43, 0x00020000
  s_mov_b32 s44, s8
  s_and_b32 s45, s9, 0xffff
  s_mov_b32 s46, 0x62000
  s_mov_b32 s47, 0x00020000
  s_mov_b32 s32, s20
  s_and_b32 s33, s21, 0xffff
  s_mov_b32 s34, 0x1c0000
  s_mov_b32 s35, 0x00020000
  v_lshrrev_b32 v3, 3, v1
  v_and_b32 v4, 7, v1
  v_bfe_u32 v5, v1, 4, 1
  v_lshlrev_b32 v6, 2, v5
  v_xor_b32 v4, v4, v6
  v_mul_u32_u24 v3, 896, v3
  v_lshl_add_u32 v3, v4, 4, v3
  s_lshl_b32 s56, s60, 7
  v_add_u32 v19, s56, v3
  s_mul_i32 s26, s48, 229376
  s_mul_i32 s27, s48, 12288
  s_add_u32 s27, s27, 0x4000
  s_lshl_b32 s55, s59, 7
  s_lshl_b32 s56, s48, 5
  s_add_u32 s55, s55, s56
  s_add_u32 s55, s55, 0x1c01000
  v_and_b32 v3, 7, v1
  v_lshl_add_u32 v20, v3, 2, s55
  s_lshl_b32 s11, s48, 11
  s_add_u32 s11, s11, 0x10000
  s_and_b32 s55, s48, 1
  s_lshl_b32 s56, s59, 1
  s_add_u32 s57, s55, s56
  s_lshl_b32 s58, s48, 4
  s_mul_i32 s4, s57, 112
  s_add_u32 s4, s4, s58
  s_lshl_b32 s4, s4, 10
  s_add_u32 s4, s4, 0x800000
  s_xor_b32 s56, s57, 1
  s_mul_i32 s5, s56, 112
  s_add_u32 s5, s5, s58
  s_lshl_b32 s5, s5, 10
  s_add_u32 s5, s5, 0x800000
  s_lshl_b32 s7, s57, 15
  s_add_u32 s7, s7, 0x1000000
  s_lshl_b32 s55, s57, 6
  s_add_u32 s55, s55, 0x1c02000
  v_and_b32 v3, 15, v1
  v_lshl_add_u32 v14, v3, 2, s55
  s_lshl_b32 s55, s48, 13
  s_add_u32 s7, s7, s55
  v_add_u32 v14, 0x1000, v2
  s_lshl_b32 s55, s57, 5
  v_and_b32 v7, 31, v1
  v_add_u32 v7, s55, v7
  v_lshrrev_b32 v6, 5, v1
  v_mul_u32_u24 v7, 896, v7
  v_lshl_add_u32 v7, v6, 4, v7
  s_lshr_b32 s55, s48, 1
  s_lshl_b32 s55, s55, 6
  s_lshl_b32 s56, s60, 7
  s_add_u32 s56, s56, s55
  v_add_u32 v27, s56, v7
  v_bfe_u32 v4, v1, 2, 2
  v_lshl_add_u32 v3, v6, 2, v4
  v_lshlrev_b32 v3, 7, v3
  v_lshrrev_b32 v4, 1, v4
  v_lshl_add_u32 v3, v4, 6, v3
  v_bfe_u32 v5, v1, 4, 1
  v_lshl_add_u32 v3, v5, 5, v3
  v_and_b32 v4, 3, v1
  v_lshl_add_u32 v3, v4, 3, v3
  v_xor_b32 v3, s55, v3
  v_add_u32 v21, s27, v3
  v_xor_b32 v22, 64, v21
  v_add_u32 v38, s11, v3
  v_xor_b32 v39, 64, v38
  s_mul_i32 s10, s48, 15360
  s_add_u32 s10, s10, 99328
  s_cmp_eq_u32 s48, 0
  s_cselect_b32 s10, 0, s10
  v_add_u32 v15, s10, v3
  v_xor_b32 v36, 64, v15
  v_add_u32 v23, s27, v2
  s_xor_b32 s55, s48, 1
  s_mul_i32 s55, s55, 12288
  s_add_u32 s55, s55, 16384
  v_add_u32 v24, s55, v2
  s_xor_b32 s55, s48, 2
  s_mul_i32 s55, s55, 12288
  s_add_u32 s55, s55, 20480
  v_add_u32 v25, s55, v2
  s_xor_b32 s55, s48, 3
  s_mul_i32 s55, s55, 12288
  s_add_u32 s55, s55, 24576
  v_add_u32 v26, s55, v2
  s_mul_i32 s6, s48, 100352
  s_lshl_b32 s55, s50, 2
  s_add_u32 s55, s55, s48
  s_mul_i32 s18, s55, 12544
  s_mul_i32 s19, s55, 3200
  v_lshlrev_b32 v120, 7, v1
  ds_read_b128 v[28:31], v11 offset:80
  s_waitcnt lgkmcnt(0)
  v_min_u32 v9, v28, v29
  v_min3_u32 v9, v9, v30, v31
  s_nop 0
  v_readfirstlane_b32 s58, v9
  s_cmp_ge_u32 s58, 5
  s_cbranch_scc1 Ld118
Lp117:
  ds_read_b128 v[28:31], v11 offset:80
  s_waitcnt lgkmcnt(0)
  v_min_u32 v9, v28, v29
  v_min3_u32 v9, v9, v30, v31
  s_nop 0
  v_readfirstlane_b32 s58, v9
  s_cmp_ge_u32 s58, 5
  s_cbranch_scc1 Ld118
  s_sub_u32 s54, s54, 1
  s_cmp_gt_i32 s54, 0
  s_cbranch_scc1 Lp117
Ld118:
  ds_read_b64_tr_b16 v[40:41], v17 offset:49152
  ds_read_b64_tr_b16 v[42:43], v17 offset:49536
  ds_read_b64_tr_b16 v[44:45], v17 offset:49184
  ds_read_b64_tr_b16 v[46:47], v17 offset:49568
  ds_read_b64_tr_b16 v[48:49], v17 offset:49216
  ds_read_b64_tr_b16 v[50:51], v17 offset:49600
  ds_read_b64_tr_b16 v[52:53], v17 offset:50688
  ds_read_b64_tr_b16 v[54:55], v17 offset:51072
  ds_read_b64_tr_b16 v[56:57], v17 offset:50720
  ds_read_b64_tr_b16 v[58:59], v17 offset:51104
  ds_read_b64_tr_b16 v[60:61], v17 offset:50752
  ds_read_b64_tr_b16 v[62:63], v17 offset:51136
  s_waitcnt lgkmcnt(10)
  v_mfma_f32_32x32x16_bf16 v[72:87], v[40:43], v[136:139], 0
  ds_read_b64_tr_b16 v[64:65], v17 offset:52224
  ds_read_b64_tr_b16 v[66:67], v17 offset:52608
  s_waitcnt lgkmcnt(10)
  v_mfma_f32_32x32x16_bf16 v[88:103], v[44:47], v[136:139], 0
  ds_read_b64_tr_b16 v[68:69], v17 offset:52256
  ds_read_b64_tr_b16 v[70:71], v17 offset:52640
  s_waitcnt lgkmcnt(10)
  v_mfma_f32_32x32x16_bf16 v[104:119], v[48:51], v[136:139], 0
  ds_read_b64_tr_b16 v[40:41], v17 offset:52288
  ds_read_b64_tr_b16 v[42:43], v17 offset:52672
  s_waitcnt lgkmcnt(10)
  v_mfma_f32_32x32x16_bf16 v[72:87], v[52:55], v[140:143], v[72:87]
  ds_read_b128 v[28:31], v11 offset:80
  ds_read_b64_tr_b16 v[44:45], v17 offset:53760
  ds_read_b64_tr_b16 v[46:47], v17 offset:54144
  s_waitcnt lgkmcnt(11)
  v_mfma_f32_32x32x16_bf16 v[88:103], v[56:59], v[140:143], v[88:103]
  ds_read_b64_tr_b16 v[48:49], v17 offset:53792
  ds_read_b64_tr_b16 v[50:51], v17 offset:54176
  s_waitcnt lgkmcnt(11)
  v_mfma_f32_32x32x16_bf16 v[104:119], v[60:63], v[140:143], v[104:119]
  ds_read_b64_tr_b16 v[52:53], v17 offset:53824
  ds_read_b64_tr_b16 v[54:55], v17 offset:54208
  s_waitcnt lgkmcnt(11)
  v_mfma_f32_32x32x16_bf16 v[72:87], v[64:67], v[144:147], v[72:87]
  s_waitcnt lgkmcnt(6)
  v_min_u32 v9, v28, v29
  v_min3_u32 v9, v9, v30, v31
  s_nop 0
  v_readfirstlane_b32 s58, v9
  s_cmp_ge_u32 s58, 5
  s_cbranch_scc1 Ld120
Lp119:
  ds_read_b128 v[28:31], v11 offset:80
  s_waitcnt lgkmcnt(0)
  v_min_u32 v9, v28, v29
  v_min3_u32 v9, v9, v30, v31
  s_nop 0
  v_readfirstlane_b32 s58, v9
  s_cmp_ge_u32 s58, 5
  s_cbranch_scc1 Ld120
  s_sub_u32 s54, s54, 1
  s_cmp_gt_i32 s54, 0
  s_cbranch_scc1 Lp119
Ld120:
  ds_read_b64_tr_b16 v[56:57], v17 offset:61696
  ds_read_b64_tr_b16 v[58:59], v17 offset:62080
  v_mfma_f32_32x32x16_bf16 v[88:103], v[68:71], v[144:147], v[88:103]
  ds_read_b64_tr_b16 v[60:61], v17 offset:61728
  ds_read_b64_tr_b16 v[62:63], v17 offset:62112
  v_mfma_f32_32x32x16_bf16 v[104:119], v[40:43], v[144:147], v[104:119]
  ds_read_b64_tr_b16 v[64:65], v17 offset:61760
  ds_read_b64_tr_b16 v[66:67], v17 offset:62144
  s_waitcnt lgkmcnt(10)
  v_mfma_f32_32x32x16_bf16 v[72:87], v[44:47], v[148:151], v[72:87]
  ds_read_b64_tr_b16 v[68:69], v17 offset:63232
  ds_read_b64_tr_b16 v[70:71], v17 offset:63616
  s_waitcnt lgkmcnt(10)
  v_mfma_f32_32x32x16_bf16 v[88:103], v[48:51], v[148:151], v[88:103]
  ds_read_b64_tr_b16 v[40:41], v17 offset:63264
  ds_read_b64_tr_b16 v[42:43], v17 offset:63648
  s_waitcnt lgkmcnt(10)
  v_mfma_f32_32x32x16_bf16 v[104:119], v[52:55], v[148:151], v[104:119]
  v_mov_b32 v10, 17
  ds_write_b32 v12, v10 offset:16
  ds_read_b64_tr_b16 v[44:45], v17 offset:63296
  ds_read_b64_tr_b16 v[46:47], v17 offset:63680
  ds_read_b128 v[32:35], v11 offset:16
  s_waitcnt lgkmcnt(12)
  v_mfma_f32_32x32x16_bf16 v[72:87], v[56:59], v[152:155], v[72:87]
  ds_read_b64_tr_b16 v[48:49], v17 offset:64768
  ds_read_b64_tr_b16 v[50:51], v17 offset:65152
  s_waitcnt lgkmcnt(12)
  v_mfma_f32_32x32x16_bf16 v[88:103], v[60:63], v[152:155], v[88:103]
  ds_read_b64_tr_b16 v[52:53], v17 offset:64800
  ds_read_b64_tr_b16 v[54:55], v17 offset:65184
  s_waitcnt lgkmcnt(12)
  v_mfma_f32_32x32x16_bf16 v[104:119], v[64:67], v[152:155], v[104:119]
  ds_read_b64_tr_b16 v[56:57], v17 offset:64832
  ds_read_b64_tr_b16 v[58:59], v17 offset:65216
  s_waitcnt lgkmcnt(6)
  v_min_u32 v9, v32, v33
  v_min3_u32 v9, v9, v34, v35
  s_nop 0
  v_readfirstlane_b32 s58, v9
  s_cmp_ge_u32 s58, 16
  s_cbranch_scc1 Ld122
Lp121:
  ds_read_b128 v[32:35], v11 offset:16
  s_waitcnt lgkmcnt(0)
  v_min_u32 v9, v32, v33
  v_min3_u32 v9, v9, v34, v35
  s_nop 0
  v_readfirstlane_b32 s58, v9
  s_cmp_ge_u32 s58, 16
  s_cbranch_scc1 Ld122
  s_sub_u32 s54, s54, 1
  s_cmp_gt_i32 s54, 0
  s_cbranch_scc1 Lp121
Ld122:
  s_add_u32 m0, s27, 0x0
  s_nop 0
  buffer_load_dwordx4 v19, s[40:43], s26 offen lds
  s_add_u32 s26, s26, 7168
  s_add_u32 m0, s27, 0x400
  s_nop 0
  buffer_load_dwordx4 v19, s[40:43], s26 offen lds
  s_add_u32 s26, s26, 7168
  s_add_u32 m0, s27, 0x800
  s_nop 0
  buffer_load_dwordx4 v19, s[40:43], s26 offen lds
  s_add_u32 s26, s26, 7168
  s_add_u32 m0, s27, 0xc00
  s_nop 0
  buffer_load_dwordx4 v19, s[40:43], s26 offen lds
  s_add_u32 s26, s26, 7168
  s_add_u32 m0, s27, 0x1000
  s_nop 0
  buffer_load_dwordx4 v19, s[40:43], s26 offen lds
  s_add_u32 s26, s26, 7168
  s_add_u32 m0, s27, 0x1400
  s_nop 0
  buffer_load_dwordx4 v19, s[40:43], s26 offen lds
  s_add_u32 s26, s26, 7168
  s_add_u32 m0, s27, 0x1800
  s_nop 0
  buffer_load_dwordx4 v19, s[40:43], s26 offen lds
  s_add_u32 s26, s26, 7168
  s_add_u32 m0, s27, 0x1c00
  s_nop 0
  buffer_load_dwordx4 v19, s[40:43], s26 offen lds
  s_add_u32 s26, s26, 7168
  s_add_u32 m0, s27, 0x2000
  s_nop 0
  buffer_load_dwordx4 v19, s[40:43], s26 offen lds
  s_add_u32 s26, s26, 7168
  s_add_u32 m0, s27, 0x2400
  s_nop 0
  buffer_load_dwordx4 v19, s[40:43], s26 offen lds
  s_add_u32 s26, s26, 7168
  s_add_u32 m0, s27, 0x2800
  s_nop 0
  buffer_load_dwordx4 v19, s[40:43], s26 offen lds
  s_add_u32 s26, s26, 7168
  s_add_u32 m0, s27, 0x2c00
  s_nop 0
  buffer_load_dwordx4 v19, s[40:43], s26 offen lds
  s_add_u32 s26, s26, 7168
  v_mfma_f32_32x32x16_bf16 v[72:87], v[68:71], v[156:159], v[72:87]
  ds_read_b128 v[28:31], v11 offset:80
  ds_read_b64_tr_b16 v[60:61], v18 offset:768
  ds_read_b64_tr_b16 v[62:63], v18 offset:1152
  v_mfma_f32_32x32x16_bf16 v[88:103], v[40:43], v[156:159], v[88:103]
  ds_read_b64_tr_b16 v[64:65], v18 offset:800
  ds_read_b64_tr_b16 v[66:67], v18 offset:1184
  v_mfma_f32_32x32x16_bf16 v[104:119], v[44:47], v[156:159], v[104:119]
  ds_read_b64_tr_b16 v[68:69], v18 offset:832
  ds_read_b64_tr_b16 v[70:71], v18 offset:1216
  s_waitcnt lgkmcnt(11)
  v_mfma_f32_32x32x16_bf16 v[72:87], v[48:51], v[160:163], v[72:87]
  s_waitcnt lgkmcnt(6)
  v_min_u32 v9, v28, v29
  v_min3_u32 v9, v9, v30, v31
  s_nop 0
  v_readfirstlane_b32 s58, v9
  s_cmp_ge_u32 s58, 5
  s_cbranch_scc1 Ld124
Lp123:
  ds_read_b128 v[28:31], v11 offset:80
  s_waitcnt lgkmcnt(0)
  v_min_u32 v9, v28, v29
  v_min3_u32 v9, v9, v30, v31
  s_nop 0
  v_readfirstlane_b32 s58, v9
  s_cmp_ge_u32 s58, 5
  s_cbranch_scc1 Ld124
  s_sub_u32 s54, s54, 1
  s_cmp_gt_i32 s54, 0
  s_cbranch_scc1 Lp123
Ld124:
  ds_read_b64_tr_b16 v[40:41], v18 offset:8704
  ds_read_b64_tr_b16 v[42:43], v18 offset:9088
  v_mfma_f32_32x32x16_bf16 v[88:103], v[52:55], v[160:163], v[88:103]
  ds_read_b64_tr_b16 v[44:45], v18 offset:8736
  ds_read_b64_tr_b16 v[46:47], v18 offset:9120
  v_mfma_f32_32x32x16_bf16 v[104:119], v[56:59], v[160:163], v[104:119]
  ds_read_b64_tr_b16 v[48:49], v18 offset:8768
  ds_read_b64_tr_b16 v[50:51], v18 offset:9152
  s_waitcnt lgkmcnt(10)
  v_mfma_f32_32x32x16_bf16 v[72:87], v[60:63], v[164:167], v[72:87]
  ds_read_b64_tr_b16 v[52:53], v18 offset:10240
  ds_read_b64_tr_b16 v[54:55], v18 offset:10624
  s_waitcnt lgkmcnt(10)
  v_mfma_f32_32x32x16_bf16 v[88:103], v[64:67], v[164:167], v[88:103]
  ds_read_b64_tr_b16 v[56:57], v18 offset:10272
  ds_read_b64_tr_b16 v[58:59], v18 offset:10656
  s_waitcnt lgkmcnt(10)
  v_mfma_f32_32x32x16_bf16 v[104:119], v[68:71], v[164:167], v[104:119]
  v_mov_b32 v10, 18
  ds_write_b32 v12, v10 offset:16
  ds_read_b64_tr_b16 v[60:61], v18 offset:10304
  ds_read_b64_tr_b16 v[62:63], v18 offset:10688
  s_waitcnt lgkmcnt(11)
  v_mfma_f32_32x32x16_bf16 v[72:87], v[40:43], v[168:171], v[72:87]
  ds_read_b64_tr_b16 v[64:65], v18 offset:11776
  ds_read_b64_tr_b16 v[66:67], v18 offset:12160
  s_waitcnt lgkmcnt(11)
  v_mfma_f32_32x32x16_bf16 v[88:103], v[44:47], v[168:171], v[88:103]
  ds_read_b64_tr_b16 v[68:69], v18 offset:11808
  ds_read_b64_tr_b16 v[70:71], v18 offset:12192
  s_waitcnt lgkmcnt(11)
  v_mfma_f32_32x32x16_bf16 v[104:119], v[48:51], v[168:171], v[104:119]
  ds_read_b64_tr_b16 v[40:41], v18 offset:11840
  ds_read_b64_tr_b16 v[42:43], v18 offset:12224
  s_waitcnt lgkmcnt(11)
  v_mfma_f32_32x32x16_bf16 v[72:87], v[52:55], v[172:175], v[72:87]
  ds_read_b128 v[28:31], v11 offset:80
  ds_read_b64_tr_b16 v[44:45], v18 offset:13312
  ds_read_b64_tr_b16 v[46:47], v18 offset:13696
  s_waitcnt lgkmcnt(12)
  v_mfma_f32_32x32x16_bf16 v[88:103], v[56:59], v[172:175], v[88:103]
  ds_read_b64_tr_b16 v[48:49], v18 offset:13344
  ds_read_b64_tr_b16 v[50:51], v18 offset:13728
  s_waitcnt lgkmcnt(11)
  v_mfma_f32_32x32x16_bf16 v[104:119], v[60:63], v[172:175], v[104:119]
  ds_read_b64_tr_b16 v[52:53], v18 offset:13376
  ds_read_b64_tr_b16 v[54:55], v18 offset:13760
  s_waitcnt lgkmcnt(11)
  v_mfma_f32_32x32x16_bf16 v[72:87], v[64:67], v[176:179], v[72:87]
  s_waitcnt lgkmcnt(6)
  v_min_u32 v9, v28, v29
  v_min3_u32 v9, v9, v30, v31
  s_nop 0
  v_readfirstlane_b32 s58, v9
  s_cmp_ge_u32 s58, 5
  s_cbranch_scc1 Ld126
Lp125:
  ds_read_b128 v[28:31], v11 offset:80
  s_waitcnt lgkmcnt(0)
  v_min_u32 v9, v28, v29
  v_min3_u32 v9, v9, v30, v31
  s_nop 0
  v_readfirstlane_b32 s58, v9
  s_cmp_ge_u32 s58, 5
  s_cbranch_scc1 Ld126
  s_sub_u32 s54, s54, 1
  s_cmp_gt_i32 s54, 0
  s_cbranch_scc1 Lp125
Ld126:
  ds_read_b64_tr_b16 v[56:57], v17 offset:0
  ds_read_b64_tr_b16 v[58:59], v17 offset:384
  s_waitcnt vmcnt(12)
  v_mov_b32 v9, 1
  v_mov_b32 v10, 0
  s_mov_b64 exec, 1
  buffer_store_dword v9, v10, s[28:31], s62 offen sc1
  s_mov_b64 exec, -1
  v_mfma_f32_32x32x16_bf16 v[88:103], v[68:71], v[176:179], v[88:103]
  ds_read_b64_tr_b16 v[60:61], v17 offset:32
  ds_read_b64_tr_b16 v[62:63], v17 offset:416
  v_mfma_f32_32x32x16_bf16 v[104:119], v[40:43], v[176:179], v[104:119]
  ds_read_b64_tr_b16 v[64:65], v17 offset:64
  ds_read_b64_tr_b16 v[66:67], v17 offset:448
  s_waitcnt lgkmcnt(10)
  v_mfma_f32_32x32x16_bf16 v[72:87], v[44:47], v[180:183], v[72:87]
  ds_read_b64_tr_b16 v[68:69], v17 offset:1536
  ds_read_b64_tr_b16 v[70:71], v17 offset:1920
  s_waitcnt lgkmcnt(10)
  v_mfma_f32_32x32x16_bf16 v[88:103], v[48:51], v[180:183], v[88:103]
  ds_read_b64_tr_b16 v[40:41], v17 offset:1568
  ds_read_b64_tr_b16 v[42:43], v17 offset:1952
  buffer_load_dword v121, v120, s[40:43], s18 offen
  s_waitcnt lgkmcnt(10)
  v_mfma_f32_32x32x16_bf16 v[104:119], v[52:55], v[180:183], v[104:119]
  v_mov_b32 v10, 19
  ds_write_b32 v12, v10 offset:16
  ds_read_b64_tr_b16 v[44:45], v17 offset:1600
  ds_read_b64_tr_b16 v[46:47], v17 offset:1984
  s_waitcnt lgkmcnt(11)
  v_mfma_f32_32x32x16_bf16 v[72:87], v[56:59], v[184:187], v[72:87]
  ds_read_b64_tr_b16 v[48:49], v17 offset:3072
  ds_read_b64_tr_b16 v[50:51], v17 offset:3456
  s_waitcnt lgkmcnt(11)
  v_mfma_f32_32x32x16_bf16 v[88:103], v[60:63], v[184:187], v[88:103]
  ds_read_b64_tr_b16 v[52:53], v17 offset:3104
  ds_read_b64_tr_b16 v[54:55], v17 offset:3488
  s_waitcnt lgkmcnt(11)
  v_mfma_f32_32x32x16_bf16 v[104:119], v[64:67], v[184:187], v[104:119]
  ds_read_b64_tr_b16 v[56:57], v17 offset:3136
  ds_read_b64_tr_b16 v[58:59], v17 offset:3520
  s_add_u32 s18, s18, 4352
  buffer_load_dword v122, v120, s[40:43], s18 offen
  s_waitcnt lgkmcnt(11)
  v_mfma_f32_32x32x16_bf16 v[72:87], v[68:71], v[188:191], v[72:87]
  ds_read_b128 v[28:31], v11 offset:80
  ds_read_b64_tr_b16 v[60:61], v17 offset:4608
  ds_read_b64_tr_b16 v[62:63], v17 offset:4992
  s_waitcnt lgkmcnt(12)
  v_mfma_f32_32x32x16_bf16 v[88:103], v[40:43], v[188:191], v[88:103]
  ds_read_b64_tr_b16 v[64:65], v17 offset:4640
  ds_read_b64_tr_b16 v[66:67], v17 offset:5024
  s_waitcnt lgkmcnt(11)
  v_mfma_f32_32x32x16_bf16 v[104:119], v[44:47], v[188:191], v[104:119]
  ds_read_b64_tr_b16 v[68:69], v17 offset:4672
  ds_read_b64_tr_b16 v[70:71], v17 offset:5056
  s_waitcnt lgkmcnt(11)
  v_mfma_f32_32x32x16_bf16 v[72:87], v[48:51], v[192:195], v[72:87]
  s_waitcnt lgkmcnt(6)
  v_min_u32 v9, v28, v29
  v_min3_u32 v9, v9, v30, v31
  s_nop 0
  v_readfirstlane_b32 s58, v9
  s_cmp_ge_u32 s58, 5
  s_cbranch_scc1 Ld128
Lp127:
  ds_read_b128 v[28:31], v11 offset:80
  s_waitcnt lgkmcnt(0)
  v_min_u32 v9, v28, v29
  v_min3_u32 v9, v9, v30, v31
  s_nop 0
  v_readfirstlane_b32 s58, v9
  s_cmp_ge_u32 s58, 5
  s_cbranch_scc1 Ld128
  s_sub_u32 s54, s54, 1
  s_cmp_gt_i32 s54, 0
  s_cbranch_scc1 Lp127
Ld128:
  ds_read_b64_tr_b16 v[40:41], v17 offset:16384
  ds_read_b64_tr_b16 v[42:43], v17 offset:16768
  buffer_load_dword v123, v120, s[44:47], s19 offen
  v_mfma_f32_32x32x16_bf16 v[88:103], v[52:55], v[192:195], v[88:103]
  ds_read_b64_tr_b16 v[44:45], v17 offset:16416
  ds_read_b64_tr_b16 v[46:47], v17 offset:16800
  v_mfma_f32_32x32x16_bf16 v[104:119], v[56:59], v[192:195], v[104:119]
  ds_read_b64_tr_b16 v[48:49], v17 offset:16448
  ds_read_b64_tr_b16 v[50:51], v17 offset:16832
  s_waitcnt lgkmcnt(10)
  v_mfma_f32_32x32x16_bf16 v[72:87], v[60:63], v[196:199], v[72:87]
  ds_read_b64_tr_b16 v[52:53], v17 offset:17920
  ds_read_b64_tr_b16 v[54:55], v17 offset:18304
  s_waitcnt lgkmcnt(10)
  v_mfma_f32_32x32x16_bf16 v[88:103], v[64:67], v[196:199], v[88:103]
  ds_read_b64_tr_b16 v[56:57], v17 offset:17952
  ds_read_b64_tr_b16 v[58:59], v17 offset:18336
  s_waitcnt lgkmcnt(10)
  v_mfma_f32_32x32x16_bf16 v[104:119], v[68:71], v[196:199], v[104:119]
  v_mov_b32 v10, 20
  ds_write_b32 v12, v10 offset:16
  ds_read_b64_tr_b16 v[60:61], v17 offset:17984
  ds_read_b64_tr_b16 v[62:63], v17 offset:18368
  s_waitcnt lgkmcnt(11)
  v_mfma_f32_32x32x16_bf16 v[72:87], v[40:43], v[200:203], v[72:87]
  ds_read_b64_tr_b16 v[64:65], v17 offset:19456
  ds_read_b64_tr_b16 v[66:67], v17 offset:19840
  s_waitcnt lgkmcnt(11)
  v_mfma_f32_32x32x16_bf16 v[88:103], v[44:47], v[200:203], v[88:103]
  ds_read_b64_tr_b16 v[68:69], v17 offset:19488
  ds_read_b64_tr_b16 v[70:71], v17 offset:19872
  s_waitcnt lgkmcnt(11)
  v_mfma_f32_32x32x16_bf16 v[104:119], v[48:51], v[200:203], v[104:119]
  ds_read_b64_tr_b16 v[40:41], v17 offset:19520
  ds_read_b64_tr_b16 v[42:43], v17 offset:19904
  s_waitcnt lgkmcnt(11)
  v_mfma_f32_32x32x16_bf16 v[72:87], v[52:55], v[204:207], v[72:87]
  ds_read_b128 v[28:31], v11 offset:80
  ds_read_b64_tr_b16 v[44:45], v17 offset:20992
  ds_read_b64_tr_b16 v[46:47], v17 offset:21376
  s_waitcnt lgkmcnt(12)
  v_mfma_f32_32x32x16_bf16 v[88:103], v[56:59], v[204:207], v[88:103]
  ds_read_b64_tr_b16 v[48:49], v17 offset:21024
  ds_read_b64_tr_b16 v[50:51], v17 offset:21408
  s_waitcnt lgkmcnt(11)
  v_mfma_f32_32x32x16_bf16 v[104:119], v[60:63], v[204:207], v[104:119]
  ds_read_b64_tr_b16 v[52:53], v17 offset:21056
  ds_read_b64_tr_b16 v[54:55], v17 offset:21440
  s_waitcnt lgkmcnt(11)
  v_mfma_f32_32x32x16_bf16 v[72:87], v[64:67], v[208:211], v[72:87]
  s_waitcnt lgkmcnt(6)
  v_min_u32 v9, v28, v29
  v_min3_u32 v9, v9, v30, v31
  s_nop 0
  v_readfirstlane_b32 s58, v9
  s_cmp_ge_u32 s58, 7
  s_cbranch_scc1 Ld130
Lp129:
  ds_read_b128 v[28:31], v11 offset:80
  s_waitcnt lgkmcnt(0)
  v_min_u32 v9, v28, v29
  v_min3_u32 v9, v9, v30, v31
  s_nop 0
  v_readfirstlane_b32 s58, v9
  s_cmp_ge_u32 s58, 7
  s_cbranch_scc1 Ld130
  s_sub_u32 s54, s54, 1
  s_cmp_gt_i32 s54, 0
  s_cbranch_scc1 Lp129
Ld130:
  ds_read_b64_tr_b16 v[56:57], v17 offset:32768
  ds_read_b64_tr_b16 v[58:59], v17 offset:33152
  v_mfma_f32_32x32x16_bf16 v[88:103], v[68:71], v[208:211], v[88:103]
  ds_read_b64_tr_b16 v[60:61], v17 offset:32800
  ds_read_b64_tr_b16 v[62:63], v17 offset:33184
  v_mfma_f32_32x32x16_bf16 v[104:119], v[40:43], v[208:211], v[104:119]
  ds_read_b64_tr_b16 v[64:65], v17 offset:32832
  ds_read_b64_tr_b16 v[66:67], v17 offset:33216
  s_waitcnt lgkmcnt(10)
  v_mfma_f32_32x32x16_bf16 v[72:87], v[44:47], v[212:215], v[72:87]
  ds_read_b64_tr_b16 v[68:69], v17 offset:34304
  ds_read_b64_tr_b16 v[70:71], v17 offset:34688
  s_waitcnt lgkmcnt(10)
  v_mfma_f32_32x32x16_bf16 v[88:103], v[48:51], v[212:215], v[88:103]
  ds_read_b64_tr_b16 v[40:41], v17 offset:34336
  ds_read_b64_tr_b16 v[42:43], v17 offset:34720
  s_waitcnt lgkmcnt(10)
  v_mfma_f32_32x32x16_bf16 v[104:119], v[52:55], v[212:215], v[104:119]
  v_mov_b32 v10, 21
  ds_write_b32 v12, v10 offset:16
  ds_read_b64_tr_b16 v[44:45], v17 offset:34368
  ds_read_b64_tr_b16 v[46:47], v17 offset:34752
  s_waitcnt lgkmcnt(11)
  v_mfma_f32_32x32x16_bf16 v[72:87], v[56:59], v[216:219], v[72:87]
  ds_read_b64_tr_b16 v[48:49], v17 offset:35840
  ds_read_b64_tr_b16 v[50:51], v17 offset:36224
  s_waitcnt lgkmcnt(11)
  v_mfma_f32_32x32x16_bf16 v[88:103], v[60:63], v[216:219], v[88:103]
  ds_read_b64_tr_b16 v[52:53], v17 offset:35872
  ds_read_b64_tr_b16 v[54:55], v17 offset:36256
  s_waitcnt lgkmcnt(11)
  v_mfma_f32_32x32x16_bf16 v[104:119], v[64:67], v[216:219], v[104:119]
  ds_read_b64_tr_b16 v[56:57], v17 offset:35904
  ds_read_b64_tr_b16 v[58:59], v17 offset:36288
  s_waitcnt lgkmcnt(11)
  v_mfma_f32_32x32x16_bf16 v[72:87], v[68:71], v[220:223], v[72:87]
  ds_read_b128 v[28:31], v11 offset:80
  ds_read_b64_tr_b16 v[60:61], v17 offset:37376
  ds_read_b64_tr_b16 v[62:63], v17 offset:37760
  s_waitcnt lgkmcnt(12)
  v_mfma_f32_32x32x16_bf16 v[88:103], v[40:43], v[220:223], v[88:103]
  ds_read_b64_tr_b16 v[64:65], v17 offset:37408
  ds_read_b64_tr_b16 v[66:67], v17 offset:37792
  s_waitcnt lgkmcnt(11)
  v_mfma_f32_32x32x16_bf16 v[104:119], v[44:47], v[220:223], v[104:119]
  ds_read_b64_tr_b16 v[68:69], v17 offset:37440
  ds_read_b64_tr_b16 v[70:71], v17 offset:37824
  s_waitcnt lgkmcnt(11)
  v_mfma_f32_32x32x16_bf16 v[72:87], v[48:51], v[224:227], v[72:87]
  s_waitcnt lgkmcnt(6)
  v_min_u32 v9, v28, v29
  v_min3_u32 v9, v9, v30, v31
  s_nop 0
  v_readfirstlane_b32 s58, v9
  s_cmp_ge_u32 s58, 7
  s_cbranch_scc1 Ld132
Lp131:
  ds_read_b128 v[28:31], v11 offset:80
  s_waitcnt lgkmcnt(0)
  v_min_u32 v9, v28, v29
  v_min3_u32 v9, v9, v30, v31
  s_nop 0
  v_readfirstlane_b32 s58, v9
  s_cmp_ge_u32 s58, 7
  s_cbranch_scc1 Ld132
  s_sub_u32 s54, s54, 1
  s_cmp_gt_i32 s54, 0
  s_cbranch_scc1 Lp131
Ld132:
  ds_read_b64_tr_b16 v[40:41], v16 offset:0
  ds_read_b64_tr_b16 v[42:43], v16 offset:384
  buffer_load_dword v37, v20, s[28:31], 0 offen sc1
  v_mfma_f32_32x32x16_bf16 v[88:103], v[52:55], v[224:227], v[88:103]
  ds_read_b64_tr_b16 v[44:45], v16 offset:32
  ds_read_b64_tr_b16 v[46:47], v16 offset:416
  v_mfma_f32_32x32x16_bf16 v[104:119], v[56:59], v[224:227], v[104:119]
  ds_read_b64_tr_b16 v[48:49], v16 offset:64
  ds_read_b64_tr_b16 v[50:51], v16 offset:448
  s_waitcnt lgkmcnt(10)
  v_mfma_f32_32x32x16_bf16 v[72:87], v[60:63], v[228:231], v[72:87]
  ds_read_b64_tr_b16 v[52:53], v16 offset:1536
  ds_read_b64_tr_b16 v[54:55], v16 offset:1920
  s_waitcnt lgkmcnt(10)
  v_mfma_f32_32x32x16_bf16 v[88:103], v[64:67], v[228:231], v[88:103]
  ds_read_b64_tr_b16 v[56:57], v16 offset:1568
  ds_read_b64_tr_b16 v[58:59], v16 offset:1952
  s_waitcnt lgkmcnt(10)
  v_mfma_f32_32x32x16_bf16 v[104:119], v[68:71], v[228:231], v[104:119]
  v_mov_b32 v10, 22
  ds_write_b32 v12, v10 offset:16
  ds_read_b64_tr_b16 v[60:61], v16 offset:1600
  ds_read_b64_tr_b16 v[62:63], v16 offset:1984
  s_waitcnt lgkmcnt(11)
  v_mfma_f32_32x32x16_bf16 v[72:87], v[40:43], v[232:235], v[72:87]
  ds_read_b64_tr_b16 v[64:65], v16 offset:3072
  ds_read_b64_tr_b16 v[66:67], v16 offset:3456
  s_waitcnt lgkmcnt(11)
  v_mfma_f32_32x32x16_bf16 v[88:103], v[44:47], v[232:235], v[88:103]
  ds_read_b64_tr_b16 v[68:69], v16 offset:3104
  ds_read_b64_tr_b16 v[70:71], v16 offset:3488
  s_waitcnt lgkmcnt(11)
  v_mfma_f32_32x32x16_bf16 v[104:119], v[48:51], v[232:235], v[104:119]
  ds_read_b64_tr_b16 v[40:41], v16 offset:3136
  ds_read_b64_tr_b16 v[42:43], v16 offset:3520
  s_waitcnt lgkmcnt(11)
  v_mfma_f32_32x32x16_bf16 v[72:87], v[52:55], v[236:239], v[72:87]
  ds_read_b64_tr_b16 v[44:45], v16 offset:4608
  ds_read_b64_tr_b16 v[46:47], v16 offset:4992
  s_waitcnt lgkmcnt(11)
  v_mfma_f32_32x32x16_bf16 v[88:103], v[56:59], v[236:239], v[88:103]
  ds_read_b64_tr_b16 v[48:49], v16 offset:4640
  ds_read_b64_tr_b16 v[50:51], v16 offset:5024
  s_waitcnt lgkmcnt(10)
  v_mfma_f32_32x32x16_bf16 v[104:119], v[60:63], v[236:239], v[104:119]
  ds_read_b64_tr_b16 v[52:53], v16 offset:4672
  ds_read_b64_tr_b16 v[54:55], v16 offset:5056
  s_waitcnt lgkmcnt(10)
  v_mfma_f32_32x32x16_bf16 v[72:87], v[64:67], v[240:243], v[72:87]
  s_waitcnt lgkmcnt(8)
  v_mfma_f32_32x32x16_bf16 v[88:103], v[68:71], v[240:243], v[88:103]
  s_waitcnt lgkmcnt(6)
  v_mfma_f32_32x32x16_bf16 v[104:119], v[40:43], v[240:243], v[104:119]
  s_waitcnt lgkmcnt(4)
  v_mfma_f32_32x32x16_bf16 v[72:87], v[44:47], v[244:247], v[72:87]
  s_waitcnt lgkmcnt(2)
  v_mfma_f32_32x32x16_bf16 v[88:103], v[48:51], v[244:247], v[88:103]
  s_waitcnt lgkmcnt(0)
  v_mfma_f32_32x32x16_bf16 v[104:119], v[52:55], v[244:247], v[104:119]
  v_mov_b32 v10, 23
  ds_write_b32 v12, v10 offset:16
  s_cmp_ge_u32 s50, 28
  s_cbranch_scc1 f_gtail
  s_waitcnt vmcnt(0)
  v_cmp_le_u32 vcc, 1, v37
  s_nop 1
  s_cmp_eq_u64 vcc, exec
  s_cbranch_scc1 Le134
Lg133:
  buffer_load_dword v37, v20, s[28:31], 0 offen sc1
  s_waitcnt vmcnt(0)
  v_cmp_le_u32 vcc, 1, v37
  s_nop 1
  s_cmp_eq_u64 vcc, exec
  s_cbranch_scc1 Le134
  s_sleep 2
  s_sub_u32 s54, s54, 1
  s_cmp_gt_i32 s54, 0
  s_cbranch_scc1 Lg133
Le134:
  buffer_load_dwordx4 v[136:139], v2, s[28:31], s4 offen offset:0 sc1
  buffer_load_dwordx4 v[140:143], v2, s[28:31], s5 offen offset:0 sc1
  buffer_load_dwordx4 v[144:147], v2, s[28:31], s4 offen offset:1024 sc1
  buffer_load_dwordx4 v[148:151], v2, s[28:31], s5 offen offset:1024 sc1
  buffer_load_dwordx4 v[152:155], v2, s[28:31], s4 offen offset:2048 sc1
  buffer_load_dwordx4 v[156:159], v2, s[28:31], s5 offen offset:2048 sc1
  buffer_load_dwordx4 v[160:163], v2, s[28:31], s4 offen offset:3072 sc1
  buffer_load_dwordx4 v[164:167], v2, s[28:31], s5 offen offset:3072 sc1
  s_add_u32 s4, s4, 4096
  s_add_u32 s5, s5, 4096
  v_mul_f32 v72, 0xbfb8aa3b, v72
  v_mul_f32 v73, 0xbfb8aa3b, v73
  v_mul_f32 v74, 0xbfb8aa3b, v74
  v_mul_f32 v75, 0xbfb8aa3b, v75
  v_mul_f32 v76, 0xbfb8aa3b, v76
  v_mul_f32 v77, 0xbfb8aa3b, v77
  v_mul_f32 v78, 0xbfb8aa3b, v78
  v_mul_f32 v79, 0xbfb8aa3b, v79
  v_exp_f32 v72, v72
  v_exp_f32 v73, v73
  v_exp_f32 v74, v74
  v_exp_f32 v75, v75
  v_exp_f32 v76, v76
  v_exp_f32 v77, v77
  v_exp_f32 v78, v78
  v_exp_f32 v79, v79
  v_fma_f32 v72, v72, v13, v13
  v_fma_f32 v73, v73, v13, v13
  v_fma_f32 v74, v74, v13, v13
  v_fma_f32 v75, v75, v13, v13
  v_fma_f32 v76, v76, v13, v13
  v_fma_f32 v77, v77, v13, v13
  v_fma_f32 v78, v78, v13, v13
  v_fma_f32 v79, v79, v13, v13
  v_rcp_f32 v72, v72
  v_rcp_f32 v73, v73
  v_rcp_f32 v74, v74
  v_rcp_f32 v75, v75
  v_rcp_f32 v76, v76
  v_rcp_f32 v77, v77
  v_rcp_f32 v78, v78
  v_rcp_f32 v79, v79
  v_mul_f32 v80, v72, v80
  v_mul_f32 v81, v73, v81
  v_mul_f32 v82, v74, v82
  v_mul_f32 v83, v75, v83
  v_mul_f32 v84, v76, v84
  v_mul_f32 v85, v77, v85
  v_mul_f32 v86, v78, v86
  v_mul_f32 v87, v79, v87
  v_cvt_pk_bf16_f32 v72, v80, v81
  v_cvt_pk_bf16_f32 v73, v82, v83
  v_cvt_pk_bf16_f32 v74, v84, v85
  v_cvt_pk_bf16_f32 v75, v86, v87
  buffer_store_dwordx4 v[72:75], v2, s[28:31], s63 offen offset:0 sc1
  v_mul_f32 v88, 0xbfb8aa3b, v88
  v_mul_f32 v89, 0xbfb8aa3b, v89
  v_mul_f32 v90, 0xbfb8aa3b, v90
  v_mul_f32 v91, 0xbfb8aa3b, v91
  v_mul_f32 v92, 0xbfb8aa3b, v92
  v_mul_f32 v93, 0xbfb8aa3b, v93
  v_mul_f32 v94, 0xbfb8aa3b, v94
  v_mul_f32 v95, 0xbfb8aa3b, v95
  v_exp_f32 v88, v88
  v_exp_f32 v89, v89
  v_exp_f32 v90, v90
  v_exp_f32 v91, v91
  v_exp_f32 v92, v92
  v_exp_f32 v93, v93
  v_exp_f32 v94, v94
  v_exp_f32 v95, v95
  v_fma_f32 v88, v88, v13, v13
  v_fma_f32 v89, v89, v13, v13
  v_fma_f32 v90, v90, v13, v13
  v_fma_f32 v91, v91, v13, v13
  v_fma_f32 v92, v92, v13, v13
  v_fma_f32 v93, v93, v13, v13
  v_fma_f32 v94, v94, v13, v13
  v_fma_f32 v95, v95, v13, v13
  v_rcp_f32 v88, v88
  v_rcp_f32 v89, v89
  v_rcp_f32 v90, v90
  v_rcp_f32 v91, v91
  v_rcp_f32 v92, v92
  v_rcp_f32 v93, v93
  v_rcp_f32 v94, v94
  v_rcp_f32 v95, v95
  v_mul_f32 v96, v88, v96
  v_mul_f32 v97, v89, v97
  v_mul_f32 v98, v90, v98
  v_mul_f32 v99, v91, v99
  v_mul_f32 v100, v92, v100
  v_mul_f32 v101, v93, v101
  v_mul_f32 v102, v94, v102
  v_mul_f32 v103, v95, v103
  v_cvt_pk_bf16_f32 v88, v96, v97
  v_cvt_pk_bf16_f32 v89, v98, v99
  v_cvt_pk_bf16_f32 v90, v100, v101
  v_cvt_pk_bf16_f32 v91, v102, v103
  buffer_store_dwordx4 v[88:91], v2, s[28:31], s63 offen offset:1024 sc1
  v_mul_f32 v104, 0xbfb8aa3b, v104
  v_mul_f32 v105, 0xbfb8aa3b, v105
  v_mul_f32 v106, 0xbfb8aa3b, v106
  v_mul_f32 v107, 0xbfb8aa3b, v107
  v_mul_f32 v108, 0xbfb8aa3b, v108
  v_mul_f32 v109, 0xbfb8aa3b, v109
  v_mul_f32 v110, 0xbfb8aa3b, v110
  v_mul_f32 v111, 0xbfb8aa3b, v111
  v_exp_f32 v104, v104
  v_exp_f32 v105, v105
  v_exp_f32 v106, v106
  v_exp_f32 v107, v107
  v_exp_f32 v108, v108
  v_exp_f32 v109, v109
  v_exp_f32 v110, v110
  v_exp_f32 v111, v111
  v_fma_f32 v104, v104, v13, v13
  v_fma_f32 v105, v105, v13, v13
  v_fma_f32 v106, v106, v13, v13
  v_fma_f32 v107, v107, v13, v13
  v_fma_f32 v108, v108, v13, v13
  v_fma_f32 v109, v109, v13, v13
  v_fma_f32 v110, v110, v13, v13
  v_fma_f32 v111, v111, v13, v13
  v_rcp_f32 v104, v104
  v_rcp_f32 v105, v105
  v_rcp_f32 v106, v106
  v_rcp_f32 v107, v107
  v_rcp_f32 v108, v108
  v_rcp_f32 v109, v109
  v_rcp_f32 v110, v110
  v_rcp_f32 v111, v111
  v_mul_f32 v112, v104, v112
  v_mul_f32 v113, v105, v113
  v_mul_f32 v114, v106, v114
  v_mul_f32 v115, v107, v115
  v_mul_f32 v116, v108, v116
  v_mul_f32 v117, v109, v117
  v_mul_f32 v118, v110, v118
  v_mul_f32 v119, v111, v119
  v_cvt_pk_bf16_f32 v104, v112, v113
  v_cvt_pk_bf16_f32 v105, v114, v115
  v_cvt_pk_bf16_f32 v106, v116, v117
  v_cvt_pk_bf16_f32 v107, v118, v119
  buffer_store_dwordx4 v[104:107], v2, s[28:31], s63 offen offset:2048 sc1
  buffer_load_dwordx4 v[168:171], v2, s[28:31], s4 offen offset:0 sc1
  buffer_load_dwordx4 v[172:175], v2, s[28:31], s5 offen offset:0 sc1
  buffer_load_dwordx4 v[176:179], v2, s[28:31], s4 offen offset:1024 sc1
  buffer_load_dwordx4 v[180:183], v2, s[28:31], s5 offen offset:1024 sc1
  buffer_load_dwordx4 v[184:187], v2, s[28:31], s4 offen offset:2048 sc1
  buffer_load_dwordx4 v[188:191], v2, s[28:31], s5 offen offset:2048 sc1
  buffer_load_dwordx4 v[192:195], v2, s[28:31], s4 offen offset:3072 sc1
  buffer_load_dwordx4 v[196:199], v2, s[28:31], s5 offen offset:3072 sc1
  s_add_u32 s4, s4, 4096
  s_add_u32 s5, s5, 4096
  s_waitcnt vmcnt(8)
  v_mov_b32 v9, 2
  v_mov_b32 v10, 0
  s_mov_b64 exec, 1
  buffer_store_dword v9, v10, s[28:31], s62 offen sc1
  s_mov_b64 exec, -1
  s_setprio 1
  ds_read_b64_tr_b16 v[40:41], v21 offset:0
  ds_read_b64_tr_b16 v[42:43], v21 offset:1024
  ds_read_b64_tr_b16 v[44:45], v22 offset:0
  ds_read_b64_tr_b16 v[46:47], v22 offset:1024
  s_xor_b32 s11, s7, 0x8000
  ds_read_b64_tr_b16 v[48:49], v21 offset:2048
  ds_read_b64_tr_b16 v[50:51], v21 offset:3072
  ds_read_b64_tr_b16 v[52:53], v22 offset:2048
  ds_read_b64_tr_b16 v[54:55], v22 offset:3072
  s_waitcnt lgkmcnt(4)
  v_mfma_f32_32x32x16_bf16 v[120:135], v[44:47], v[140:143], 0
  v_mfma_f32_32x32x16_bf16 v[104:119], v[44:47], v[136:139], 0
  v_mfma_f32_32x32x16_bf16 v[88:103], v[40:43], v[140:143], 0
  v_mfma_f32_32x32x16_bf16 v[72:87], v[40:43], v[136:139], 0
  s_add_u32 m0, s27, 0x0
  s_nop 0
  buffer_load_dwordx4 v19, s[40:43], s26 offen lds
  s_add_u32 s26, s26, 7168
  s_add_u32 m0, s27, 0x400
  s_nop 0
  buffer_load_dwordx4 v19, s[40:43], s26 offen lds
  s_add_u32 s26, s26, 7168
  buffer_load_dwordx4 v[136:139], v2, s[28:31], s4 offen offset:0 sc1
  buffer_load_dwordx4 v[140:143], v2, s[28:31], s5 offen offset:0 sc1
  ds_read_b64_tr_b16 v[40:41], v21 offset:4096
  ds_read_b64_tr_b16 v[42:43], v21 offset:5120
  ds_read_b64_tr_b16 v[44:45], v22 offset:4096
  ds_read_b64_tr_b16 v[46:47], v22 offset:5120
  s_waitcnt lgkmcnt(4)
  v_mfma_f32_32x32x16_bf16 v[120:135], v[52:55], v[148:151], v[120:135]
  v_mfma_f32_32x32x16_bf16 v[104:119], v[52:55], v[144:147], v[104:119]
  v_mfma_f32_32x32x16_bf16 v[88:103], v[48:51], v[148:151], v[88:103]
  v_mfma_f32_32x32x16_bf16 v[72:87], v[48:51], v[144:147], v[72:87]
  s_add_u32 m0, s27, 0x800
  s_nop 0
  buffer_load_dwordx4 v19, s[40:43], s26 offen lds
  s_add_u32 s26, s26, 7168
  s_add_u32 m0, s27, 0xc00
  s_nop 0
  buffer_load_dwordx4 v19, s[40:43], s26 offen lds
  s_add_u32 s26, s26, 7168
  buffer_load_dwordx4 v[144:147], v2, s[28:31], s4 offen offset:1024 sc1
  buffer_load_dwordx4 v[148:151], v2, s[28:31], s5 offen offset:1024 sc1
  ds_read_b64_tr_b16 v[48:49], v21 offset:6144
  ds_read_b64_tr_b16 v[50:51], v21 offset:7168
  ds_read_b64_tr_b16 v[52:53], v22 offset:6144
  ds_read_b64_tr_b16 v[54:55], v22 offset:7168
  s_waitcnt lgkmcnt(4)
  v_mfma_f32_32x32x16_bf16 v[120:135], v[44:47], v[156:159], v[120:135]
  v_mfma_f32_32x32x16_bf16 v[104:119], v[44:47], v[152:155], v[104:119]
  v_mfma_f32_32x32x16_bf16 v[88:103], v[40:43], v[156:159], v[88:103]
  v_mfma_f32_32x32x16_bf16 v[72:87], v[40:43], v[152:155], v[72:87]
  s_add_u32 m0, s27, 0x1000
  s_nop 0
  buffer_load_dwordx4 v19, s[40:43], s26 offen lds
  s_add_u32 s26, s26, 7168
  s_add_u32 m0, s27, 0x1400
  s_nop 0
  buffer_load_dwordx4 v19, s[40:43], s26 offen lds
  s_add_u32 s26, s26, 7168
  buffer_load_dwordx4 v[152:155], v2, s[28:31], s4 offen offset:2048 sc1
  buffer_load_dwordx4 v[156:159], v2, s[28:31], s5 offen offset:2048 sc1
  ds_read_b64_tr_b16 v[40:41], v21 offset:8192
  ds_read_b64_tr_b16 v[42:43], v21 offset:9216
  ds_read_b64_tr_b16 v[44:45], v22 offset:8192
  ds_read_b64_tr_b16 v[46:47], v22 offset:9216
  s_waitcnt lgkmcnt(4)
  v_mfma_f32_32x32x16_bf16 v[120:135], v[52:55], v[164:167], v[120:135]
  v_mfma_f32_32x32x16_bf16 v[104:119], v[52:55], v[160:163], v[104:119]
  v_mfma_f32_32x32x16_bf16 v[88:103], v[48:51], v[164:167], v[88:103]
  v_mfma_f32_32x32x16_bf16 v[72:87], v[48:51], v[160:163], v[72:87]
  s_add_u32 m0, s27, 0x1800
  s_nop 0
  buffer_load_dwordx4 v19, s[40:43], s26 offen lds
  s_add_u32 s26, s26, 7168
  s_add_u32 m0, s27, 0x1c00
  s_nop 0
  buffer_load_dwordx4 v19, s[40:43], s26 offen lds
  s_add_u32 s26, s26, 7168
  buffer_load_dwordx4 v[160:163], v2, s[28:31], s4 offen offset:3072 sc1
  buffer_load_dwordx4 v[164:167], v2, s[28:31], s5 offen offset:3072 sc1
  s_add_u32 s4, s4, 4096
  s_add_u32 s5, s5, 4096
  ds_read_b64_tr_b16 v[48:49], v21 offset:10240
  ds_read_b64_tr_b16 v[50:51], v21 offset:11264
  ds_read_b64_tr_b16 v[52:53], v22 offset:10240
  ds_read_b64_tr_b16 v[54:55], v22 offset:11264
  s_waitcnt vmcnt(23)
  s_waitcnt lgkmcnt(4)
  v_mfma_f32_32x32x16_bf16 v[120:135], v[44:47], v[172:175], v[120:135]
  v_mfma_f32_32x32x16_bf16 v[104:119], v[44:47], v[168:171], v[104:119]
  v_mfma_f32_32x32x16_bf16 v[88:103], v[40:43], v[172:175], v[88:103]
  v_mfma_f32_32x32x16_bf16 v[72:87], v[40:43], v[168:171], v[72:87]
  s_add_u32 m0, s27, 0x2000
  s_nop 0
  buffer_load_dwordx4 v19, s[40:43], s26 offen lds
  s_add_u32 s26, s26, 7168
  s_add_u32 m0, s27, 0x2400
  s_nop 0
  buffer_load_dwordx4 v19, s[40:43], s26 offen lds
  s_add_u32 s26, s26, 7168
  buffer_load_dwordx4 v[168:171], v2, s[28:31], s4 offen offset:0 sc1
  buffer_load_dwordx4 v[172:175], v2, s[28:31], s5 offen offset:0 sc1
  s_waitcnt vmcnt(18)
  ds_read_b64_tr_b16 v[40:41], v21 offset:0
  ds_read_b64_tr_b16 v[42:43], v21 offset:1024
  ds_read_b64_tr_b16 v[44:45], v22 offset:0
  ds_read_b64_tr_b16 v[46:47], v22 offset:1024
  s_waitcnt lgkmcnt(4)
  v_mfma_f32_32x32x16_bf16 v[120:135], v[52:55], v[180:183], v[120:135]
  v_mfma_f32_32x32x16_bf16 v[104:119], v[52:55], v[176:179], v[104:119]
  v_mfma_f32_32x32x16_bf16 v[88:103], v[48:51], v[180:183], v[88:103]
  v_mfma_f32_32x32x16_bf16 v[72:87], v[48:51], v[176:179], v[72:87]
  s_add_u32 m0, s27, 0x2800
  s_nop 0
  buffer_load_dwordx4 v19, s[40:43], s26 offen lds
  s_add_u32 s26, s26, 7168
  s_add_u32 m0, s27, 0x2c00
  s_nop 0
  buffer_load_dwordx4 v19, s[40:43], s26 offen lds
  s_add_u32 s26, s26, 7168
  buffer_load_dwordx4 v[176:179], v2, s[28:31], s4 offen offset:1024 sc1
  buffer_load_dwordx4 v[180:183], v2, s[28:31], s5 offen offset:1024 sc1
  buffer_load_dword v37, v20, s[28:31], 0 offen sc1
  s_waitcnt vmcnt(19)
  ds_read_b64_tr_b16 v[48:49], v21 offset:2048
  ds_read_b64_tr_b16 v[50:51], v21 offset:3072
  ds_read_b64_tr_b16 v[52:53], v22 offset:2048
  ds_read_b64_tr_b16 v[54:55], v22 offset:3072
  s_waitcnt lgkmcnt(4)
  v_mfma_f32_32x32x16_bf16 v[120:135], v[44:47], v[188:191], v[120:135]
  v_mfma_f32_32x32x16_bf16 v[104:119], v[44:47], v[184:187], v[104:119]
  v_mfma_f32_32x32x16_bf16 v[88:103], v[40:43], v[188:191], v[88:103]
  v_mfma_f32_32x32x16_bf16 v[72:87], v[40:43], v[184:187], v[72:87]
  s_add_u32 m0, s27, 0x0
  s_nop 0
  buffer_load_dwordx4 v19, s[40:43], s26 offen lds
  s_add_u32 s26, s26, 7168
  s_add_u32 m0, s27, 0x400
  s_nop 0
  buffer_load_dwordx4 v19, s[40:43], s26 offen lds
  s_add_u32 s26, s26, 7168
  buffer_load_dwordx4 v[184:187], v2, s[28:31], s4 offen offset:2048 sc1
  buffer_load_dwordx4 v[188:191], v2, s[28:31], s5 offen offset:2048 sc1
Lp135:
  ds_read_b128 v[28:31], v11 offset:16
  s_waitcnt lgkmcnt(0)
  v_min_u32 v9, v28, v29
  v_min3_u32 v9, v9, v30, v31
  s_nop 0
  v_readfirstlane_b32 s58, v9
  s_cmp_ge_u32 s58, 23
  s_cbranch_scc1 Ld136
  s_sub_u32 s54, s54, 1
  s_cmp_gt_i32 s54, 0
  s_cbranch_scc1 Lp135
Ld136:
Lp137:
  ds_read_b128 v[28:31], v11 offset:48
  s_waitcnt lgkmcnt(0)
  v_min_u32 v9, v28, v29
  v_min3_u32 v9, v9, v30, v31
  s_nop 0
  v_readfirstlane_b32 s58, v9
  s_cmp_ge_u32 s58, 1
  s_cbranch_scc1 Ld138
  s_sub_u32 s54, s54, 1
  s_cmp_gt_i32 s54, 0
  s_cbranch_scc1 Lp137
Ld138:
  s_add_u32 m0, s10, 0x0
  s_nop 0
  buffer_load_dwordx4 v19, s[44:47], s6 offen lds
  s_add_u32 s6, s6, 7168
  s_waitcnt vmcnt(20)
  ds_read_b64_tr_b16 v[40:41], v21 offset:4096
  ds_read_b64_tr_b16 v[42:43], v21 offset:5120
  ds_read_b64_tr_b16 v[44:45], v22 offset:4096
  ds_read_b64_tr_b16 v[46:47], v22 offset:5120
  s_waitcnt lgkmcnt(4)
  v_mfma_f32_32x32x16_bf16 v[120:135], v[52:55], v[196:199], v[120:135]
  v_mfma_f32_32x32x16_bf16 v[104:119], v[52:55], v[192:195], v[104:119]
  v_mfma_f32_32x32x16_bf16 v[88:103], v[48:51], v[196:199], v[88:103]
  v_mfma_f32_32x32x16_bf16 v[72:87], v[48:51], v[192:195], v[72:87]
  s_add_u32 m0, s27, 0x800
  s_nop 0
  buffer_load_dwordx4 v19, s[40:43], s26 offen lds
  s_add_u32 s26, s26, 7168
  s_add_u32 m0, s27, 0xc00
  s_nop 0
  buffer_load_dwordx4 v19, s[40:43], s26 offen lds
  s_add_u32 s26, s26, 7168
  buffer_load_dwordx4 v[192:195], v2, s[28:31], s4 offen offset:3072 sc1
  buffer_load_dwordx4 v[196:199], v2, s[28:31], s5 offen offset:3072 sc1
  s_lshl_b32 s55, s48, 12
  s_sub_u32 s4, s4, s55
  s_add_u32 s4, s4, 53248
  s_sub_u32 s5, s5, s55
  s_add_u32 s5, s5, 53248
  s_add_u32 m0, s10, 0x400
  s_nop 0
  buffer_load_dwordx4 v19, s[44:47], s6 offen lds
  s_add_u32 s6, s6, 7168
  s_waitcnt vmcnt(21)
  ds_read_b64_tr_b16 v[48:49], v21 offset:6144
  ds_read_b64_tr_b16 v[50:51], v21 offset:7168
  ds_read_b64_tr_b16 v[52:53], v22 offset:6144
  ds_read_b64_tr_b16 v[54:55], v22 offset:7168
  s_waitcnt lgkmcnt(4)
  v_mfma_f32_32x32x16_bf16 v[120:135], v[44:47], v[140:143], v[120:135]
  v_mfma_f32_32x32x16_bf16 v[104:119], v[44:47], v[136:139], v[104:119]
  v_mfma_f32_32x32x16_bf16 v[88:103], v[40:43], v[140:143], v[88:103]
  v_mfma_f32_32x32x16_bf16 v[72:87], v[40:43], v[136:139], v[72:87]
  s_add_u32 m0, s27, 0x1000
  s_nop 0
  buffer_load_dwordx4 v19, s[40:43], s26 offen lds
  s_add_u32 s26, s26, 7168
  s_add_u32 m0, s27, 0x1400
  s_nop 0
  buffer_load_dwordx4 v19, s[40:43], s26 offen lds
  s_add_u32 s26, s26, 7168
  s_waitcnt vmcnt(12)
  v_cmp_le_u32 vcc, 2, v37
  s_nop 1
  s_cmp_eq_u64 vcc, exec
  s_cbranch_scc1 Le140
Lg139:
  buffer_load_dword v37, v20, s[28:31], 0 offen sc1
  s_waitcnt vmcnt(0)
  v_cmp_le_u32 vcc, 2, v37
  s_nop 1
  s_cmp_eq_u64 vcc, exec
  s_cbranch_scc1 Le140
  s_sleep 2
  s_sub_u32 s54, s54, 1
  s_cmp_gt_i32 s54, 0
  s_cbranch_scc1 Lg139
Le140:
  buffer_load_dwordx4 v[136:139], v2, s[28:31], s4 offen offset:0 sc1
  buffer_load_dwordx4 v[140:143], v2, s[28:31], s5 offen offset:0 sc1
  s_add_u32 m0, s10, 0x800
  s_nop 0
  buffer_load_dwordx4 v19, s[44:47], s6 offen lds
  s_add_u32 s6, s6, 7168
  ds_read_b64_tr_b16 v[40:41], v21 offset:8192
  ds_read_b64_tr_b16 v[42:43], v21 offset:9216
  ds_read_b64_tr_b16 v[44:45], v22 offset:8192
  ds_read_b64_tr_b16 v[46:47], v22 offset:9216
  s_waitcnt lgkmcnt(4)
  v_mfma_f32_32x32x16_bf16 v[120:135], v[52:55], v[148:151], v[120:135]
  v_mfma_f32_32x32x16_bf16 v[104:119], v[52:55], v[144:147], v[104:119]
  v_mfma_f32_32x32x16_bf16 v[88:103], v[48:51], v[148:151], v[88:103]
  v_mfma_f32_32x32x16_bf16 v[72:87], v[48:51], v[144:147], v[72:87]
  s_add_u32 m0, s27, 0x1800
  s_nop 0
  buffer_load_dwordx4 v19, s[40:43], s26 offen lds
  s_add_u32 s26, s26, 7168
  s_add_u32 m0, s27, 0x1c00
  s_nop 0
  buffer_load_dwordx4 v19, s[40:43], s26 offen lds
  s_add_u32 s26, s26, 7168
  s_mul_i32 s55, s48, 57344
  s_sub_u32 s26, s26, s55
  s_add_u32 s26, s26, 688128
  buffer_load_dwordx4 v[144:147], v2, s[28:31], s4 offen offset:1024 sc1
  buffer_load_dwordx4 v[148:151], v2, s[28:31], s5 offen offset:1024 sc1
  s_add_u32 m0, s10, 0xc00
  s_nop 0
  buffer_load_dwordx4 v19, s[44:47], s6 offen lds
  s_add_u32 s6, s6, 7168
  ds_read_b64_tr_b16 v[48:49], v21 offset:10240
  ds_read_b64_tr_b16 v[50:51], v21 offset:11264
  ds_read_b64_tr_b16 v[52:53], v22 offset:10240
  ds_read_b64_tr_b16 v[54:55], v22 offset:11264
  s_waitcnt lgkmcnt(4)
  v_mfma_f32_32x32x16_bf16 v[120:135], v[44:47], v[156:159], v[120:135]
  v_mfma_f32_32x32x16_bf16 v[104:119], v[44:47], v[152:155], v[104:119]
  v_mfma_f32_32x32x16_bf16 v[88:103], v[40:43], v[156:159], v[88:103]
  v_mfma_f32_32x32x16_bf16 v[72:87], v[40:43], v[152:155], v[72:87]
  s_add_u32 m0, s27, 0x2000
  s_nop 0
  buffer_load_dwordx4 v19, s[40:43], s26 offen lds
  s_add_u32 s26, s26, 7168
  s_add_u32 m0, s27, 0x2400
  s_nop 0
  buffer_load_dwordx4 v19, s[40:43], s26 offen lds
  s_add_u32 s26, s26, 7168
  buffer_load_dwordx4 v[152:155], v2, s[28:31], s4 offen offset:2048 sc1
  buffer_load_dwordx4 v[156:159], v2, s[28:31], s5 offen offset:2048 sc1
  s_add_u32 m0, s10, 0x1000
  s_nop 0
  buffer_load_dwordx4 v19, s[44:47], s6 offen lds
  s_add_u32 s6, s6, 7168
  s_waitcnt vmcnt(23)
  ds_read_b64_tr_b16 v[40:41], v21 offset:0
  ds_read_b64_tr_b16 v[42:43], v21 offset:1024
  ds_read_b64_tr_b16 v[44:45], v22 offset:0
  ds_read_b64_tr_b16 v[46:47], v22 offset:1024
  s_waitcnt lgkmcnt(4)
  v_mfma_f32_32x32x16_bf16 v[120:135], v[52:55], v[164:167], v[120:135]
  v_mfma_f32_32x32x16_bf16 v[104:119], v[52:55], v[160:163], v[104:119]
  v_mfma_f32_32x32x16_bf16 v[88:103], v[48:51], v[164:167], v[88:103]
  v_mfma_f32_32x32x16_bf16 v[72:87], v[48:51], v[160:163], v[72:87]
  s_add_u32 m0, s27, 0x2800
  s_nop 0
  buffer_load_dwordx4 v19, s[40:43], s26 offen lds
  s_add_u32 s26, s26, 7168
  s_add_u32 m0, s27, 0x2c00
  s_nop 0
  buffer_load_dwordx4 v19, s[40:43], s26 offen lds
  s_add_u32 s26, s26, 7168
  buffer_load_dwordx4 v[160:163], v2, s[28:31], s4 offen offset:3072 sc1
  buffer_load_dwordx4 v[164:167], v2, s[28:31], s5 offen offset:3072 sc1
  s_add_u32 s4, s4, 4096
  s_add_u32 s5, s5, 4096
  s_add_u32 m0, s10, 0x1400
  s_nop 0
  buffer_load_dwordx4 v19, s[44:47], s6 offen lds
  s_add_u32 s6, s6, 7168
  s_waitcnt vmcnt(23)
  ds_read_b64_tr_b16 v[48:49], v21 offset:2048
  ds_read_b64_tr_b16 v[50:51], v21 offset:3072
  ds_read_b64_tr_b16 v[52:53], v22 offset:2048
  ds_read_b64_tr_b16 v[54:55], v22 offset:3072
  s_waitcnt lgkmcnt(4)
  v_mfma_f32_32x32x16_bf16 v[120:135], v[44:47], v[172:175], v[120:135]
  v_mfma_f32_32x32x16_bf16 v[104:119], v[44:47], v[168:171], v[104:119]
  v_mfma_f32_32x32x16_bf16 v[88:103], v[40:43], v[172:175], v[88:103]
  v_mfma_f32_32x32x16_bf16 v[72:87], v[40:43], v[168:171], v[72:87]
  s_add_u32 m0, s27, 0x0
  s_nop 0
  buffer_load_dwordx4 v19, s[40:43], s26 offen lds
  s_add_u32 s26, s26, 7168
  s_add_u32 m0, s27, 0x400
  s_nop 0
  buffer_load_dwordx4 v19, s[40:43], s26 offen lds
  s_add_u32 s26, s26, 7168
  buffer_load_dwordx4 v[168:171], v2, s[28:31], s4 offen offset:0 sc1
  buffer_load_dwordx4 v[172:175], v2, s[28:31], s5 offen offset:0 sc1
  s_add_u32 m0, s10, 0x1800
  s_nop 0
  buffer_load_dwordx4 v19, s[44:47], s6 offen lds
  s_add_u32 s6, s6, 7168
  s_waitcnt vmcnt(23)
  ds_read_b64_tr_b16 v[40:41], v21 offset:4096
  ds_read_b64_tr_b16 v[42:43], v21 offset:5120
  ds_read_b64_tr_b16 v[44:45], v22 offset:4096
  ds_read_b64_tr_b16 v[46:47], v22 offset:5120
  s_waitcnt lgkmcnt(4)
  v_mfma_f32_32x32x16_bf16 v[120:135], v[52:55], v[180:183], v[120:135]
  v_mfma_f32_32x32x16_bf16 v[104:119], v[52:55], v[176:179], v[104:119]
  v_mfma_f32_32x32x16_bf16 v[88:103], v[48:51], v[180:183], v[88:103]
  v_mfma_f32_32x32x16_bf16 v[72:87], v[48:51], v[176:179], v[72:87]
  s_add_u32 m0, s27, 0x800
  s_nop 0
  buffer_load_dwordx4 v19, s[40:43], s26 offen lds
  s_add_u32 s26, s26, 7168
  s_add_u32 m0, s27, 0xc00
  s_nop 0
  buffer_load_dwordx4 v19, s[40:43], s26 offen lds
  s_add_u32 s26, s26, 7168
  buffer_load_dwordx4 v[176:179], v2, s[28:31], s4 offen offset:1024 sc1
  buffer_load_dwordx4 v[180:183], v2, s[28:31], s5 offen offset:1024 sc1
  s_add_u32 m0, s10, 0x1c00
  s_nop 0
  buffer_load_dwordx4 v19, s[44:47], s6 offen lds
  s_add_u32 s6, s6, 7168
  s_waitcnt vmcnt(23)
  ds_read_b64_tr_b16 v[48:49], v21 offset:6144
  ds_read_b64_tr_b16 v[50:51], v21 offset:7168
  ds_read_b64_tr_b16 v[52:53], v22 offset:6144
  ds_read_b64_tr_b16 v[54:55], v22 offset:7168
  s_waitcnt lgkmcnt(4)
  v_mfma_f32_32x32x16_bf16 v[120:135], v[44:47], v[188:191], v[120:135]
  v_mfma_f32_32x32x16_bf16 v[104:119], v[44:47], v[184:187], v[104:119]
  v_mfma_f32_32x32x16_bf16 v[88:103], v[40:43], v[188:191], v[88:103]
  v_mfma_f32_32x32x16_bf16 v[72:87], v[40:43], v[184:187], v[72:87]
  s_add_u32 m0, s27, 0x1000
  s_nop 0
  buffer_load_dwordx4 v19, s[40:43], s26 offen lds
  s_add_u32 s26, s26, 7168
  s_add_u32 m0, s27, 0x1400
  s_nop 0
  buffer_load_dwordx4 v19, s[40:43], s26 offen lds
  s_add_u32 s26, s26, 7168
  buffer_load_dwordx4 v[184:187], v2, s[28:31], s4 offen offset:2048 sc1
  buffer_load_dwordx4 v[188:191], v2, s[28:31], s5 offen offset:2048 sc1
  s_add_u32 m0, s10, 0x2000
  s_nop 0
  buffer_load_dwordx4 v19, s[44:47], s6 offen lds
  s_add_u32 s6, s6, 7168
  s_waitcnt vmcnt(23)
  ds_read_b64_tr_b16 v[40:41], v21 offset:8192
  ds_read_b64_tr_b16 v[42:43], v21 offset:9216
  ds_read_b64_tr_b16 v[44:45], v22 offset:8192
  ds_read_b64_tr_b16 v[46:47], v22 offset:9216
  s_waitcnt lgkmcnt(4)
  v_mfma_f32_32x32x16_bf16 v[120:135], v[52:55], v[196:199], v[120:135]
  v_mfma_f32_32x32x16_bf16 v[104:119], v[52:55], v[192:195], v[104:119]
  v_mfma_f32_32x32x16_bf16 v[88:103], v[48:51], v[196:199], v[88:103]
  v_mfma_f32_32x32x16_bf16 v[72:87], v[48:51], v[192:195], v[72:87]
  s_add_u32 m0, s27, 0x1800
  s_nop 0
  buffer_load_dwordx4 v19, s[40:43], s26 offen lds
  s_add_u32 s26, s26, 7168
  s_add_u32 m0, s27, 0x1c00
  s_nop 0
  buffer_load_dwordx4 v19, s[40:43], s26 offen lds
  s_add_u32 s26, s26, 7168
  buffer_load_dwordx4 v[192:195], v2, s[28:31], s4 offen offset:3072 sc1
  buffer_load_dwordx4 v[196:199], v2, s[28:31], s5 offen offset:3072 sc1
  s_add_u32 s4, s4, 4096
  s_add_u32 s5, s5, 4096
  s_add_u32 m0, s10, 0x2400
  s_nop 0
  buffer_load_dwordx4 v19, s[44:47], s6 offen lds
  s_add_u32 s6, s6, 7168
  s_waitcnt vmcnt(23)
  ds_read_b64_tr_b16 v[48:49], v21 offset:10240
  ds_read_b64_tr_b16 v[50:51], v21 offset:11264
  ds_read_b64_tr_b16 v[52:53], v22 offset:10240
  ds_read_b64_tr_b16 v[54:55], v22 offset:11264
  s_waitcnt lgkmcnt(4)
  v_mfma_f32_32x32x16_bf16 v[120:135], v[44:47], v[140:143], v[120:135]
  v_mfma_f32_32x32x16_bf16 v[104:119], v[44:47], v[136:139], v[104:119]
  v_mfma_f32_32x32x16_bf16 v[88:103], v[40:43], v[140:143], v[88:103]
  v_mfma_f32_32x32x16_bf16 v[72:87], v[40:43], v[136:139], v[72:87]
  s_add_u32 m0, s27, 0x2000
  s_nop 0
  buffer_load_dwordx4 v19, s[40:43], s26 offen lds
  s_add_u32 s26, s26, 7168
  s_add_u32 m0, s27, 0x2400
  s_nop 0
  buffer_load_dwordx4 v19, s[40:43], s26 offen lds
  s_add_u32 s26, s26, 7168
  buffer_load_dwordx4 v[136:139], v2, s[28:31], s4 offen offset:0 sc1
  buffer_load_dwordx4 v[140:143], v2, s[28:31], s5 offen offset:0 sc1
  s_add_u32 m0, s10, 0x2800
  s_nop 0
  buffer_load_dwordx4 v19, s[44:47], s6 offen lds
  s_add_u32 s6, s6, 7168
  s_waitcnt vmcnt(23)
  ds_read_b64_tr_b16 v[40:41], v21 offset:0
  ds_read_b64_tr_b16 v[42:43], v21 offset:1024
  ds_read_b64_tr_b16 v[44:45], v22 offset:0
  ds_read_b64_tr_b16 v[46:47], v22 offset:1024
  s_waitcnt lgkmcnt(4)
  v_mfma_f32_32x32x16_bf16 v[120:135], v[52:55], v[148:151], v[120:135]
  v_mfma_f32_32x32x16_bf16 v[104:119], v[52:55], v[144:147], v[104:119]
  v_mfma_f32_32x32x16_bf16 v[88:103], v[48:51], v[148:151], v[88:103]
  v_mfma_f32_32x32x16_bf16 v[72:87], v[48:51], v[144:147], v[72:87]
  s_add_u32 m0, s27, 0x2800
  s_nop 0
  buffer_load_dwordx4 v19, s[40:43], s26 offen lds
  s_add_u32 s26, s26, 7168
  s_add_u32 m0, s27, 0x2c00
  s_nop 0
  buffer_load_dwordx4 v19, s[40:43], s26 offen lds
  s_add_u32 s26, s26, 7168
  buffer_load_dwordx4 v[144:147], v2, s[28:31], s4 offen offset:1024 sc1
  buffer_load_dwordx4 v[148:151], v2, s[28:31], s5 offen offset:1024 sc1
  s_add_u32 m0, s10, 0x2c00
  s_nop 0
  buffer_load_dwordx4 v19, s[44:47], s6 offen lds
  s_add_u32 s6, s6, 7168
  s_waitcnt vmcnt(23)
  ds_read_b64_tr_b16 v[48:49], v21 offset:2048
  ds_read_b64_tr_b16 v[50:51], v21 offset:3072
  ds_read_b64_tr_b16 v[52:53], v22 offset:2048
  ds_read_b64_tr_b16 v[54:55], v22 offset:3072
  s_waitcnt lgkmcnt(4)
  v_mfma_f32_32x32x16_bf16 v[120:135], v[44:47], v[156:159], v[120:135]
  v_mfma_f32_32x32x16_bf16 v[104:119], v[44:47], v[152:155], v[104:119]
  v_mfma_f32_32x32x16_bf16 v[88:103], v[40:43], v[156:159], v[88:103]
  v_mfma_f32_32x32x16_bf16 v[72:87], v[40:43], v[152:155], v[72:87]
  s_add_u32 m0, s27, 0x0
  s_nop 0
  buffer_load_dwordx4 v19, s[40:43], s26 offen lds
  s_add_u32 s26, s26, 7168
  s_add_u32 m0, s27, 0x400
  s_nop 0
  buffer_load_dwordx4 v19, s[40:43], s26 offen lds
  s_add_u32 s26, s26, 7168
  buffer_load_dwordx4 v[152:155], v2, s[28:31], s4 offen offset:2048 sc1
  buffer_load_dwordx4 v[156:159], v2, s[28:31], s5 offen offset:2048 sc1
  s_add_u32 m0, s10, 0x3000
  s_nop 0
  buffer_load_dwordx4 v19, s[44:47], s6 offen lds
  s_add_u32 s6, s6, 7168
  ds_read_b64_tr_b16 v[200:201], v15 offset:0
  ds_read_b64_tr_b16 v[202:203], v15 offset:1024
  ds_read_b64_tr_b16 v[204:205], v36 offset:0
  ds_read_b64_tr_b16 v[206:207], v36 offset:1024
  s_waitcnt vmcnt(23)
  ds_read_b64_tr_b16 v[40:41], v21 offset:4096
  ds_read_b64_tr_b16 v[42:43], v21 offset:5120
  ds_read_b64_tr_b16 v[44:45], v22 offset:4096
  ds_read_b64_tr_b16 v[46:47], v22 offset:5120
  s_waitcnt lgkmcnt(4)
  v_mfma_f32_32x32x16_bf16 v[120:135], v[52:55], v[164:167], v[120:135]
  v_mfma_f32_32x32x16_bf16 v[104:119], v[52:55], v[160:163], v[104:119]
  v_mfma_f32_32x32x16_bf16 v[88:103], v[48:51], v[164:167], v[88:103]
  v_mfma_f32_32x32x16_bf16 v[72:87], v[48:51], v[160:163], v[72:87]
  s_add_u32 m0, s27, 0x800
  s_nop 0
  buffer_load_dwordx4 v19, s[40:43], s26 offen lds
  s_add_u32 s26, s26, 7168
  s_add_u32 m0, s27, 0xc00
  s_nop 0
  buffer_load_dwordx4 v19, s[40:43], s26 offen lds
  s_add_u32 s26, s26, 7168
  buffer_load_dwordx4 v[160:163], v2, s[28:31], s4 offen offset:3072 sc1
  buffer_load_dwordx4 v[164:167], v2, s[28:31], s5 offen offset:3072 sc1
  s_add_u32 s4, s4, 4096
  s_add_u32 s5, s5, 4096
  s_add_u32 m0, s10, 0x3400
  s_nop 0
  buffer_load_dwordx4 v19, s[44:47], s6 offen lds
  s_add_u32 s6, s6, 7168
  ds_read_b64_tr_b16 v[208:209], v15 offset:2048
  ds_read_b64_tr_b16 v[210:211], v15 offset:3072
  ds_read_b64_tr_b16 v[212:213], v36 offset:2048
  ds_read_b64_tr_b16 v[214:215], v36 offset:3072
  s_waitcnt vmcnt(23)
  ds_read_b64_tr_b16 v[48:49], v21 offset:6144
  ds_read_b64_tr_b16 v[50:51], v21 offset:7168
  ds_read_b64_tr_b16 v[52:53], v22 offset:6144
  ds_read_b64_tr_b16 v[54:55], v22 offset:7168
  s_waitcnt lgkmcnt(4)
  v_mfma_f32_32x32x16_bf16 v[120:135], v[44:47], v[172:175], v[120:135]
  v_mfma_f32_32x32x16_bf16 v[104:119], v[44:47], v[168:171], v[104:119]
  v_mfma_f32_32x32x16_bf16 v[88:103], v[40:43], v[172:175], v[88:103]
  v_mfma_f32_32x32x16_bf16 v[72:87], v[40:43], v[168:171], v[72:87]
  s_add_u32 m0, s27, 0x1000
  s_nop 0
  buffer_load_dwordx4 v19, s[40:43], s26 offen lds
  s_add_u32 s26, s26, 7168
  s_add_u32 m0, s27, 0x1400
  s_nop 0
  buffer_load_dwordx4 v19, s[40:43], s26 offen lds
  s_add_u32 s26, s26, 7168
  s_add_u32 m0, s10, 0x3800
  s_nop 0
  buffer_load_dwordx4 v19, s[44:47], s6 offen lds
  s_add_u32 s6, s6, 7168
  ds_read_b64_tr_b16 v[216:217], v15 offset:3584
  ds_read_b64_tr_b16 v[218:219], v15 offset:4608
  ds_read_b64_tr_b16 v[220:221], v36 offset:3584
  ds_read_b64_tr_b16 v[222:223], v36 offset:4608
  s_waitcnt vmcnt(21)
  ds_read_b64_tr_b16 v[40:41], v21 offset:8192
  ds_read_b64_tr_b16 v[42:43], v21 offset:9216
  ds_read_b64_tr_b16 v[44:45], v22 offset:8192
  ds_read_b64_tr_b16 v[46:47], v22 offset:9216
  s_waitcnt lgkmcnt(4)
  v_mfma_f32_32x32x16_bf16 v[120:135], v[52:55], v[180:183], v[120:135]
  v_mfma_f32_32x32x16_bf16 v[104:119], v[52:55], v[176:179], v[104:119]
  v_mfma_f32_32x32x16_bf16 v[88:103], v[48:51], v[180:183], v[88:103]
  v_mfma_f32_32x32x16_bf16 v[72:87], v[48:51], v[176:179], v[72:87]
  s_add_u32 m0, s27, 0x1800
  s_nop 0
  buffer_load_dwordx4 v19, s[40:43], s26 offen lds
  s_add_u32 s26, s26, 7168
  s_add_u32 m0, s27, 0x1c00
  s_nop 0
  buffer_load_dwordx4 v19, s[40:43], s26 offen lds
  s_add_u32 s26, s26, 7168
  ds_read_b64_tr_b16 v[224:225], v15 offset:5632
  ds_read_b64_tr_b16 v[226:227], v15 offset:6656
  ds_read_b64_tr_b16 v[228:229], v36 offset:5632
  ds_read_b64_tr_b16 v[230:231], v36 offset:6656
  s_waitcnt vmcnt(18)
  ds_read_b64_tr_b16 v[48:49], v21 offset:10240
  ds_read_b64_tr_b16 v[50:51], v21 offset:11264
  ds_read_b64_tr_b16 v[52:53], v22 offset:10240
  ds_read_b64_tr_b16 v[54:55], v22 offset:11264
  s_waitcnt lgkmcnt(4)
  v_mfma_f32_32x32x16_bf16 v[120:135], v[44:47], v[188:191], v[120:135]
  v_mfma_f32_32x32x16_bf16 v[104:119], v[44:47], v[184:187], v[104:119]
  v_mfma_f32_32x32x16_bf16 v[88:103], v[40:43], v[188:191], v[88:103]
  v_mfma_f32_32x32x16_bf16 v[72:87], v[40:43], v[184:187], v[72:87]
  ds_read_b64_tr_b16 v[232:233], v15 offset:7168
  ds_read_b64_tr_b16 v[234:235], v15 offset:8192
  ds_read_b64_tr_b16 v[236:237], v36 offset:7168
  ds_read_b64_tr_b16 v[238:239], v36 offset:8192
  s_waitcnt vmcnt(13)
  ds_read_b64_tr_b16 v[40:41], v21 offset:0
  ds_read_b64_tr_b16 v[42:43], v21 offset:1024
  ds_read_b64_tr_b16 v[44:45], v22 offset:0
  ds_read_b64_tr_b16 v[46:47], v22 offset:1024
  s_waitcnt lgkmcnt(4)
  v_mfma_f32_32x32x16_bf16 v[120:135], v[52:55], v[196:199], v[120:135]
  v_mfma_f32_32x32x16_bf16 v[104:119], v[52:55], v[192:195], v[104:119]
  v_mfma_f32_32x32x16_bf16 v[88:103], v[48:51], v[196:199], v[88:103]
  v_mfma_f32_32x32x16_bf16 v[72:87], v[48:51], v[192:195], v[72:87]
  ds_read_b64_tr_b16 v[240:241], v15 offset:9216
  ds_read_b64_tr_b16 v[242:243], v15 offset:10240
  ds_read_b64_tr_b16 v[244:245], v36 offset:9216
  ds_read_b64_tr_b16 v[246:247], v36 offset:10240
  s_waitcnt vmcnt(8)
  ds_read_b64_tr_b16 v[48:49], v21 offset:2048
  ds_read_b64_tr_b16 v[50:51], v21 offset:3072
  ds_read_b64_tr_b16 v[52:53], v22 offset:2048
  ds_read_b64_tr_b16 v[54:55], v22 offset:3072
  s_waitcnt lgkmcnt(4)
  v_mfma_f32_32x32x16_bf16 v[120:135], v[44:47], v[140:143], v[120:135]
  v_mfma_f32_32x32x16_bf16 v[104:119], v[44:47], v[136:139], v[104:119]
  v_mfma_f32_32x32x16_bf16 v[88:103], v[40:43], v[140:143], v[88:103]
  v_mfma_f32_32x32x16_bf16 v[72:87], v[40:43], v[136:139], v[72:87]
  ds_read_b64_tr_b16 v[56:57], v15 offset:10752
  ds_read_b64_tr_b16 v[58:59], v15 offset:11776
  ds_read_b64_tr_b16 v[60:61], v36 offset:10752
  ds_read_b64_tr_b16 v[62:63], v36 offset:11776
  buffer_load_dwordx4 v[168:171], v2, s[28:31], s7 offen offset:0 sc1
  buffer_load_dwordx4 v[172:175], v2, s[28:31], s11 offen offset:0 sc1
  buffer_load_dwordx4 v[176:179], v2, s[28:31], s7 offen offset:1024 sc1
  buffer_load_dwordx4 v[180:183], v2, s[28:31], s11 offen offset:1024 sc1
  s_waitcnt vmcnt(7)
  ds_read_b64_tr_b16 v[40:41], v21 offset:4096
  ds_read_b64_tr_b16 v[42:43], v21 offset:5120
  ds_read_b64_tr_b16 v[44:45], v22 offset:4096
  ds_read_b64_tr_b16 v[46:47], v22 offset:5120
  s_waitcnt lgkmcnt(4)
  v_mfma_f32_32x32x16_bf16 v[120:135], v[52:55], v[148:151], v[120:135]
  v_mfma_f32_32x32x16_bf16 v[104:119], v[52:55], v[144:147], v[104:119]
  v_mfma_f32_32x32x16_bf16 v[88:103], v[48:51], v[148:151], v[88:103]
  v_mfma_f32_32x32x16_bf16 v[72:87], v[48:51], v[144:147], v[72:87]
  buffer_load_dwordx4 v[184:187], v2, s[28:31], s7 offen offset:2048 sc1
  buffer_load_dwordx4 v[188:191], v2, s[28:31], s11 offen offset:2048 sc1
  buffer_load_dwordx4 v[192:195], v2, s[28:31], s7 offen offset:3072 sc1
  buffer_load_dwordx4 v[196:199], v2, s[28:31], s11 offen offset:3072 sc1
  s_waitcnt vmcnt(8)
  ds_read_b64_tr_b16 v[48:49], v21 offset:6144
  ds_read_b64_tr_b16 v[50:51], v21 offset:7168
  ds_read_b64_tr_b16 v[52:53], v22 offset:6144
  ds_read_b64_tr_b16 v[54:55], v22 offset:7168
  s_waitcnt lgkmcnt(4)
  v_mfma_f32_32x32x16_bf16 v[120:135], v[44:47], v[156:159], v[120:135]
  v_mfma_f32_32x32x16_bf16 v[104:119], v[44:47], v[152:155], v[104:119]
  v_mfma_f32_32x32x16_bf16 v[88:103], v[40:43], v[156:159], v[88:103]
  v_mfma_f32_32x32x16_bf16 v[72:87], v[40:43], v[152:155], v[72:87]
  ds_read_b64_tr_b16 v[64:65], v15 offset:12800
  ds_read_b64_tr_b16 v[66:67], v15 offset:13824
  ds_read_b64_tr_b16 v[68:69], v36 offset:12800
  ds_read_b64_tr_b16 v[70:71], v36 offset:13824
  buffer_load_dwordx4 v[136:139], v14, s[28:31], s7 offen offset:0 sc1
  buffer_load_dwordx4 v[140:143], v14, s[28:31], s11 offen offset:0 sc1
  buffer_load_dwordx4 v[144:147], v14, s[28:31], s7 offen offset:1024 sc1
  buffer_load_dwordx4 v[148:151], v14, s[28:31], s11 offen offset:1024 sc1
  s_waitcnt lgkmcnt(0)
  v_mfma_f32_32x32x16_bf16 v[120:135], v[52:55], v[164:167], v[120:135]
  v_mfma_f32_32x32x16_bf16 v[104:119], v[52:55], v[160:163], v[104:119]
  v_mfma_f32_32x32x16_bf16 v[88:103], v[48:51], v[164:167], v[88:103]
  v_mfma_f32_32x32x16_bf16 v[72:87], v[48:51], v[160:163], v[72:87]
  buffer_load_dwordx4 v[152:155], v14, s[28:31], s7 offen offset:2048 sc1
  buffer_load_dwordx4 v[156:159], v14, s[28:31], s11 offen offset:2048 sc1
  buffer_load_dwordx4 v[160:163], v14, s[28:31], s7 offen offset:3072 sc1
  buffer_load_dwordx4 v[164:167], v14, s[28:31], s11 offen offset:3072 sc1
  s_mov_b32 s18, 0
  s_mov_b32 s19, -2
  s_waitcnt vmcnt(14)
  s_waitcnt lgkmcnt(0)
  v_max3_u32 v3, v168, v169, v170
  v_max3_u32 v4, v171, v172, v173
  v_max3_u32 v3, v3, v174, v175
  v_max_u32 v3, v3, v4
  v_cmp_lt_u32 vcc, s19, v3
  s_nop 1
  s_cbranch_vccnz Lm141
  v_mfma_f32_32x32x16_bf16 v[120:135], v[204:207], v[172:175], v[120:135]
  v_mfma_f32_32x32x16_bf16 v[104:119], v[204:207], v[168:171], v[104:119]
  v_mfma_f32_32x32x16_bf16 v[88:103], v[200:203], v[172:175], v[88:103]
  v_mfma_f32_32x32x16_bf16 v[72:87], v[200:203], v[168:171], v[72:87]
Ld142:
  s_waitcnt vmcnt(12)
  v_max3_u32 v3, v176, v177, v178
  v_max3_u32 v4, v179, v180, v181
  v_max3_u32 v3, v3, v182, v183
  v_max_u32 v3, v3, v4
  v_cmp_lt_u32 vcc, s19, v3
  s_nop 1
  s_cbranch_vccnz Lm143
  v_mfma_f32_32x32x16_bf16 v[120:135], v[212:215], v[180:183], v[120:135]
  v_mfma_f32_32x32x16_bf16 v[104:119], v[212:215], v[176:179], v[104:119]
  v_mfma_f32_32x32x16_bf16 v[88:103], v[208:211], v[180:183], v[88:103]
  v_mfma_f32_32x32x16_bf16 v[72:87], v[208:211], v[176:179], v[72:87]
Ld144:
  s_waitcnt vmcnt(10)
  v_max3_u32 v3, v184, v185, v186
  v_max3_u32 v4, v187, v188, v189
  v_max3_u32 v3, v3, v190, v191
  v_max_u32 v3, v3, v4
  v_cmp_lt_u32 vcc, s19, v3
  s_nop 1
  s_cbranch_vccnz Lm145
  v_mfma_f32_32x32x16_bf16 v[120:135], v[220:223], v[188:191], v[120:135]
  v_mfma_f32_32x32x16_bf16 v[104:119], v[220:223], v[184:187], v[104:119]
  v_mfma_f32_32x32x16_bf16 v[88:103], v[216:219], v[188:191], v[88:103]
  v_mfma_f32_32x32x16_bf16 v[72:87], v[216:219], v[184:187], v[72:87]
Ld146:
  s_waitcnt vmcnt(8)
  v_max3_u32 v3, v192, v193, v194
  v_max3_u32 v4, v195, v196, v197
  v_max3_u32 v3, v3, v198, v199
  v_max_u32 v3, v3, v4
  v_cmp_lt_u32 vcc, s19, v3
  s_nop 1
  s_cbranch_vccnz Lm147
  v_mfma_f32_32x32x16_bf16 v[120:135], v[228:231], v[196:199], v[120:135]
  v_mfma_f32_32x32x16_bf16 v[104:119], v[228:231], v[192:195], v[104:119]
  v_mfma_f32_32x32x16_bf16 v[88:103], v[224:227], v[196:199], v[88:103]
  v_mfma_f32_32x32x16_bf16 v[72:87], v[224:227], v[192:195], v[72:87]
Ld148:
  s_waitcnt vmcnt(6)
  v_max3_u32 v3, v136, v137, v138
  v_max3_u32 v4, v139, v140, v141
  v_max3_u32 v3, v3, v142, v143
  v_max_u32 v3, v3, v4
  v_cmp_lt_u32 vcc, s19, v3
  s_nop 1
  s_cbranch_vccnz Lm149
  v_mfma_f32_32x32x16_bf16 v[120:135], v[236:239], v[140:143], v[120:135]
  v_mfma_f32_32x32x16_bf16 v[104:119], v[236:239], v[136:139], v[104:119]
  v_mfma_f32_32x32x16_bf16 v[88:103], v[232:235], v[140:143], v[88:103]
  v_mfma_f32_32x32x16_bf16 v[72:87], v[232:235], v[136:139], v[72:87]
Ld150:
  s_waitcnt vmcnt(4)
  v_max3_u32 v3, v144, v145, v146
  v_max3_u32 v4, v147, v148, v149
  v_max3_u32 v3, v3, v150, v151
  v_max_u32 v3, v3, v4
  v_cmp_lt_u32 vcc, s19, v3
  s_nop 1
  s_cbranch_vccnz Lm151
  v_mfma_f32_32x32x16_bf16 v[120:135], v[244:247], v[148:151], v[120:135]
  v_mfma_f32_32x32x16_bf16 v[104:119], v[244:247], v[144:147], v[104:119]
  v_mfma_f32_32x32x16_bf16 v[88:103], v[240:243], v[148:151], v[88:103]
  v_mfma_f32_32x32x16_bf16 v[72:87], v[240:243], v[144:147], v[72:87]
Ld152:
  s_waitcnt vmcnt(2)
  v_max3_u32 v3, v152, v153, v154
  v_max3_u32 v4, v155, v156, v157
  v_max3_u32 v3, v3, v158, v159
  v_max_u32 v3, v3, v4
  v_cmp_lt_u32 vcc, s19, v3
  s_nop 1
  s_cbranch_vccnz Lm153
  v_mfma_f32_32x32x16_bf16 v[120:135], v[60:63], v[156:159], v[120:135]
  v_mfma_f32_32x32x16_bf16 v[104:119], v[60:63], v[152:155], v[104:119]
  v_mfma_f32_32x32x16_bf16 v[88:103], v[56:59], v[156:159], v[88:103]
  v_mfma_f32_32x32x16_bf16 v[72:87], v[56:59], v[152:155], v[72:87]
Ld154:
  s_waitcnt vmcnt(0)
  v_max3_u32 v3, v160, v161, v162
  v_max3_u32 v4, v163, v164, v165
  v_max3_u32 v3, v3, v166, v167
  v_max_u32 v3, v3, v4
  v_cmp_lt_u32 vcc, s19, v3
  s_nop 1
  s_cbranch_vccnz Lm155
  v_mfma_f32_32x32x16_bf16 v[120:135], v[68:71], v[164:167], v[120:135]
  v_mfma_f32_32x32x16_bf16 v[104:119], v[68:71], v[160:163], v[104:119]
  v_mfma_f32_32x32x16_bf16 v[88:103], v[64:67], v[164:167], v[88:103]
  v_mfma_f32_32x32x16_bf16 v[72:87], v[64:67], v[160:163], v[72:87]
Ld156:
  s_cmp_eq_u32 s18, 0
  s_cbranch_scc1 Lf157
Lr158:
  s_bitcmp1_b32 s18, 0
  s_cbranch_scc0 Ln159
  buffer_load_dwordx4 v[168:171], v2, s[28:31], s7 offen offset:0 sc1
  buffer_load_dwordx4 v[172:175], v2, s[28:31], s11 offen offset:0 sc1
Ln159:
  s_bitcmp1_b32 s18, 1
  s_cbranch_scc0 Ln160
  buffer_load_dwordx4 v[176:179], v2, s[28:31], s7 offen offset:1024 sc1
  buffer_load_dwordx4 v[180:183], v2, s[28:31], s11 offen offset:1024 sc1
Ln160:
  s_bitcmp1_b32 s18, 2
  s_cbranch_scc0 Ln161
  buffer_load_dwordx4 v[184:187], v2, s[28:31], s7 offen offset:2048 sc1
  buffer_load_dwordx4 v[188:191], v2, s[28:31], s11 offen offset:2048 sc1
Ln161:
  s_bitcmp1_b32 s18, 3
  s_cbranch_scc0 Ln162
  buffer_load_dwordx4 v[192:195], v2, s[28:31], s7 offen offset:3072 sc1
  buffer_load_dwordx4 v[196:199], v2, s[28:31], s11 offen offset:3072 sc1
Ln162:
  s_bitcmp1_b32 s18, 4
  s_cbranch_scc0 Ln163
  buffer_load_dwordx4 v[136:139], v14, s[28:31], s7 offen offset:0 sc1
  buffer_load_dwordx4 v[140:143], v14, s[28:31], s11 offen offset:0 sc1
Ln163:
  s_bitcmp1_b32 s18, 5
  s_cbranch_scc0 Ln164
  buffer_load_dwordx4 v[144:147], v14, s[28:31], s7 offen offset:1024 sc1
  buffer_load_dwordx4 v[148:151], v14, s[28:31], s11 offen offset:1024 sc1
Ln164:
  s_bitcmp1_b32 s18, 6
  s_cbranch_scc0 Ln165
  buffer_load_dwordx4 v[152:155], v14, s[28:31], s7 offen offset:2048 sc1
  buffer_load_dwordx4 v[156:159], v14, s[28:31], s11 offen offset:2048 sc1
Ln165:
  s_bitcmp1_b32 s18, 7
  s_cbranch_scc0 Ln166
  buffer_load_dwordx4 v[160:163], v14, s[28:31], s7 offen offset:3072 sc1
  buffer_load_dwordx4 v[164:167], v14, s[28:31], s11 offen offset:3072 sc1
Ln166:
  s_waitcnt vmcnt(0)
  s_bitcmp1_b32 s18, 0
  s_cbranch_scc0 Ln167
  v_max3_u32 v3, v168, v169, v170
  v_max3_u32 v4, v171, v172, v173
  v_max3_u32 v3, v3, v174, v175
  v_max_u32 v3, v3, v4
  v_cmp_lt_u32 vcc, s19, v3
  s_nop 1
  s_cbranch_vccnz Ln167
  v_mfma_f32_32x32x16_bf16 v[120:135], v[204:207], v[172:175], v[120:135]
  v_mfma_f32_32x32x16_bf16 v[104:119], v[204:207], v[168:171], v[104:119]
  v_mfma_f32_32x32x16_bf16 v[88:103], v[200:203], v[172:175], v[88:103]
  v_mfma_f32_32x32x16_bf16 v[72:87], v[200:203], v[168:171], v[72:87]
  s_bitset0_b32 s18, 0
Ln167:
  s_bitcmp1_b32 s18, 1
  s_cbranch_scc0 Ln168
  v_max3_u32 v3, v176, v177, v178
  v_max3_u32 v4, v179, v180, v181
  v_max3_u32 v3, v3, v182, v183
  v_max_u32 v3, v3, v4
  v_cmp_lt_u32 vcc, s19, v3
  s_nop 1
  s_cbranch_vccnz Ln168
  v_mfma_f32_32x32x16_bf16 v[120:135], v[212:215], v[180:183], v[120:135]
  v_mfma_f32_32x32x16_bf16 v[104:119], v[212:215], v[176:179], v[104:119]
  v_mfma_f32_32x32x16_bf16 v[88:103], v[208:211], v[180:183], v[88:103]
  v_mfma_f32_32x32x16_bf16 v[72:87], v[208:211], v[176:179], v[72:87]
  s_bitset0_b32 s18, 1
Ln168:
  s_bitcmp1_b32 s18, 2
  s_cbranch_scc0 Ln169
  v_max3_u32 v3, v184, v185, v186
  v_max3_u32 v4, v187, v188, v189
  v_max3_u32 v3, v3, v190, v191
  v_max_u32 v3, v3, v4
  v_cmp_lt_u32 vcc, s19, v3
  s_nop 1
  s_cbranch_vccnz Ln169
  v_mfma_f32_32x32x16_bf16 v[120:135], v[220:223], v[188:191], v[120:135]
  v_mfma_f32_32x32x16_bf16 v[104:119], v[220:223], v[184:187], v[104:119]
  v_mfma_f32_32x32x16_bf16 v[88:103], v[216:219], v[188:191], v[88:103]
  v_mfma_f32_32x32x16_bf16 v[72:87], v[216:219], v[184:187], v[72:87]
  s_bitset0_b32 s18, 2
Ln169:
  s_bitcmp1_b32 s18, 3
  s_cbranch_scc0 Ln170
  v_max3_u32 v3, v192, v193, v194
  v_max3_u32 v4, v195, v196, v197
  v_max3_u32 v3, v3, v198, v199
  v_max_u32 v3, v3, v4
  v_cmp_lt_u32 vcc, s19, v3
  s_nop 1
  s_cbranch_vccnz Ln170
  v_mfma_f32_32x32x16_bf16 v[120:135], v[228:231], v[196:199], v[120:135]
  v_mfma_f32_32x32x16_bf16 v[104:119], v[228:231], v[192:195], v[104:119]
  v_mfma_f32_32x32x16_bf16 v[88:103], v[224:227], v[196:199], v[88:103]
  v_mfma_f32_32x32x16_bf16 v[72:87], v[224:227], v[192:195], v[72:87]
  s_bitset0_b32 s18, 3
Ln170:
  s_bitcmp1_b32 s18, 4
  s_cbranch_scc0 Ln171
  v_max3_u32 v3, v136, v137, v138
  v_max3_u32 v4, v139, v140, v141
  v_max3_u32 v3, v3, v142, v143
  v_max_u32 v3, v3, v4
  v_cmp_lt_u32 vcc, s19, v3
  s_nop 1
  s_cbranch_vccnz Ln171
  v_mfma_f32_32x32x16_bf16 v[120:135], v[236:239], v[140:143], v[120:135]
  v_mfma_f32_32x32x16_bf16 v[104:119], v[236:239], v[136:139], v[104:119]
  v_mfma_f32_32x32x16_bf16 v[88:103], v[232:235], v[140:143], v[88:103]
  v_mfma_f32_32x32x16_bf16 v[72:87], v[232:235], v[136:139], v[72:87]
  s_bitset0_b32 s18, 4
Ln171:
  s_bitcmp1_b32 s18, 5
  s_cbranch_scc0 Ln172
  v_max3_u32 v3, v144, v145, v146
  v_max3_u32 v4, v147, v148, v149
  v_max3_u32 v3, v3, v150, v151
  v_max_u32 v3, v3, v4
  v_cmp_lt_u32 vcc, s19, v3
  s_nop 1
  s_cbranch_vccnz Ln172
  v_mfma_f32_32x32x16_bf16 v[120:135], v[244:247], v[148:151], v[120:135]
  v_mfma_f32_32x32x16_bf16 v[104:119], v[244:247], v[144:147], v[104:119]
  v_mfma_f32_32x32x16_bf16 v[88:103], v[240:243], v[148:151], v[88:103]
  v_mfma_f32_32x32x16_bf16 v[72:87], v[240:243], v[144:147], v[72:87]
  s_bitset0_b32 s18, 5
Ln172:
  s_bitcmp1_b32 s18, 6
  s_cbranch_scc0 Ln173
  v_max3_u32 v3, v152, v153, v154
  v_max3_u32 v4, v155, v156, v157
  v_max3_u32 v3, v3, v158, v159
  v_max_u32 v3, v3, v4
  v_cmp_lt_u32 vcc, s19, v3
  s_nop 1
  s_cbranch_vccnz Ln173
  v_mfma_f32_32x32x16_bf16 v[120:135], v[60:63], v[156:159], v[120:135]
  v_mfma_f32_32x32x16_bf16 v[104:119], v[60:63], v[152:155], v[104:119]
  v_mfma_f32_32x32x16_bf16 v[88:103], v[56:59], v[156:159], v[88:103]
  v_mfma_f32_32x32x16_bf16 v[72:87], v[56:59], v[152:155], v[72:87]
  s_bitset0_b32 s18, 6
Ln173:
  s_bitcmp1_b32 s18, 7
  s_cbranch_scc0 Ln174
  v_max3_u32 v3, v160, v161, v162
  v_max3_u32 v4, v163, v164, v165
  v_max3_u32 v3, v3, v166, v167
  v_max_u32 v3, v3, v4
  v_cmp_lt_u32 vcc, s19, v3
  s_nop 1
  s_cbranch_vccnz Ln174
  v_mfma_f32_32x32x16_bf16 v[120:135], v[68:71], v[164:167], v[120:135]
  v_mfma_f32_32x32x16_bf16 v[104:119], v[68:71], v[160:163], v[104:119]
  v_mfma_f32_32x32x16_bf16 v[88:103], v[64:67], v[164:167], v[88:103]
  v_mfma_f32_32x32x16_bf16 v[72:87], v[64:67], v[160:163], v[72:87]
  s_bitset0_b32 s18, 7
Ln174:
  s_cmp_eq_u32 s18, 0
  s_cbranch_scc1 Lf157
  s_sub_u32 s54, s54, 1
  s_cmp_gt_i32 s54, 0
  s_cbranch_scc1 Lr158
  s_mov_b32 s19, -1
  s_branch Lr158
Lm141:
  s_bitset1_b32 s18, 0
  s_branch Ld142
Lm143:
  s_bitset1_b32 s18, 1
  s_branch Ld144
Lm145:
  s_bitset1_b32 s18, 2
  s_branch Ld146
Lm147:
  s_bitset1_b32 s18, 3
  s_branch Ld148
Lm149:
  s_bitset1_b32 s18, 4
  s_branch Ld150
Lm151:
  s_bitset1_b32 s18, 5
  s_branch Ld152
Lm153:
  s_bitset1_b32 s18, 6
  s_branch Ld154
Lm155:
  s_bitset1_b32 s18, 7
  s_branch Ld156
Lf157:
  s_nop 7
  s_nop 1
  ds_write_b128 v23, v[120:123] offset:8192
  ds_write_b128 v23, v[124:127] offset:9216
  ds_write_b128 v23, v[128:131] offset:10240
  ds_write_b128 v23, v[132:135] offset:11264
  ds_write_b128 v23, v[104:107] offset:4096
  ds_write_b128 v23, v[108:111] offset:5120
  ds_write_b128 v23, v[112:115] offset:6144
  ds_write_b128 v23, v[116:119] offset:7168
  ds_write_b128 v23, v[88:91] offset:0
  ds_write_b128 v23, v[92:95] offset:1024
  ds_write_b128 v23, v[96:99] offset:2048
  ds_write_b128 v23, v[100:103] offset:3072
  v_mov_b32 v3, 1
  ds_write_b32 v12, v3 offset:192
Lp175:
  ds_read_b128 v[28:31], v11 offset:192
  s_waitcnt lgkmcnt(0)
  v_min_u32 v9, v28, v29
  v_min3_u32 v9, v9, v30, v31
  s_nop 0
  v_readfirstlane_b32 s58, v9
  s_cmp_ge_u32 s58, 1
  s_cbranch_scc1 Ld176
  s_sub_u32 s54, s54, 1
  s_cmp_gt_i32 s54, 0
  s_cbranch_scc1 Lp175
Ld176:
  ds_read_b128 v[88:91], v24 offset:0
  ds_read_b128 v[92:95], v24 offset:1024
  ds_read_b128 v[96:99], v24 offset:2048
  ds_read_b128 v[100:103], v24 offset:3072
  ds_read_b128 v[104:107], v25 offset:0
  ds_read_b128 v[108:111], v25 offset:1024
  ds_read_b128 v[112:115], v25 offset:2048
  ds_read_b128 v[116:119], v25 offset:3072
  ds_read_b128 v[120:123], v26 offset:0
  ds_read_b128 v[124:127], v26 offset:1024
  ds_read_b128 v[128:131], v26 offset:2048
  ds_read_b128 v[132:135], v26 offset:3072
  s_waitcnt lgkmcnt(8)
  v_add_f32 v72, v72, v88
  v_add_f32 v73, v73, v89
  v_add_f32 v74, v74, v90
  v_add_f32 v75, v75, v91
  v_add_f32 v76, v76, v92
  v_add_f32 v77, v77, v93
  v_add_f32 v78, v78, v94
  v_add_f32 v79, v79, v95
  v_add_f32 v80, v80, v96
  v_add_f32 v81, v81, v97
  v_add_f32 v82, v82, v98
  v_add_f32 v83, v83, v99
  v_add_f32 v84, v84, v100
  v_add_f32 v85, v85, v101
  v_add_f32 v86, v86, v102
  v_add_f32 v87, v87, v103
  s_waitcnt lgkmcnt(4)
  v_add_f32 v72, v72, v104
  v_add_f32 v73, v73, v105
  v_add_f32 v74, v74, v106
  v_add_f32 v75, v75, v107
  v_add_f32 v76, v76, v108
  v_add_f32 v77, v77, v109
  v_add_f32 v78, v78, v110
  v_add_f32 v79, v79, v111
  v_add_f32 v80, v80, v112
  v_add_f32 v81, v81, v113
  v_add_f32 v82, v82, v114
  v_add_f32 v83, v83, v115
  v_add_f32 v84, v84, v116
  v_add_f32 v85, v85, v117
  v_add_f32 v86, v86, v118
  v_add_f32 v87, v87, v119
  s_waitcnt lgkmcnt(0)
  v_add_f32 v72, v72, v120
  v_add_f32 v73, v73, v121
  v_add_f32 v74, v74, v122
  v_add_f32 v75, v75, v123
  v_add_f32 v76, v76, v124
  v_add_f32 v77, v77, v125
  v_add_f32 v78, v78, v126
  v_add_f32 v79, v79, v127
  v_add_f32 v80, v80, v128
  v_add_f32 v81, v81, v129
  v_add_f32 v82, v82, v130
  v_add_f32 v83, v83, v131
  v_add_f32 v84, v84, v132
  v_add_f32 v85, v85, v133
  v_add_f32 v86, v86, v134
  v_add_f32 v87, v87, v135
  v_cvt_pk_bf16_f32 v88, v72, v73
  v_cvt_pk_bf16_f32 v89, v74, v75
  v_cvt_pk_bf16_f32 v90, v76, v77
  v_cvt_pk_bf16_f32 v91, v78, v79
  v_cvt_pk_bf16_f32 v92, v80, v81
  v_cvt_pk_bf16_f32 v93, v82, v83
  v_cvt_pk_bf16_f32 v94, v84, v85
  v_cvt_pk_bf16_f32 v95, v86, v87
  s_nop 1
  v_permlane32_swap_b32 v88, v90
  v_permlane32_swap_b32 v89, v91
  v_permlane32_swap_b32 v92, v94
  v_permlane32_swap_b32 v93, v95
  buffer_store_dwordx4 v[88:91], v27, s[32:35], 0 offen offset:0
  buffer_store_dwordx4 v[92:95], v27, s[32:35], 0 offen offset:32
  s_endpgm
f_gtail:
  s_nop 7
  v_mul_f32 v72, 0xbfb8aa3b, v72
  v_mul_f32 v73, 0xbfb8aa3b, v73
  v_mul_f32 v74, 0xbfb8aa3b, v74
  v_mul_f32 v75, 0xbfb8aa3b, v75
  v_mul_f32 v76, 0xbfb8aa3b, v76
  v_mul_f32 v77, 0xbfb8aa3b, v77
  v_mul_f32 v78, 0xbfb8aa3b, v78
  v_mul_f32 v79, 0xbfb8aa3b, v79
  v_exp_f32 v72, v72
  v_exp_f32 v73, v73
  v_exp_f32 v74, v74
  v_exp_f32 v75, v75
  v_exp_f32 v76, v76
  v_exp_f32 v77, v77
  v_exp_f32 v78, v78
  v_exp_f32 v79, v79
  v_fma_f32 v72, v72, v13, v13
  v_fma_f32 v73, v73, v13, v13
  v_fma_f32 v74, v74, v13, v13
  v_fma_f32 v75, v75, v13, v13
  v_fma_f32 v76, v76, v13, v13
  v_fma_f32 v77, v77, v13, v13
  v_fma_f32 v78, v78, v13, v13
  v_fma_f32 v79, v79, v13, v13
  v_rcp_f32 v72, v72
  v_rcp_f32 v73, v73
  v_rcp_f32 v74, v74
  v_rcp_f32 v75, v75
  v_rcp_f32 v76, v76
  v_rcp_f32 v77, v77
  v_rcp_f32 v78, v78
  v_rcp_f32 v79, v79
  v_mul_f32 v80, v72, v80
  v_mul_f32 v81, v73, v81
  v_mul_f32 v82, v74, v82
  v_mul_f32 v83, v75, v83
  v_mul_f32 v84, v76, v84
  v_mul_f32 v85, v77, v85
  v_mul_f32 v86, v78, v86
  v_mul_f32 v87, v79, v87
  v_cvt_pk_bf16_f32 v72, v80, v81
  v_cvt_pk_bf16_f32 v73, v82, v83
  v_cvt_pk_bf16_f32 v74, v84, v85
  v_cvt_pk_bf16_f32 v75, v86, v87
  buffer_store_dwordx4 v[72:75], v2, s[28:31], s63 offen offset:0 sc1
  v_mul_f32 v88, 0xbfb8aa3b, v88
  v_mul_f32 v89, 0xbfb8aa3b, v89
  v_mul_f32 v90, 0xbfb8aa3b, v90
  v_mul_f32 v91, 0xbfb8aa3b, v91
  v_mul_f32 v92, 0xbfb8aa3b, v92
  v_mul_f32 v93, 0xbfb8aa3b, v93
  v_mul_f32 v94, 0xbfb8aa3b, v94
  v_mul_f32 v95, 0xbfb8aa3b, v95
  v_exp_f32 v88, v88
  v_exp_f32 v89, v89
  v_exp_f32 v90, v90
  v_exp_f32 v91, v91
  v_exp_f32 v92, v92
  v_exp_f32 v93, v93
  v_exp_f32 v94, v94
  v_exp_f32 v95, v95
  v_fma_f32 v88, v88, v13, v13
  v_fma_f32 v89, v89, v13, v13
  v_fma_f32 v90, v90, v13, v13
  v_fma_f32 v91, v91, v13, v13
  v_fma_f32 v92, v92, v13, v13
  v_fma_f32 v93, v93, v13, v13
  v_fma_f32 v94, v94, v13, v13
  v_fma_f32 v95, v95, v13, v13
  v_rcp_f32 v88, v88
  v_rcp_f32 v89, v89
  v_rcp_f32 v90, v90
  v_rcp_f32 v91, v91
  v_rcp_f32 v92, v92
  v_rcp_f32 v93, v93
  v_rcp_f32 v94, v94
  v_rcp_f32 v95, v95
  v_mul_f32 v96, v88, v96
  v_mul_f32 v97, v89, v97
  v_mul_f32 v98, v90, v98
  v_mul_f32 v99, v91, v99
  v_mul_f32 v100, v92, v100
  v_mul_f32 v101, v93, v101
  v_mul_f32 v102, v94, v102
  v_mul_f32 v103, v95, v103
  v_cvt_pk_bf16_f32 v88, v96, v97
  v_cvt_pk_bf16_f32 v89, v98, v99
  v_cvt_pk_bf16_f32 v90, v100, v101
  v_cvt_pk_bf16_f32 v91, v102, v103
  buffer_store_dwordx4 v[88:91], v2, s[28:31], s63 offen offset:1024 sc1
  v_mul_f32 v104, 0xbfb8aa3b, v104
  v_mul_f32 v105, 0xbfb8aa3b, v105
  v_mul_f32 v106, 0xbfb8aa3b, v106
  v_mul_f32 v107, 0xbfb8aa3b, v107
  v_mul_f32 v108, 0xbfb8aa3b, v108
  v_mul_f32 v109, 0xbfb8aa3b, v109
  v_mul_f32 v110, 0xbfb8aa3b, v110
  v_mul_f32 v111, 0xbfb8aa3b, v111
  v_exp_f32 v104, v104
  v_exp_f32 v105, v105
  v_exp_f32 v106, v106
  v_exp_f32 v107, v107
  v_exp_f32 v108, v108
  v_exp_f32 v109, v109
  v_exp_f32 v110, v110
  v_exp_f32 v111, v111
  v_fma_f32 v104, v104, v13, v13
  v_fma_f32 v105, v105, v13, v13
  v_fma_f32 v106, v106, v13, v13
  v_fma_f32 v107, v107, v13, v13
  v_fma_f32 v108, v108, v13, v13
  v_fma_f32 v109, v109, v13, v13
  v_fma_f32 v110, v110, v13, v13
  v_fma_f32 v111, v111, v13, v13
  v_rcp_f32 v104, v104
  v_rcp_f32 v105, v105
  v_rcp_f32 v106, v106
  v_rcp_f32 v107, v107
  v_rcp_f32 v108, v108
  v_rcp_f32 v109, v109
  v_rcp_f32 v110, v110
  v_rcp_f32 v111, v111
  v_mul_f32 v112, v104, v112
  v_mul_f32 v113, v105, v113
  v_mul_f32 v114, v106, v114
  v_mul_f32 v115, v107, v115
  v_mul_f32 v116, v108, v116
  v_mul_f32 v117, v109, v117
  v_mul_f32 v118, v110, v118
  v_mul_f32 v119, v111, v119
  v_cvt_pk_bf16_f32 v104, v112, v113
  v_cvt_pk_bf16_f32 v105, v114, v115
  v_cvt_pk_bf16_f32 v106, v116, v117
  v_cvt_pk_bf16_f32 v107, v118, v119
  buffer_store_dwordx4 v[104:107], v2, s[28:31], s63 offen offset:2048 sc1
  s_waitcnt vmcnt(0)
  v_mov_b32 v9, 2
  v_mov_b32 v10, 0
  s_mov_b64 exec, 1
  buffer_store_dword v9, v10, s[28:31], s62 offen sc1
  s_mov_b64 exec, -1
  v_mov_b32 v10, 24
  ds_write_b32 v12, v10 offset:16
f_exit:
  s_endpgm
f_end:
.section .rodata,"a"
.p2align 6
.amdhsa_kernel f_kernel
  .amdhsa_next_free_vgpr 248
  .amdhsa_next_free_sgpr 102
  .amdhsa_accum_offset 248
  .amdhsa_group_segment_fixed_size 0
  .amdhsa_kernarg_size 88
  .amdhsa_user_sgpr_count 2
  .amdhsa_user_sgpr_kernarg_segment_ptr 1
  .amdhsa_system_sgpr_workgroup_id_x 1
.end_amdhsa_kernel
```
